```python
import torch

def _softmax(x, axis=-1):
    return torch.softmax(x, dim=axis)
def _gelu(x):
    return torch.nn.functional.gelu(x, approximate="tanh")
def _silu(x):
    return torch.nn.functional.silu(x)
def _sigmoid(x):
    return torch.sigmoid(x)
def _layernorm(x, axis=-1, eps=1e-5):
    m = x.mean(dim=axis, keepdim=True)
    v = x.var(dim=axis, keepdim=True, unbiased=False)
    return (x - m) / torch.sqrt(v + eps)
def _scatter_add(tgt, idx, src, axis=0):
    return tgt.clone().index_add_(axis, idx, src)
def _segment_sum(src, seg, n):
    out = torch.zeros((n,) + src.shape[1:], dtype=src.dtype)
    return out.index_add_(0, seg, src)
def _pad(x, pw):
    flat = tuple(v for pair in reversed(pw) for v in pair)
    return torch.nn.functional.pad(x, flat)

kernel_name = 'gated_mix__ssm_conv_s4d__spectral_gfnet__prompt'

def setup_inputs():

    _w = (lambda a: (lambda t: t.to(torch.bfloat16) if t.is_floating_point() else t)(torch.as_tensor(a)))
    def _A_setup():
        Bsz, L, D, N = 1, 2048, 640, 128
        return {
            "u": _w((lambda *s: torch.randn(*s, dtype=torch.bfloat16) * 0.05)(Bsz, L, D)),
            "log_A_real": _w((lambda *s: torch.randn(*s, dtype=torch.bfloat16) * 3.2)(D, N) * 0.5),
            "A_imag": _w((lambda *s: torch.randn(*s, dtype=torch.bfloat16) * 0.05)(D, N) * 3.14),
            "C_real": _w((lambda *s: torch.randn(*s, dtype=torch.bfloat16) * 0.1)(D, N) / N ** 0.5),
            "C_imag": _w((lambda *s: torch.randn(*s, dtype=torch.bfloat16) * 0.1)(D, N) / N ** 0.5),
            "log_dt": _w((lambda *s: torch.randn(*s, dtype=torch.bfloat16) * 0.05)(D) * 0.5 - 4.0),
            "D_skip": _w((lambda *s: torch.randn(*s, dtype=torch.bfloat16) * 0.05)(D)),
        }
    _A_in = _A_setup()

    def _B_setup():
        B, S, D = 1, 2048, 640
        Df = D // 2 + 1
        return {
            "x": _w((lambda *s: torch.randn(*s, dtype=torch.bfloat16) * 0.05)(B, S, D)),
            "w_r": _w((lambda *s: torch.randn(*s, dtype=torch.bfloat16) * 0.8)(S, Df) * 0.02),
            "w_i": _w((lambda *s: torch.randn(*s, dtype=torch.bfloat16) * 0.8)(S, Df) * 0.02),
        }
    _B_in = _B_setup()

    return {
        "A_u": _A_in["u"],
        "A_log_A_real": _A_in["log_A_real"],
        "A_A_imag": _A_in["A_imag"],
        "A_C_real": _A_in["C_real"],
        "A_C_imag": _A_in["C_imag"],
        "A_log_dt": _A_in["log_dt"],
        "A_D_skip": _A_in["D_skip"],
        "B_x": _B_in["x"],
        "B_w_r": _B_in["w_r"],
        "B_w_i": _B_in["w_i"],
        "gate_w": _w((lambda *s: torch.randn(*s, dtype=torch.bfloat16) * 0.05)(640) * 16.0),
    }

def reference(A_u, A_log_A_real, A_A_imag, A_C_real, A_C_imag, A_log_dt, A_D_skip, B_x, B_w_r, B_w_i, gate_w):
    def _A_ref(u, log_A_real, A_imag, C_real, C_imag, log_dt, D_skip):
        L = u.shape[1]
        dt = torch.exp(log_dt)
        A = -torch.exp(log_A_real) + 1j * A_imag
        C = (C_real + 1j * C_imag) * dt[:, None]
        pos = (lambda x, dt: x.to(dt))(torch.arange(L), log_dt.dtype)
        P = torch.exp((A * dt[:, None])[:, :, None] * pos[None, None, :])
        K = 2.0 * torch.einsum("dn,dnl->dl", C, P).real
        L2 = 2 * L
        u_t = (lambda x, *d: x.permute(*d))(u, 0, 2, 1)
        Kf = (lambda x, *a, **k: torch.fft.rfft(x.float(), *a, **k))(K, L2)
        Uf = (lambda x, *a, **k: torch.fft.rfft(x.float(), *a, **k))(u_t, L2)
        y = (lambda x, *a, **k: torch.fft.irfft(x, *a, **k).to(torch.bfloat16))(Uf * Kf[None, :, :], L2)[:, :, :L]
        y = (lambda x, *d: x.permute(*d))(y, 0, 2, 1)
        return y + u * D_skip[None, None, :]

    def _B_ref(x, w_r, w_i):
        B, S, D = x.shape
        X = (lambda x, axes=(-2,-1): torch.fft.rfft2(x.float(), dim=axes))(x, axes=(-2, -1))
        W = w_r + 1j * w_i
        X = X * W
        y = (lambda x, s, axes=(-2,-1): torch.fft.irfft2(x, s=s, dim=axes).to(torch.bfloat16))(X, (S, D), axes=(-2, -1))
        return y

    x = A_u
    g = _sigmoid((x * gate_w).sum(-1, keepdims=True))
    a = _A_ref(x, A_log_A_real, A_A_imag, A_C_real, A_C_imag, A_log_dt, A_D_skip)
    b = _B_ref(x, B_w_r, B_w_i)
    return g * a + (1 - g) * b
```

```asm
; @launch grid=(480,1,1) block=(256,1,1) lds=77232
.amdgcn_target "amdgcn-amd-amdhsa--gfx950"
.text
.globl gated_mix__ssm_conv_s4d__spectral_gfnet__prompt_kernel
.p2align 8
.type gated_mix__ssm_conv_s4d__spectral_gfnet__prompt_kernel,@function
gated_mix__ssm_conv_s4d__spectral_gfnet__prompt_kernel:
    s_cmp_ge_u32 s2, 480
    s_cbranch_scc1 Lend
    s_load_dwordx16 s[4:19], s[0:1], 0
    s_load_dwordx8 s[20:27], s[0:1], 64
    s_load_dwordx4 s[28:31], s[0:1], 96
    s_getpc_b64 s[94:95]
Lbase:
    v_lshrrev_b32 v1, 6, v0
    s_lshr_b32 s3, s2, 3
    v_readfirstlane_b32 s33, v1
    s_cmp_ge_u32 s2, 224
    s_cbranch_scc1 LroleB
    s_cmp_lg_u32 s33, 3
    s_cbranch_scc1 LA_nocpf
    v_and_b32 v2, 7, v0
    v_mul_u32_u24 v2, 28, v2
    v_add_lshl_u32 v2, v2, s3, 7
    v_min_u32 v2, Lcode_end-Lbase-4, v2
    global_load_dword v254, v2, s[94:95]
LA_nocpf:
    s_sub_u32 s56, s2, 0
    s_and_b32 s57, s56, 7
    s_lshr_b32 s56, s56, 3
    s_and_b32 s85, s56, 1
    s_lshr_b32 s58, s56, 1
    s_lshl_b32 s84, s58, 3
    s_add_u32 s84, s84, s57
    s_cmp_ge_u32 s84, 107
    s_cbranch_scc1 Lend
    s_lshl_b32 s83, s84, 1
    s_add_u32 s83, s83, s85
    s_mul_i32 s86, s83, 3
    s_add_u32 s86, s86, s33
    s_min_u32 s86, s86, 639
    v_and_b32 v1, 63, v0
    v_and_b32 v2, 15, v0
    v_bfe_u32 v3, v0, 4, 2
    v_mov_b32 v4, 0xffff0000
    s_lshl_b32 s57, s86, 8
    v_lshl_add_u32 v5, v1, 2, s57
    s_lshl_b32 s58, s86, 1
    v_mov_b32 v6, s58
    v_mov_b32 v16, 0
    s_waitcnt lgkmcnt(0)
    s_load_dword s32, s[30:31], 0
    s_cmp_eq_u32 s33, 3
    s_cbranch_scc1 LA_w3
    global_load_dword v11, v5, s[6:7]
    global_load_dword v12, v5, s[8:9]
    global_load_dword v13, v5, s[10:11]
    global_load_dword v14, v5, s[12:13]
    global_load_ushort v15, v6, s[14:15]
    global_load_short_d16_hi v16, v6, s[16:17]
    s_setprio 1
    s_branch LA_main
LroleB:
    v_lshlrev_b32 v4, 4, v0
    v_and_b32 v1, 63, v0
    v_and_b32 v2, 15, v0
    v_bfe_u32 v3, v0, 4, 2
    s_and_b32 s83, s2, 7
    s_sub_u32 s84, s3, 28
    s_lshl_b32 s34, s83, 5
    s_add_u32 s34, s34, s84
    s_mul_i32 s87, s34, 1280
    v_lshlrev_b32 v5, 4, v1
    v_add_u32 v7, 1024, v5
    v_min_u32 v7, 1264, v7
    v_add_u32 v8, 327360, v5
    v_sub_u32 v9, 19, v1
    v_ashrrev_i32 v9, 31, v9
    v_bfi_b32 v17, v9, v8, v7
    v_add_u32 v7, 704, v5
    v_min_u32 v7, 1264, v7
    v_add_u32 v8, 327040, v5
    v_sub_u32 v9, 39, v1
    v_ashrrev_i32 v9, 31, v9
    v_bfi_b32 v18, v9, v8, v7
    s_lshr_b32 s85, s83, 1
    s_add_u32 s85, s85, 1
    s_and_b32 s86, s83, 1
    s_sub_u32 s56, s83, 6
    s_lshl_b32 s56, s56, 2
    s_cmp_ge_u32 s83, 6
    s_cselect_b32 s85, s56, s85
    s_cselect_b32 s86, 0, s86
    s_mul_i32 s57, s33, 655360
    s_add_u32 s57, s57, s87
    s_add_u32 s58, s57, 327680
    s_mul_i32 s56, s33, 2688
    s_waitcnt lgkmcnt(0)
    s_load_dword s32, s[30:31], 0
    s_mov_b32 s36, s4
    s_mov_b32 s37, s5
    s_mov_b32 s38, 2621440
    s_mov_b32 s39, 0x20000
    s_add_u32 m0, s56, 0
    s_nop 0
    buffer_load_dwordx4 v5, s[36:39], s57 offen nt lds
    s_add_u32 m0, s56, 1024
    s_nop 0
    buffer_load_dwordx4 v17, s[36:39], s57 offen nt lds
    s_add_u32 m0, s56, 2048
    s_nop 0
    buffer_load_dwordx4 v18, s[36:39], s58 offen nt lds
    s_setprio 3
    s_cmp_ge_u32 s84, 27
    s_cselect_b32 s56, 5, 0
    s_cselect_b32 s96, 0, 3538944
    s_sub_u32 s88, s84, s56
    s_lshl_b32 s60, s84, 6
    s_add_u32 s60, s60, s85
    s_sub_u32 s61, 1992, s60
    s_cmp_eq_u32 s86, 1
    s_cselect_b32 s60, s61, s60
    s_mul_i32 s60, s60, 642
    s_and_b32 s71, s60, -4
    s_mul_i32 s60, s33, 640
    s_sub_u32 s60, s60, 1280
    s_cmp_ge_u32 s33, 2
    s_cselect_b32 s71, s60, s71
    v_lshrrev_b32 v15, 3, v1
    v_and_b32 v16, 7, v1
    v_mul_u32_u24 v15, 5136, v15
    v_lshlrev_b32 v16, 7, v16
    v_min_u32 v16, 648, v16
    v_add_u32 v15, v16, v15
    s_cmp_eq_u32 s33, 0
    s_cselect_b32 s72, s20, s22
    s_cselect_b32 s73, s21, s23
    s_cmp_ge_u32 s33, 2
    s_cselect_b32 s72, s24, s72
    s_cselect_b32 s73, s25, s73
    s_mov_b32 s74, 1314816
    s_cselect_b32 s74, 1280, s74
    s_mov_b32 s75, 0x20000
    buffer_load_dword v254, v15, s[72:75], s71 offen nt
    v_lshlrev_b32 v44, 2, v3
    v_lshrrev_b32 v45, 2, v2
    v_and_b32 v46, 2, v2
    v_lshl_add_u32 v45, v46, 1, v45
    v_and_b32 v46, 1, v2
    v_cvt_f32_u32 v45, v45
    v_cvt_f32_u32 v46, v46
    v_cvt_f32_u32 v19, v44
    v_mul_f32 v45, 0x3ccccccd, v45
    v_mul_f32 v46, 0x3e800000, v46
    v_subrev_u32 v44, 8, v44
    v_ashrrev_i32 v44, 31, v44
    s_lshl_b32 s56, s33, 3
    s_lshr_b32 s56, 0x1201000, s56
    s_and_b32 s57, s56, 15
    s_and_b32 s58, s56, 0x30
    v_cvt_f32_u32 v7, s57
    v_cvt_f32_u32 v8, s58
    s_cmp_eq_u32 s58, 0x20
    s_cselect_b32 s57, 0, -1
    v_fmamk_f32 v7, v7, 0x3e4ccccd, v45
    v_add_f32 v8, v8, v19
    v_or_b32 v51, s57, v44
    v_fma_f32 v8, v7, v8, v46
    v_cos_f32 v9, v8
    v_sin_f32 v10, v8
    v_add_f32 v8, v8, v7
    v_cos_f32 v11, v8
    v_sin_f32 v12, v8
    v_add_f32 v8, v8, v7
    v_cos_f32 v13, v8
    v_sin_f32 v14, v8
    v_add_f32 v8, v8, v7
    v_cos_f32 v15, v8
    v_sin_f32 v16, v8
    v_cvt_pk_bf16_f32 v9, v9, v10
    v_cvt_pk_bf16_f32 v10, v11, v12
    v_cvt_pk_bf16_f32 v11, v13, v14
    v_cvt_pk_bf16_f32 v12, v15, v16
    v_and_b32 v48, v51, v9
    v_and_b32 v49, v51, v10
    v_and_b32 v50, v51, v11
    v_and_b32 v51, v51, v12
    ds_write_b128 v4, v[48:51] offset:12288
    s_lshl_b32 s56, s33, 3
    s_lshr_b32 s56, 0x12022111, s56
    s_and_b32 s57, s56, 15
    s_and_b32 s58, s56, 0x30
    v_cvt_f32_u32 v7, s57
    v_cvt_f32_u32 v8, s58
    s_cmp_eq_u32 s58, 0x20
    s_cselect_b32 s57, 0, -1
    v_fmamk_f32 v7, v7, 0x3e4ccccd, v45
    v_add_f32 v8, v8, v19
    v_or_b32 v51, s57, v44
    v_fma_f32 v8, v7, v8, v46
    v_cos_f32 v9, v8
    v_sin_f32 v10, v8
    v_add_f32 v8, v8, v7
    v_cos_f32 v11, v8
    v_sin_f32 v12, v8
    v_add_f32 v8, v8, v7
    v_cos_f32 v13, v8
    v_sin_f32 v14, v8
    v_add_f32 v8, v8, v7
    v_cos_f32 v15, v8
    v_sin_f32 v16, v8
    v_cvt_pk_bf16_f32 v9, v9, v10
    v_cvt_pk_bf16_f32 v10, v11, v12
    v_cvt_pk_bf16_f32 v11, v13, v14
    v_cvt_pk_bf16_f32 v12, v15, v16
    v_and_b32 v48, v51, v9
    v_and_b32 v49, v51, v10
    v_and_b32 v50, v51, v11
    v_and_b32 v51, v51, v12
    ds_write_b128 v4, v[48:51] offset:16384
    s_lshl_b32 s56, s33, 3
    s_lshr_b32 s56, 0x23130322, s56
    s_and_b32 s57, s56, 15
    s_and_b32 s58, s56, 0x30
    v_cvt_f32_u32 v7, s57
    v_cvt_f32_u32 v8, s58
    s_cmp_eq_u32 s58, 0x20
    s_cselect_b32 s57, 0, -1
    v_fmamk_f32 v7, v7, 0x3e4ccccd, v45
    v_add_f32 v8, v8, v19
    v_or_b32 v51, s57, v44
    v_fma_f32 v8, v7, v8, v46
    v_cos_f32 v9, v8
    v_sin_f32 v10, v8
    v_add_f32 v8, v8, v7
    v_cos_f32 v11, v8
    v_sin_f32 v12, v8
    v_add_f32 v8, v8, v7
    v_cos_f32 v13, v8
    v_sin_f32 v14, v8
    v_add_f32 v8, v8, v7
    v_cos_f32 v15, v8
    v_sin_f32 v16, v8
    v_cvt_pk_bf16_f32 v9, v9, v10
    v_cvt_pk_bf16_f32 v10, v11, v12
    v_cvt_pk_bf16_f32 v11, v13, v14
    v_cvt_pk_bf16_f32 v12, v15, v16
    v_and_b32 v48, v51, v9
    v_and_b32 v49, v51, v10
    v_and_b32 v50, v51, v11
    v_and_b32 v51, v51, v12
    ds_write_b128 v4, v[48:51] offset:20480
    s_cmp_eq_u32 s33, 3
    s_cbranch_scc1 LB_tw
    s_lshl_b32 s56, s33, 3
    s_lshr_b32 s56, 0x5241404, s56
    s_and_b32 s57, s56, 15
    s_and_b32 s58, s56, 0x30
    v_cvt_f32_u32 v7, s57
    v_cvt_f32_u32 v8, s58
    s_cmp_eq_u32 s58, 0x20
    s_cselect_b32 s57, 0, -1
    v_fmamk_f32 v7, v7, 0x3e4ccccd, v45
    v_add_f32 v8, v8, v19
    v_or_b32 v51, s57, v44
    v_fma_f32 v8, v7, v8, v46
    v_cos_f32 v9, v8
    v_sin_f32 v10, v8
    v_add_f32 v8, v8, v7
    v_cos_f32 v11, v8
    v_sin_f32 v12, v8
    v_add_f32 v8, v8, v7
    v_cos_f32 v13, v8
    v_sin_f32 v14, v8
    v_add_f32 v8, v8, v7
    v_cos_f32 v15, v8
    v_sin_f32 v16, v8
    v_cvt_pk_bf16_f32 v9, v9, v10
    v_cvt_pk_bf16_f32 v10, v11, v12
    v_cvt_pk_bf16_f32 v11, v13, v14
    v_cvt_pk_bf16_f32 v12, v15, v16
    v_and_b32 v48, v51, v9
    v_and_b32 v49, v51, v10
    v_and_b32 v50, v51, v11
    v_and_b32 v51, v51, v12
    ds_write_b128 v4, v[48:51] offset:24576
    s_branch LB_notw
LB_tw:
    v_cvt_f32_u32 v18, v2
    v_mul_f32 v7, 0x3acccccd, v18
    v_mul_f32 v8, v7, v19
    v_fmamk_f32 v32, v7, 0x0, v8
    v_fmamk_f32 v33, v7, 0x3f800000, v8
    v_fmamk_f32 v34, v7, 0x40000000, v8
    v_fmamk_f32 v35, v7, 0x40400000, v8
    v_cos_f32 v20, v32
    v_sin_f32 v32, v32
    v_cos_f32 v21, v33
    v_sin_f32 v33, v33
    v_cos_f32 v22, v34
    v_sin_f32 v34, v34
    v_cos_f32 v23, v35
    v_sin_f32 v35, v35
    ds_write_b128 v5, v[20:23] offset:40192
    ds_write_b128 v5, v[32:35] offset:41216
    v_fmamk_f32 v36, v7, 0x41800000, v8
    v_fmamk_f32 v37, v7, 0x41880000, v8
    v_fmamk_f32 v38, v7, 0x41900000, v8
    v_fmamk_f32 v39, v7, 0x41980000, v8
    v_cos_f32 v24, v36
    v_sin_f32 v36, v36
    v_cos_f32 v25, v37
    v_sin_f32 v37, v37
    v_cos_f32 v26, v38
    v_sin_f32 v38, v38
    v_cos_f32 v27, v39
    v_sin_f32 v39, v39
    ds_write_b128 v5, v[24:27] offset:42240
    ds_write_b128 v5, v[36:39] offset:43264
    v_fmamk_f32 v40, v7, 0x42000000, v8
    v_fmamk_f32 v41, v7, 0x42040000, v8
    v_fmamk_f32 v42, v7, 0x42080000, v8
    v_fmamk_f32 v43, v7, 0x420c0000, v8
    v_cos_f32 v28, v40
    v_sin_f32 v40, v40
    v_cos_f32 v29, v41
    v_sin_f32 v41, v41
    v_cos_f32 v30, v42
    v_sin_f32 v42, v42
    v_cos_f32 v31, v43
    v_sin_f32 v43, v43
    ds_write_b128 v5, v[28:31] offset:44288
    ds_write_b128 v5, v[40:43] offset:45312
LB_notw:
    v_mov_b32 v6, 0xffff0000
    v_and_b32 v7, 1, v3
    v_lshrrev_b32 v8, 1, v3
    v_lshl_or_b32 v18, v7, 1, v8
    v_mul_u32_u24 v7, v18, v2
    v_cvt_f32_u32 v7, v7
    s_lshl_b32 s56, s33, 1
    s_lshl_b32 s57, s33, 2
    s_mul_i32 s58, s33, 6
    s_cmp_eq_u32 s33, 0
    s_cselect_b32 s59, 14, 0
    s_cselect_b32 s56, 2, s56
    s_cselect_b32 s57, 14, s57
    s_cselect_b32 s58, 2, s58
    s_and_b32 s60, s33, 1
    s_mul_i32 s60, s60, 0x80008000
    v_cvt_f32_u32 v8, s59
    v_cvt_f32_u32 v9, s56
    v_cvt_f32_u32 v10, s57
    v_cvt_f32_u32 v11, s58
    v_add_f32 v8, v8, v7
    v_add_f32 v9, v9, v7
    v_add_f32 v10, v10, v7
    v_add_f32 v11, v11, v7
    v_mul_f32 v8, 0x3d800000, v8
    v_mul_f32 v9, 0x3d800000, v9
    v_mul_f32 v10, 0x3d800000, v10
    v_mul_f32 v11, 0x3d800000, v11
    v_cos_f32 v12, v8
    v_sin_f32 v8, v8
    v_cos_f32 v13, v9
    v_sin_f32 v9, v9
    v_cos_f32 v14, v10
    v_sin_f32 v10, v10
    v_cos_f32 v15, v11
    v_sin_f32 v11, v11
    v_mov_b32 v79, s60
    v_bfe_i32 v19, v2, 0, 1
    v_bfe_i32 v76, v2, 1, 1
    v_and_b32 v78, 0x80008000, v19
    v_and_b32 v76, 0x80008000, v76
    v_xor_b32 v77, v76, v78
    v_cvt_pk_bf16_f32 v44, v12, v13
    v_cvt_pk_bf16_f32 v60, -v8, -v9
    v_cvt_pk_bf16_f32 v45, v14, v15
    v_cvt_pk_bf16_f32 v61, -v10, -v11
    v_bfi_b32 v48, v19, v60, v44
    v_bfi_b32 v64, v19, v44, v60
    v_bfi_b32 v49, v19, v61, v45
    v_bfi_b32 v65, v19, v45, v61
    v_xor_b32 v48, v76, v48
    v_xor_b32 v64, v77, v64
    v_xor_b32 v49, v76, v49
    v_xor_b32 v65, v77, v65
    v_xor_b32 v52, v78, v44
    v_xor_b32 v68, v78, v60
    v_xor_b32 v53, v78, v45
    v_xor_b32 v69, v78, v61
    v_xor_b32 v56, v78, v48
    v_xor_b32 v72, v78, v64
    v_xor_b32 v57, v78, v49
    v_xor_b32 v73, v78, v65
    v_xor_b32 v46, v79, v44
    v_xor_b32 v62, v79, v60
    v_xor_b32 v47, v79, v45
    v_xor_b32 v63, v79, v61
    v_xor_b32 v50, v79, v48
    v_xor_b32 v66, v79, v64
    v_xor_b32 v51, v79, v49
    v_xor_b32 v67, v79, v65
    v_xor_b32 v54, v79, v52
    v_xor_b32 v70, v79, v68
    v_xor_b32 v55, v79, v53
    v_xor_b32 v71, v79, v69
    v_xor_b32 v58, v79, v56
    v_xor_b32 v74, v79, v72
    v_xor_b32 v59, v79, v57
    v_xor_b32 v75, v79, v73
    s_waitcnt lgkmcnt(0)
    s_or_b32 s32, s32, 1
    s_add_u32 s32, s32, 1
    s_barrier
    ds_read_b128 v[20:23], v5 offset:40192
    ds_read_b128 v[32:35], v5 offset:41216
    ds_read_b128 v[24:27], v5 offset:42240
    ds_read_b128 v[36:39], v5 offset:43264
    ds_read_b128 v[28:31], v5 offset:44288
    ds_read_b128 v[40:43], v5 offset:45312
    v_lshrrev_b32 v7, 2, v2
    v_and_b32 v8, 3, v2
    v_mul_u32_u24 v7, 1344, v7
    v_mul_u32_u24 v9, 80, v18
    v_lshl_add_u32 v7, v8, 3, v7
    v_add_u32 v19, v7, v9
    s_waitcnt lgkmcnt(0)
    ds_read_b128 v[76:79], v5 offset:12288
    ds_read_b128 v[88:91], v5 offset:15360
    ds_read_b128 v[100:103], v5 offset:18432
    ds_read_b128 v[112:115], v5 offset:21504
    ds_read_b128 v[124:127], v5 offset:24576
    ds_read_b128 v[80:83], v5 offset:13312
    ds_read_b128 v[92:95], v5 offset:16384
    ds_read_b128 v[104:107], v5 offset:19456
    ds_read_b128 v[116:119], v5 offset:22528
    ds_read_b128 v[128:131], v5 offset:25600
    ds_read_b128 v[84:87], v5 offset:14336
    ds_read_b128 v[96:99], v5 offset:17408
    ds_read_b128 v[108:111], v5 offset:20480
    ds_read_b128 v[120:123], v5 offset:23552
    ds_read_b128 v[132:135], v5 offset:26624
    s_add_u32 s89, s32, 1
    s_mul_i32 s90, s33, 2816
    s_add_u32 s90, s90, 27648
    s_lshr_b32 s91, s33, 1
    s_mov_b32 s56, 0x01000c0c
    s_mov_b32 s57, 0x03020c0c
    s_cmp_eq_u32 s91, 0
    s_cselect_b32 s100, s56, s57
    s_cselect_b32 s101, s57, s56
    s_cselect_b32 s60, 12, -12
    s_mov_b32 s61, 30232
    s_cselect_b32 s61, 27648, s61
    s_lshl_b32 s62, s91, 3
    s_mul_i32 s63, s91, 1728
    s_add_u32 s76, s30, 524288
    s_addc_u32 s77, s31, 0
    s_mov_b32 s78, 32768
    s_mov_b32 s79, 0x20000
    s_lshr_b32 s3, s2, 3
    s_sub_u32 s3, s3, 28
    s_mul_i32 s56, s34, 13696
    s_add_u32 s40, s30, 1048576
    s_addc_u32 s41, s31, 0
    s_add_u32 s40, s40, s56
    s_addc_u32 s41, s41, 0
    s_mov_b32 s42, 13696
    s_mov_b32 s43, 0x20000
    s_mul_i32 s56, s34, 13824
    s_add_u32 s44, s30, 5242880
    s_addc_u32 s45, s31, 0
    s_add_u32 s44, s44, s56
    s_addc_u32 s45, s45, 0
    s_mov_b32 s46, 13824
    s_mov_b32 s47, 0x20000
    s_mov_b32 s48, s20
    s_mov_b32 s49, s21
    s_mov_b32 s50, 1314824
    s_mov_b32 s51, 0x20000
    s_mov_b32 s52, s22
    s_mov_b32 s53, s23
    s_mov_b32 s54, 1314824
    s_mov_b32 s55, 0x20000
    s_mul_i32 s56, s88, 24
    s_sub_u32 s57, 1984, s85
    s_cmp_eq_u32 s86, 1
    s_cselect_b32 s57, s57, s85
    s_movk_i32 s58, 5136
    s_cselect_b32 s58, -5136, s58
    s_cselect_b32 s98, 41088, 0
    s_cselect_b32 s99, 0, 41088
    s_cselect_b32 s97, 0x80008000, 0
    s_mul_i32 s57, s57, 642
    s_add_u32 s56, s56, s57
    s_mul_i32 s57, s33, s58
    s_lshl_b32 s57, s57, 4
    s_add_u32 s59, s56, s57
    s_and_b32 s59, s59, -4
    v_mov_b32 v147, s32
    v_mov_b32 v151, s32
    v_mov_b32 v155, s32
    v_mov_b32 v159, s32
    s_movk_i32 s80, 4096
    s_movk_i32 s81, 8192
    s_movk_i32 s82, 12288
    v_and_b32 v18, 7, v0
    v_lshrrev_b32 v143, 3, v0
    v_mul_u32_u24 v18, 1344, v18
    v_mul_u32_u24 v143, 12, v143
    v_add_u32 v142, v18, v143
    s_setprio 0
    s_add_u32 s64, s94, TabP-Lbase
    s_addc_u32 s65, s95, 0
    s_mul_i32 s66, s85, 14336
    s_add_u32 s64, s64, s66
    s_addc_u32 s65, s65, 0
    s_lshl_b32 s66, s33, 10
    s_add_u32 m0, s66, 56704
    global_load_lds_dwordx4 v4, s[64:65]
    s_add_u32 s64, s64, 4096
    s_addc_u32 s65, s65, 0
    s_add_u32 m0, m0, 4096
    global_load_lds_dwordx4 v4, s[64:65]
    s_add_u32 s64, s64, 4096
    s_addc_u32 s65, s65, 0
    s_add_u32 m0, m0, 4096
    global_load_lds_dwordx4 v4, s[64:65]
    s_add_u32 s64, s64, 4096
    s_addc_u32 s65, s65, 0
    s_add_u32 m0, m0, 4096
    global_load_lds_dwordx4 v4, s[64:65]
    s_mov_b32 m0, s90
    s_waitcnt vmcnt(5) lgkmcnt(0)
    s_barrier
    s_setprio 3
    ds_read_b64_tr_b16 v[176:177], v19 offset:0
    ds_read_b64_tr_b16 v[178:179], v19 offset:5376
    ds_read_b64_tr_b16 v[180:181], v19 offset:320
    ds_read_b64_tr_b16 v[182:183], v19 offset:5696
    ds_read_b64_tr_b16 v[184:185], v19 offset:640
    ds_read_b64_tr_b16 v[186:187], v19 offset:6016
    ds_read_b64_tr_b16 v[188:189], v19 offset:960
    ds_read_b64_tr_b16 v[190:191], v19 offset:6336
    ds_read_b64_tr_b16 v[192:193], v19 offset:32
    ds_read_b64_tr_b16 v[194:195], v19 offset:5408
    ds_read_b64_tr_b16 v[196:197], v19 offset:352
    ds_read_b64_tr_b16 v[198:199], v19 offset:5728
    s_waitcnt lgkmcnt(10)
    v_mfma_f32_16x16x32_bf16 v[204:207], v[176:179], v[44:47], 0
    ds_read_b64_tr_b16 v[200:201], v19 offset:672
    ds_read_b64_tr_b16 v[202:203], v19 offset:6048
    v_and_b32 v18, 127, v0
    v_mfma_f32_16x16x32_bf16 v[216:219], v[176:179], v[60:63], 0
    v_min_u32 v18, 107, v18
    v_lshlrev_b32 v136, 4, v18
    s_waitcnt lgkmcnt(10)
    v_mfma_f32_16x16x32_bf16 v[204:207], v[180:183], v[48:51], v[204:207]
    ds_read_b64_tr_b16 v[176:177], v19 offset:992
    ds_read_b64_tr_b16 v[178:179], v19 offset:6368
    v_mul_i32_i24 v18, s60, v18
    v_mfma_f32_16x16x32_bf16 v[216:219], v[180:183], v[64:67], v[216:219]
    v_add_u32 v137, s63, v136
    v_add_u32 v138, s61, v18
    s_waitcnt lgkmcnt(10)
    v_mfma_f32_16x16x32_bf16 v[204:207], v[184:187], v[52:55], v[204:207]
    ds_read_b64_tr_b16 v[180:181], v19 offset:64
    ds_read_b64_tr_b16 v[182:183], v19 offset:5440
    v_add_u32 v139, s62, v138
    v_mfma_f32_16x16x32_bf16 v[216:219], v[184:187], v[68:71], v[216:219]
    v_sub_u32 v141, 57880, v138
    v_subrev_u32 v140, s62, v138
    s_waitcnt lgkmcnt(10)
    v_mfma_f32_16x16x32_bf16 v[204:207], v[188:191], v[56:59], v[204:207]
    ds_read_b64_tr_b16 v[184:185], v19 offset:384
    ds_read_b64_tr_b16 v[186:187], v19 offset:5760
    v_lshrrev_b32 v18, 1, v2
    v_mfma_f32_16x16x32_bf16 v[216:219], v[188:191], v[72:75], v[216:219]
    v_and_b32 v143, 1, v2
    v_lshl_add_u32 v18, v3, 6, v18
    s_waitcnt lgkmcnt(10)
    v_mfma_f32_16x16x32_bf16 v[208:211], v[192:195], v[44:47], 0
    ds_read_b64_tr_b16 v[188:189], v19 offset:704
    ds_read_b64_tr_b16 v[190:191], v19 offset:6080
    v_mul_u32_u24 v143, 12, v143
    v_mfma_f32_16x16x32_bf16 v[220:223], v[192:195], v[60:63], 0
    v_mul_i32_i24 v18, s58, v18
    v_add3_u32 v17, v18, v143, s59
    s_waitcnt lgkmcnt(10)
    v_mfma_f32_16x16x32_bf16 v[208:211], v[196:199], v[48:51], v[208:211]
    ds_read_b64_tr_b16 v[192:193], v19 offset:1024
    ds_read_b64_tr_b16 v[194:195], v19 offset:6400
    v_mfma_f32_16x16x32_bf16 v[220:223], v[196:199], v[64:67], v[220:223]
    s_waitcnt lgkmcnt(10)
    v_mfma_f32_16x16x32_bf16 v[208:211], v[200:203], v[52:55], v[208:211]
    v_mfma_f32_16x16x32_bf16 v[220:223], v[200:203], v[68:71], v[220:223]
    s_waitcnt lgkmcnt(8)
    v_mfma_f32_16x16x32_bf16 v[208:211], v[176:179], v[56:59], v[208:211]
    v_mul_f32 v7, v204, v20
    v_mul_f32 v9, v205, v21
    v_mfma_f32_16x16x32_bf16 v[220:223], v[176:179], v[72:75], v[220:223]
    v_mul_f32 v11, v206, v22
    v_mul_f32 v13, v207, v23
    s_waitcnt lgkmcnt(6)
    v_mfma_f32_16x16x32_bf16 v[212:215], v[180:183], v[44:47], 0
    v_mul_f32 v8, v216, v20
    v_mul_f32 v10, v217, v21
    v_mfma_f32_16x16x32_bf16 v[224:227], v[180:183], v[60:63], 0
    v_mul_f32 v12, v218, v22
    v_mul_f32 v14, v219, v23
    buffer_load_dwordx4 v[160:163], v17, s[48:51], s98 offen
    s_waitcnt lgkmcnt(4)
    v_mfma_f32_16x16x32_bf16 v[212:215], v[184:187], v[48:51], v[212:215]
    v_fmac_f32 v7, v216, v32
    v_fmac_f32 v9, v217, v33
    v_mfma_f32_16x16x32_bf16 v[224:227], v[184:187], v[64:67], v[224:227]
    v_fmac_f32 v11, v218, v34
    v_fmac_f32 v13, v219, v35
    buffer_load_dwordx4 v[164:167], v17, s[52:55], s98 offen
    s_waitcnt lgkmcnt(2)
    v_mfma_f32_16x16x32_bf16 v[212:215], v[188:191], v[52:55], v[212:215]
    v_fma_f32 v8, -v204, v32, v8
    v_fma_f32 v10, -v205, v33, v10
    v_mfma_f32_16x16x32_bf16 v[224:227], v[188:191], v[68:71], v[224:227]
    v_fma_f32 v12, -v206, v34, v12
    v_fma_f32 v14, -v207, v35, v14
    s_waitcnt lgkmcnt(0)
    v_mfma_f32_16x16x32_bf16 v[212:215], v[192:195], v[56:59], v[212:215]
    v_cvt_pk_bf16_f32 v228, v7, v8
    v_cvt_pk_bf16_f32 v229, v9, v10
    v_mfma_f32_16x16x32_bf16 v[224:227], v[192:195], v[72:75], v[224:227]
    v_cvt_pk_bf16_f32 v230, v11, v12
    v_cvt_pk_bf16_f32 v231, v13, v14
    s_nop 1
    v_mfma_f32_16x16x32_bf16 v[176:179], v[76:79], v[228:231], 0
    v_mul_f32 v7, v208, v24
    v_mul_f32 v9, v209, v25
    v_mul_f32 v11, v210, v26
    v_mul_f32 v13, v211, v27
    v_mfma_f32_16x16x32_bf16 v[180:183], v[88:91], v[228:231], 0
    v_mul_f32 v8, v220, v24
    v_mul_f32 v10, v221, v25
    v_mul_f32 v12, v222, v26
    v_mul_f32 v14, v223, v27
    v_mfma_f32_16x16x32_bf16 v[184:187], v[100:103], v[228:231], 0
    v_fmac_f32 v7, v220, v36
    v_fmac_f32 v9, v221, v37
    v_fmac_f32 v11, v222, v38
    v_fmac_f32 v13, v223, v39
    v_mfma_f32_16x16x32_bf16 v[188:191], v[112:115], v[228:231], 0
    v_fma_f32 v8, -v208, v36, v8
    v_fma_f32 v10, -v209, v37, v10
    v_fma_f32 v12, -v210, v38, v12
    v_fma_f32 v14, -v211, v39, v14
    v_mfma_f32_16x16x32_bf16 v[192:195], v[124:127], v[228:231], 0
    v_cvt_pk_bf16_f32 v232, v7, v8
    v_cvt_pk_bf16_f32 v233, v9, v10
    v_cvt_pk_bf16_f32 v234, v11, v12
    v_cvt_pk_bf16_f32 v235, v13, v14
    v_mul_f32 v7, v212, v28
    v_mul_f32 v9, v213, v29
    v_mul_f32 v11, v214, v30
    v_mul_f32 v13, v215, v31
    v_mfma_f32_16x16x32_bf16 v[176:179], v[80:83], v[232:235], v[176:179]
    v_mul_f32 v8, v224, v28
    v_mul_f32 v10, v225, v29
    v_mul_f32 v12, v226, v30
    v_mul_f32 v14, v227, v31
    v_mfma_f32_16x16x32_bf16 v[180:183], v[92:95], v[232:235], v[180:183]
    v_fmac_f32 v7, v224, v40
    v_fmac_f32 v9, v225, v41
    v_fmac_f32 v11, v226, v42
    v_fmac_f32 v13, v227, v43
    v_mfma_f32_16x16x32_bf16 v[184:187], v[104:107], v[232:235], v[184:187]
    v_fma_f32 v8, -v212, v40, v8
    v_fma_f32 v10, -v213, v41, v10
    v_fma_f32 v12, -v214, v42, v12
    v_fma_f32 v14, -v215, v43, v14
    v_mfma_f32_16x16x32_bf16 v[188:191], v[116:119], v[232:235], v[188:191]
    v_cvt_pk_bf16_f32 v236, v7, v8
    v_cvt_pk_bf16_f32 v237, v9, v10
    v_cvt_pk_bf16_f32 v238, v11, v12
    v_cvt_pk_bf16_f32 v239, v13, v14
    v_mfma_f32_16x16x32_bf16 v[192:195], v[128:131], v[232:235], v[192:195]
    s_nop 0
    v_mfma_f32_16x16x32_bf16 v[176:179], v[84:87], v[236:239], v[176:179]
    v_mfma_f32_16x16x32_bf16 v[180:183], v[96:99], v[236:239], v[180:183]
    v_mfma_f32_16x16x32_bf16 v[184:187], v[108:111], v[236:239], v[184:187]
    v_mfma_f32_16x16x32_bf16 v[188:191], v[120:123], v[236:239], v[188:191]
    v_mfma_f32_16x16x32_bf16 v[192:195], v[132:135], v[236:239], v[192:195]
    s_nop 3
    v_cvt_pk_bf16_f32 v7, v176, v177
    v_cvt_pk_bf16_f32 v8, v178, v179
    v_cvt_pk_bf16_f32 v9, v180, v181
    v_cvt_pk_bf16_f32 v10, v182, v183
    v_cvt_pk_bf16_f32 v11, v184, v185
    v_cvt_pk_bf16_f32 v12, v186, v187
    v_cvt_pk_bf16_f32 v13, v188, v189
    v_cvt_pk_bf16_f32 v14, v190, v191
    v_cvt_pk_bf16_f32 v15, v192, v193
    v_cvt_pk_bf16_f32 v16, v194, v195
    ds_write_addtid_b32 v7 offset:0
    ds_write_addtid_b32 v8 offset:256
    ds_write_addtid_b32 v9 offset:512
    ds_write_addtid_b32 v10 offset:768
    ds_write_addtid_b32 v11 offset:1024
    ds_write_addtid_b32 v12 offset:1312
    ds_write_addtid_b32 v13 offset:1568
    ds_write_addtid_b32 v14 offset:1824
    ds_write_addtid_b32 v15 offset:2080
    ds_write_addtid_b32 v16 offset:2336
    s_mov_b64 exec, 1
    ds_write_addtid_b32 v7 offset:2592
    ds_write_addtid_b32 v12 offset:1280
    s_mov_b64 exec, -1
    v_mov_b32 v47, s32
    v_mov_b32 v51, s32
    v_mov_b32 v55, s32
    v_mov_b32 v59, s32
    s_waitcnt lgkmcnt(0)
    s_barrier
    ds_read2_b32 v[204:205], v138 offset0:0 offset1:1
    ds_read2_b32 v[208:209], v141 offset0:2 offset1:1
    ds_read_b32 v206, v138 offset:8
    ds_read_b32 v210, v141
    ds_read_b32 v44, v139 offset:2816
    ds_read_b32 v45, v138 offset:2820
    ds_read_b32 v46, v140 offset:2824
    ds_read_b32 v48, v139 offset:5632
    ds_read_b32 v49, v138 offset:5636
    ds_read_b32 v50, v140 offset:5640
    ds_read_b32 v52, v139 offset:8448
    ds_read_b32 v53, v138 offset:8452
    ds_read_b32 v54, v140 offset:8456
    s_movk_i32 s56, 6912
    s_movk_i32 s57, 10368
    s_cmp_eq_u32 s91, 0
    s_waitcnt lgkmcnt(9)
    v_perm_b32 v7, v204, v204, s100
    v_perm_b32 v8, v208, v208, s100
    v_perm_b32 v9, v204, v204, s101
    v_perm_b32 v10, v208, v208, s101
    v_add_f32 v7, v7, v8
    v_sub_f32 v9, v9, v10
    v_cvt_pk_bf16_f32 v56, v7, v9
    s_waitcnt lgkmcnt(6)
    buffer_store_dwordx4 v[44:47], v137, s[44:47], 0 offen sc1
    v_perm_b32 v7, v205, v205, s100
    v_perm_b32 v8, v209, v209, s100
    v_perm_b32 v9, v205, v205, s101
    v_perm_b32 v10, v209, v209, s101
    v_add_f32 v7, v7, v8
    v_sub_f32 v9, v9, v10
    v_cvt_pk_bf16_f32 v57, v7, v9
    s_waitcnt lgkmcnt(3)
    buffer_store_dwordx4 v[48:51], v137, s[44:47], 0 offen offset:3456 sc1
    v_perm_b32 v7, v206, v206, s100
    v_perm_b32 v8, v210, v210, s100
    v_perm_b32 v9, v206, v206, s101
    v_perm_b32 v10, v210, v210, s101
    v_add_f32 v7, v7, v8
    v_sub_f32 v9, v9, v10
    v_cvt_pk_bf16_f32 v58, v7, v9
    s_waitcnt lgkmcnt(0)
    buffer_store_dwordx4 v[52:55], v137, s[44:47], s56 offen sc1
    s_cbranch_scc1 LB_nosw
    v_swap_b32 v56, v58
LB_nosw:
    buffer_store_dwordx4 v[56:59], v137, s[44:47], s57 offen sc1
    s_cmp_lg_u32 s33, 0
    s_cbranch_scc1 Lfw2
    s_and_b32 s35, s2, 7
    s_lshl_b32 s66, s35, 5
    s_add_u32 s66, s66, s3
    s_lshl_b32 s66, s66, 2
    v_mov_b32 v15, 4096
    v_mov_b32 v16, s32
    buffer_store_dword v16, v15, s[76:79], s66 offen
    s_lshl_b32 s35, s3, 2
    s_add_u32 s35, s35, s33
    s_cmp_lg_u32 s35, 104
    s_cbranch_scc1 Lfw2
    s_and_b32 s35, s2, 7
    s_lshl_b32 s35, s35, 4
    s_add_u32 s35, s35, 20480
    v_mov_b32 v16, s32
    v_and_b32 v15, 7, v0
    v_lshlrev_b32 v15, 7, v15
    buffer_store_dword v16, v15, s[76:79], s35 offen sc1
Lfw2:
    ds_read2_b32 v[144:145], v142 offset0:0 offset1:1
    ds_read_b32 v146, v142 offset:8
    ds_read2_b32 v[148:149], v142 offset0:96 offset1:97
    ds_read_b32 v150, v142 offset:392
    ds_read2_b32 v[152:153], v142 offset0:192 offset1:193
    ds_read_b32 v154, v142 offset:776
    ds_read_b32 v156, v142 offset:1152
    ds_read_b32 v157, v142 offset:1156
    ds_read_b32 v158, v142 offset:1160
    s_waitcnt lgkmcnt(7)
    buffer_store_dwordx4 v[144:147], v4, s[40:43], 0 offen sc1
    s_waitcnt lgkmcnt(5)
    buffer_store_dwordx4 v[148:151], v4, s[40:43], s80 offen sc1
    s_waitcnt lgkmcnt(3)
    buffer_store_dwordx4 v[152:155], v4, s[40:43], s81 offen sc1
    s_waitcnt lgkmcnt(0)
    buffer_store_dwordx4 v[156:159], v4, s[40:43], s82 offen sc1
    s_cmp_lg_u32 s33, 0
    s_cbranch_scc1 Lfw3
    s_and_b32 s35, s2, 7
    s_lshl_b32 s66, s35, 5
    s_add_u32 s66, s66, s3
    s_lshl_b32 s66, s66, 2
    v_mov_b32 v15, 0
    v_mov_b32 v16, s32
    buffer_store_dword v16, v15, s[76:79], s66 offen
    s_lshl_b32 s35, s3, 2
    s_add_u32 s35, s35, s33
    s_cmp_lg_u32 s35, 104
    s_cbranch_scc1 Lfw3
    s_and_b32 s35, s2, 7
    s_lshl_b32 s35, s35, 4
    s_add_u32 s35, s35, 16384
    v_mov_b32 v16, s32
    v_and_b32 v15, 7, v0
    v_lshlrev_b32 v15, 7, v15
    buffer_store_dword v16, v15, s[76:79], s35 offen sc1
Lfw3:
    s_waitcnt vmcnt(12)
    s_barrier
    s_setprio 0
    s_mul_i32 s56, s33, 320
    v_lshl_add_u32 v7, v3, 4, s56
    global_load_dwordx4 v[64:67], v7, s[24:25] offset:0
    global_load_dwordx4 v[68:71], v7, s[24:25] offset:64
    global_load_dwordx4 v[72:75], v7, s[24:25] offset:128
    global_load_dwordx4 v[144:147], v7, s[24:25] offset:192
    global_load_dwordx4 v[148:151], v7, s[24:25] offset:256
    buffer_load_dwordx4 v[168:171], v17, s[48:51], s99 offen
    buffer_load_dwordx4 v[172:175], v17, s[52:55], s99 offen
    s_setprio 3
    v_add_u32 v15, 56704, v5
    ds_read_b128 v[152:155], v15 offset:0
    ds_read_b128 v[156:159], v15 offset:1024
    ds_read_b128 v[176:179], v15 offset:2048
    ds_read_b128 v[180:183], v15 offset:3072
    ds_read_b128 v[184:187], v15 offset:4096
    ds_read_b128 v[188:191], v15 offset:5120
    ds_read_b128 v[192:195], v15 offset:6144
    ds_read_b128 v[196:199], v15 offset:7168
    ds_read_b128 v[200:203], v15 offset:8192
    ds_read_b128 v[204:207], v15 offset:9216
    ds_read_b128 v[208:211], v15 offset:10240
    ds_read_b128 v[212:215], v15 offset:11264
    ds_read_b128 v[216:219], v15 offset:12288
    ds_read_b128 v[220:223], v15 offset:13312
    s_mul_i32 s62, s83, 27
    s_add_u32 s62, s62, s88
    s_lshl_b32 s58, s62, 6
    s_mul_i32 s56, s33, 884736
    s_add_u32 s58, s58, s56
    v_lshrrev_b32 v7, 2, v1
    v_and_b32 v9, 3, v0
    v_mul_u32_u24 v10, 13824, v7
    v_lshl_add_u32 v18, v9, 4, v10
    v_mul_u32_u24 v9, 776, v9
    s_lshl_b32 s56, s33, 6
    s_add_u32 s56, s56, 40192
    v_add_u32 v9, v9, v7
    v_lshl_add_u32 v141, v9, 2, s56
    v_mul_u32_u24 v9, 770, v3
    s_lshl_b32 s56, s33, 2
    s_add_u32 s56, s56, 27648
    v_lshl_add_u32 v9, v2, 2, v9
    v_lshl_add_u32 v19, v9, 2, s56
    v_and_b32 v7, 7, v2
    v_lshrrev_b32 v8, 3, v2
    v_lshlrev_b32 v7, 1, v7
    v_mul_u32_u24 v8, 2049, v8
    v_lshl_add_u32 v7, v3, 4, v7
    s_and_b32 s56, s33, 1
    s_mul_i32 s56, s56, 3
    s_and_b32 s57, s85, 1
    s_add_u32 s56, s56, s57
    s_lshr_b32 s57, s56, 1
    s_and_b32 s56, s56, 1
    s_lshl_b32 s57, s57, 8
    s_add_u32 s57, s57, s91
    s_lshl_b32 s57, s57, 2
    s_add_u32 s57, s57, 40192
    v_add_u32 v7, v7, v8
    v_lshl_add_u32 v142, v7, 2, s57
    v_mov_b32 v16, s97
    s_add_u32 s59, s58, 221184
    s_add_u32 s60, s58, 442368
    s_add_u32 s61, s58, 663552
    s_lshl_b32 s57, s33, 8
    s_add_u32 m0, s57, 40192
    s_cmp_eq_u32 s56, 0
    s_mov_b32 s64, 0x01000c0c
    s_mov_b32 s65, 0x03020c0c
    s_mov_b32 s66, 0x05040c0c
    s_mov_b32 s67, 0x07060c0c
    s_cselect_b32 s80, s64, s65
    s_cselect_b32 s81, s65, s66
    s_cselect_b32 s82, s66, s67
    s_add_u32 s40, s30, 5242880
    s_addc_u32 s41, s31, 0
    s_mov_b32 s42, 3538944
    s_mov_b32 s43, 0x20000
    s_add_u32 s36, s30, 5242880
    s_addc_u32 s37, s31, 0
    s_mov_b32 s38, 0
    s_mov_b32 s39, 0x20000
    s_mov_b32 s38, s96
    s_mul_i32 s56, s33, 320
    v_lshlrev_b32 v7, 4, v3
    v_and_b32 v8, 7, v2
    s_lshl_b32 s57, s33, 2
    v_lshl_add_u32 v17, v8, 4, s57
    v_mul_u32_u24 v8, 1344, v8
    v_add3_u32 v8, v8, v7, s56
    s_waitcnt lgkmcnt(4)
    ds_read_b128 v[44:47], v8 offset:0
    ds_read_b128 v[48:51], v8 offset:64
    ds_read_b128 v[52:55], v8 offset:128
    ds_read_b128 v[56:59], v8 offset:192
    ds_read_b128 v[60:63], v8 offset:256
    s_waitcnt lgkmcnt(0) vmcnt(2)
    v_mfma_f32_16x16x32_bf16 v[240:243], v[64:67], v[44:47], 0
    v_mfma_f32_16x16x32_bf16 v[240:243], v[68:71], v[48:51], v[240:243]
    v_mfma_f32_16x16x32_bf16 v[240:243], v[72:75], v[52:55], v[240:243]
    v_mfma_f32_16x16x32_bf16 v[240:243], v[144:147], v[56:59], v[240:243]
    v_mfma_f32_16x16x32_bf16 v[240:243], v[148:151], v[60:63], v[240:243]
    s_waitcnt vmcnt(0)
    s_and_b32 s35, s2, 7
    s_lshl_b32 s35, s35, 7
    v_min_u32 v14, 31, v1
    v_and_b32 v13, 7, v1
    v_lshlrev_b32 v14, 2, v14
    v_lshlrev_b32 v13, 4, v13
    v_add_u32 v13, 16384, v13
    s_mov_b32 exec_lo, 0
    v_mov_b32 v14, v13
    s_mov_b32 exec_lo, -1
    v_add_u32 v14, s35, v14
    s_movk_i32 s66, 4096
    s_mov_b32 s35, 0
Lq4:
    buffer_load_dword v224, v14, s[76:79], s66 offen sc1
    s_waitcnt vmcnt(0)
    v_cmp_ne_u32 vcc, s32, v224
    s_nop 0
    s_cbranch_vccz Lqd4
    s_add_u32 s35, s35, 1
    s_sleep 1
    s_cmp_lt_u32 s35, 24
    s_cbranch_scc1 Lq4
Lqd4:
    s_cmp_eq_u32 s35, 0
    s_cbranch_scc1 Lqe4
    s_sleep 2
Lqe4:
    s_setprio 0
    buffer_load_dwordx4 v[224:227], v18, s[40:43], s58 offen sc1
    buffer_load_dwordx4 v[228:231], v18, s[40:43], s59 offen sc1
    buffer_load_dwordx4 v[232:235], v18, s[40:43], s60 offen sc1
    buffer_load_dwordx4 v[236:239], v18, s[40:43], s61 offen sc1
    s_setprio 3
    v_xor_b32 v164, v16, v164
    v_xor_b32 v165, v16, v165
    v_xor_b32 v166, v16, v166
    v_xor_b32 v167, v16, v167
    v_xor_b32 v172, v16, v172
    v_xor_b32 v173, v16, v173
    v_xor_b32 v174, v16, v174
    v_xor_b32 v175, v16, v175
    ds_write_addtid_b32 v160 offset:0
    ds_write_addtid_b32 v161 offset:1024
    ds_write_addtid_b32 v162 offset:2048
    ds_write_addtid_b32 v163 offset:3072
    ds_write_addtid_b32 v164 offset:4096
    ds_write_addtid_b32 v165 offset:5120
    ds_write_addtid_b32 v166 offset:6144
    ds_write_addtid_b32 v167 offset:7168
    ds_write_addtid_b32 v168 offset:8196
    ds_write_addtid_b32 v169 offset:9220
    ds_write_addtid_b32 v170 offset:10244
    ds_write_addtid_b32 v171 offset:11268
    ds_write_addtid_b32 v172 offset:12292
    ds_write_addtid_b32 v173 offset:13316
    ds_write_addtid_b32 v174 offset:14340
    ds_write_addtid_b32 v175 offset:15364
    ds_write_b32 v17, v240 offset:11264
    s_mul_i32 s56, s33, 3080
    s_add_u32 m0, s56, 27648
    s_waitcnt lgkmcnt(0) vmcnt(4)
    s_barrier
    ds_read2st64_b32 v[160:161], v142 offset0:0 offset1:1
    ds_read2st64_b32 v[162:163], v142 offset0:2 offset1:3
    ds_read2st64_b32 v[164:165], v142 offset0:4 offset1:5
    ds_read2st64_b32 v[166:167], v142 offset0:6 offset1:7
    ds_read2st64_b32 v[168:169], v142 offset0:16 offset1:17
    ds_read2st64_b32 v[170:171], v142 offset0:18 offset1:19
    ds_read2st64_b32 v[172:173], v142 offset0:20 offset1:21
    ds_read2st64_b32 v[174:175], v142 offset0:22 offset1:23
    v_and_b32 v7, 3, v2
    v_lshlrev_b32 v8, 4, v7
    ds_read_b128 v[68:71], v8 offset:11264
    ds_read_b128 v[72:75], v8 offset:11328
    s_waitcnt lgkmcnt(6)
    v_perm_b32 v44, v164, v160, s80
    v_perm_b32 v45, v165, v161, s80
    v_perm_b32 v46, v166, v162, s80
    v_perm_b32 v47, v167, v163, s80
    v_perm_b32 v48, v164, v160, s81
    v_perm_b32 v49, v165, v161, s81
    v_perm_b32 v50, v166, v162, s81
    v_perm_b32 v51, v167, v163, s81
    v_perm_b32 v52, v164, v160, s82
    v_perm_b32 v53, v165, v161, s82
    v_perm_b32 v54, v166, v162, s82
    v_perm_b32 v55, v167, v163, s82
    s_waitcnt lgkmcnt(2)
    v_perm_b32 v56, v172, v168, s80
    v_perm_b32 v57, v173, v169, s80
    v_perm_b32 v58, v174, v170, s80
    v_perm_b32 v59, v175, v171, s80
    v_perm_b32 v60, v172, v168, s81
    v_perm_b32 v61, v173, v169, s81
    v_perm_b32 v62, v174, v170, s81
    v_perm_b32 v63, v175, v171, s81
    v_perm_b32 v64, v172, v168, s82
    v_perm_b32 v65, v173, v169, s82
    v_perm_b32 v66, v174, v170, s82
    v_perm_b32 v67, v175, v171, s82
    s_waitcnt lgkmcnt(0)
    v_add_f32 v68, v68, v69
    v_add_f32 v70, v70, v71
    v_add_f32 v72, v72, v73
    v_add_f32 v74, v74, v75
    v_add_f32 v68, v68, v70
    v_add_f32 v72, v72, v74
    v_cvt_pk_bf16_f32 v9, v68, v72
    v_lshlrev_b32 v10, 16, v9
    v_and_b32 v11, v6, v9
    v_mul_f32 v10, 0xbfb8aa3b, v10
    v_mul_f32 v11, 0xbfb8aa3b, v11
    v_exp_f32 v10, v10
    v_exp_f32 v11, v11
    v_add_f32 v10, 1.0, v10
    v_add_f32 v11, 1.0, v11
    v_rcp_f32 v10, v10
    v_rcp_f32 v11, v11
    s_nop 0
    v_cvt_pk_bf16_f32 v9, v10, v11
    v_lshlrev_b32 v17, 16, v9
    v_and_b32 v143, v6, v9
    v_sub_f32 v10, 1.0, v17
    v_sub_f32 v11, 1.0, v143
    v_cvt_pk_bf16_f32 v9, v10, v11
    v_lshlrev_b32 v10, 16, v9
    v_and_b32 v11, v6, v9
    v_mul_f32 v68, v184, v10
    v_mul_f32 v69, v185, v10
    v_mul_f32 v70, v186, v10
    v_mul_f32 v71, v187, v10
    v_mul_f32 v72, v188, v10
    v_mul_f32 v73, v189, v10
    v_mul_f32 v74, v190, v10
    v_mul_f32 v75, v191, v10
    v_cvt_pk_bf16_f32 v144, v68, v69
    v_cvt_pk_bf16_f32 v145, v70, v71
    v_cvt_pk_bf16_f32 v146, v72, v73
    v_cvt_pk_bf16_f32 v147, v74, v75
    v_mul_f32 v68, v184, v11
    v_mul_f32 v69, v185, v11
    v_mul_f32 v70, v186, v11
    v_mul_f32 v71, v187, v11
    v_mul_f32 v72, v188, v11
    v_mul_f32 v73, v189, v11
    v_mul_f32 v74, v190, v11
    v_mul_f32 v75, v191, v11
    v_cvt_pk_bf16_f32 v148, v68, v69
    v_cvt_pk_bf16_f32 v149, -v70, -v71
    v_cvt_pk_bf16_f32 v150, v72, v73
    v_cvt_pk_bf16_f32 v151, -v74, -v75
    s_lshl_b32 s57, s88, 2
    s_add_u32 s57, s57, s33
    s_cmp_lg_u32 s57, 0
    s_cbranch_scc1 LB_sp1
    v_mul_f32 v44, 0.5, v44
    v_mul_f32 v56, 0.5, v56
    v_mul_f32 v45, 0.5, v45
    v_mul_f32 v57, 0.5, v57
    v_mul_f32 v46, 0.5, v46
    v_mul_f32 v58, 0.5, v58
    v_mul_f32 v47, 0.5, v47
    v_mul_f32 v59, 0.5, v59
LB_sp1:
    s_cmp_lg_u32 s57, 106
    s_cbranch_scc1 LB_sp2
    v_mul_f32 v52, 0.5, v52
    v_mul_f32 v64, 0.5, v64
    v_mul_f32 v53, 0.5, v53
    v_mul_f32 v65, 0.5, v65
    v_mul_f32 v54, 0.5, v54
    v_mul_f32 v66, 0.5, v66
    v_mul_f32 v55, 0.5, v55
    v_mul_f32 v67, 0.5, v67
LB_sp2:
    s_mov_b32 s35, 0
    s_branch Lpc5
Lp5:
    buffer_load_dwordx4 v[224:227], v18, s[40:43], s58 offen sc1
    buffer_load_dwordx4 v[228:231], v18, s[40:43], s59 offen sc1
    buffer_load_dwordx4 v[232:235], v18, s[40:43], s60 offen sc1
    buffer_load_dwordx4 v[236:239], v18, s[40:43], s61 offen sc1
Lpc5:
    s_waitcnt vmcnt(0)
    v_or_b32 v227, 1, v227
    v_or_b32 v231, 1, v231
    v_or_b32 v235, 1, v235
    v_or_b32 v239, 1, v239
    v_cmp_ne_u32 s[64:65], s89, v227
    v_cmp_ne_u32 s[66:67], s89, v231
    v_cmp_ne_u32 s[68:69], s89, v235
    v_cmp_ne_u32 s[70:71], s89, v239
    s_or_b64 s[64:65], s[64:65], s[66:67]
    s_or_b64 s[68:69], s[68:69], s[70:71]
    s_or_b64 s[64:65], s[64:65], s[68:69]
    s_and_b64 exec, exec, s[64:65]
    s_cbranch_execz Lpd5
    s_add_u32 s35, s35, 1
    s_sleep 8
    s_cmp_lt_u32 s35, 300000
    s_cbranch_scc1 Lp5
Lpd5:
    s_mov_b64 exec, -1
    s_setprio 3
    ds_write_addtid_b32 v224 offset:0
    ds_write_addtid_b32 v228 offset:768
    ds_write_addtid_b32 v232 offset:1536
    ds_write_addtid_b32 v236 offset:2304
    ds_write_addtid_b32 v225 offset:256
    ds_write_addtid_b32 v229 offset:1024
    ds_write_addtid_b32 v233 offset:1792
    ds_write_addtid_b32 v237 offset:2560
    ds_write_addtid_b32 v226 offset:512
    ds_write_addtid_b32 v230 offset:1280
    ds_write_addtid_b32 v234 offset:2048
    ds_write_addtid_b32 v238 offset:2816
    s_mul_i32 s56, s33, 3104
    s_add_u32 m0, s56, 40192
    s_waitcnt lgkmcnt(0)
    s_barrier
    ds_read2st64_b32 v[68:69], v19 offset0:0 offset1:3
    ds_read2st64_b32 v[70:71], v19 offset0:6 offset1:9
    ds_read2st64_b32 v[72:73], v19 offset0:1 offset1:4
    ds_read2st64_b32 v[74:75], v19 offset0:7 offset1:10
    ds_read2st64_b32 v[160:161], v19 offset0:2 offset1:5
    ds_read2st64_b32 v[162:163], v19 offset0:8 offset1:11
    v_mov_b32 v227, s89
    v_mov_b32 v231, s89
    v_mov_b32 v235, s89
    v_mov_b32 v239, s89
    s_waitcnt lgkmcnt(4)
    v_mfma_f32_16x16x32_bf16 v[164:167], v[68:71], v[192:195], 0
    v_mfma_f32_16x16x32_bf16 v[184:187], v[68:71], v[196:199], 0
    s_waitcnt lgkmcnt(2)
    v_mfma_f32_16x16x32_bf16 v[168:171], v[72:75], v[192:195], 0
    v_mfma_f32_16x16x32_bf16 v[188:191], v[72:75], v[196:199], 0
    s_waitcnt lgkmcnt(0)
    s_nop 2
    v_mul_f32 v7, v164, v208
    v_mul_f32 v9, v165, v209
    v_mfma_f32_16x16x32_bf16 v[172:175], v[160:163], v[192:195], 0
    v_mul_f32 v11, v166, v210
    v_mul_f32 v13, v167, v211
    v_mul_f32 v8, v184, v208
    v_mfma_f32_16x16x32_bf16 v[240:243], v[160:163], v[196:199], 0
    v_mul_f32 v10, v185, v209
    v_mul_f32 v12, v186, v210
    v_mul_f32 v14, v187, v211
    v_fmac_f32 v7, v184, v212
    v_fmac_f32 v9, v185, v213
    v_fmac_f32 v11, v186, v214
    v_fmac_f32 v13, v187, v215
    v_fma_f32 v8, -v164, v212, v8
    v_fma_f32 v10, -v165, v213, v10
    v_fma_f32 v12, -v166, v214, v12
    v_fma_f32 v14, -v167, v215, v14
    v_cvt_pk_bf16_f32 v68, v7, v8
    v_cvt_pk_bf16_f32 v69, v9, v10
    v_cvt_pk_bf16_f32 v70, v11, v12
    v_cvt_pk_bf16_f32 v71, v13, v14
    v_mul_f32 v7, v168, v208
    v_mul_f32 v9, v169, v209
    v_mfma_f32_16x16x32_bf16 v[164:167], v[152:155], v[68:71], 0
    v_mul_f32 v11, v170, v210
    v_mul_f32 v13, v171, v211
    v_mul_f32 v8, v188, v208
    v_mfma_f32_16x16x32_bf16 v[184:187], v[156:159], v[68:71], 0
    v_mul_f32 v10, v189, v209
    v_mul_f32 v12, v190, v210
    v_mul_f32 v14, v191, v211
    v_fmac_f32 v7, v188, v212
    v_fmac_f32 v9, v189, v213
    v_fmac_f32 v11, v190, v214
    v_fmac_f32 v13, v191, v215
    v_fma_f32 v8, -v168, v212, v8
    v_fma_f32 v10, -v169, v213, v10
    v_fma_f32 v12, -v170, v214, v12
    v_fma_f32 v14, -v171, v215, v14
    v_cvt_pk_bf16_f32 v72, v7, v8
    v_cvt_pk_bf16_f32 v73, v9, v10
    v_cvt_pk_bf16_f32 v74, v11, v12
    v_cvt_pk_bf16_f32 v75, v13, v14
    v_mul_f32 v7, v172, v208
    v_mul_f32 v9, v173, v209
    v_mfma_f32_16x16x32_bf16 v[168:171], v[152:155], v[72:75], 0
    v_mul_f32 v11, v174, v210
    v_mul_f32 v13, v175, v211
    v_mul_f32 v8, v240, v208
    v_mfma_f32_16x16x32_bf16 v[188:191], v[156:159], v[72:75], 0
    v_mul_f32 v10, v241, v209
    v_mul_f32 v12, v242, v210
    v_mul_f32 v14, v243, v211
    v_fmac_f32 v7, v240, v212
    v_fmac_f32 v9, v241, v213
    v_fmac_f32 v11, v242, v214
    v_fmac_f32 v13, v243, v215
    v_fma_f32 v8, -v172, v212, v8
    v_fma_f32 v10, -v173, v213, v10
    v_fma_f32 v12, -v174, v214, v12
    v_fma_f32 v14, -v175, v215, v14
    v_cvt_pk_bf16_f32 v160, v7, v8
    v_cvt_pk_bf16_f32 v161, v9, v10
    v_cvt_pk_bf16_f32 v162, v11, v12
    v_cvt_pk_bf16_f32 v163, v13, v14
    s_lshl_b32 s35, s3, 2
    s_add_u32 s35, s35, s33
    s_cmp_lg_u32 s35, 104
    s_cbranch_scc1 Lfw6
    s_and_b32 s35, s2, 7
    s_lshl_b32 s35, s35, 4
    s_add_u32 s35, s35, 24576
    v_mov_b32 v16, s32
    v_and_b32 v15, 7, v0
    v_lshlrev_b32 v15, 7, v15
    buffer_store_dword v16, v15, s[76:79], s35 offen sc1
Lfw6:
    v_mul_f32 v7, v164, v44
    v_mul_f32 v9, v165, v45
    v_mfma_f32_16x16x32_bf16 v[172:175], v[152:155], v[160:163], 0
    v_mul_f32 v11, v166, v46
    v_mul_f32 v13, v167, v47
    v_mul_f32 v8, v184, v44
    v_mfma_f32_16x16x32_bf16 v[240:243], v[156:159], v[160:163], 0
    v_mul_f32 v10, v185, v45
    v_mul_f32 v12, v186, v46
    v_mul_f32 v14, v187, v47
    v_fma_f32 v7, -v184, v56, v7
    v_fma_f32 v9, -v185, v57, v9
    v_fma_f32 v11, -v186, v58, v11
    v_fma_f32 v13, -v187, v59, v13
    v_fmac_f32 v8, v164, v56
    v_fmac_f32 v10, v165, v57
    v_fmac_f32 v12, v166, v58
    v_fmac_f32 v14, v167, v59
    v_cvt_pk_bf16_f32 v68, v7, v8
    v_cvt_pk_bf16_f32 v69, v9, v10
    v_cvt_pk_bf16_f32 v70, v11, v12
    v_cvt_pk_bf16_f32 v71, v13, v14
    v_mul_f32 v7, v168, v48
    v_mul_f32 v9, v169, v49
    v_mfma_f32_16x16x32_bf16 v[164:167], v[68:71], v[176:179], 0
    v_mul_f32 v11, v170, v50
    v_mul_f32 v13, v171, v51
    v_mul_f32 v8, v188, v48
    v_mfma_f32_16x16x32_bf16 v[184:187], v[68:71], v[180:183], 0
    v_mul_f32 v10, v189, v49
    v_mul_f32 v12, v190, v50
    v_mul_f32 v14, v191, v51
    v_fma_f32 v7, -v188, v60, v7
    v_fma_f32 v9, -v189, v61, v9
    v_fma_f32 v11, -v190, v62, v11
    v_fma_f32 v13, -v191, v63, v13
    v_fmac_f32 v8, v168, v60
    v_fmac_f32 v10, v169, v61
    v_fmac_f32 v12, v170, v62
    v_fmac_f32 v14, v171, v63
    v_cvt_pk_bf16_f32 v72, v7, v8
    v_cvt_pk_bf16_f32 v73, v9, v10
    v_cvt_pk_bf16_f32 v74, v11, v12
    v_cvt_pk_bf16_f32 v75, v13, v14
    v_mul_f32 v7, v172, v52
    v_mul_f32 v9, v173, v53
    v_mfma_f32_16x16x32_bf16 v[168:171], v[72:75], v[176:179], 0
    v_mul_f32 v11, v174, v54
    v_mul_f32 v13, v175, v55
    v_mul_f32 v8, v240, v52
    v_mfma_f32_16x16x32_bf16 v[188:191], v[72:75], v[180:183], 0
    v_mul_f32 v10, v241, v53
    v_mul_f32 v12, v242, v54
    v_mul_f32 v14, v243, v55
    v_fma_f32 v7, -v240, v64, v7
    v_fma_f32 v9, -v241, v65, v9
    v_fma_f32 v11, -v242, v66, v11
    v_fma_f32 v13, -v243, v67, v13
    v_fmac_f32 v8, v172, v64
    v_fmac_f32 v10, v173, v65
    v_fmac_f32 v12, v174, v66
    v_fmac_f32 v14, v175, v67
    v_cvt_pk_bf16_f32 v160, v7, v8
    v_cvt_pk_bf16_f32 v161, v9, v10
    v_cvt_pk_bf16_f32 v162, v11, v12
    v_cvt_pk_bf16_f32 v163, v13, v14
    v_mul_f32 v7, v164, v216
    v_mul_f32 v9, v165, v217
    v_mfma_f32_16x16x32_bf16 v[172:175], v[160:163], v[176:179], 0
    v_mul_f32 v11, v166, v218
    v_mul_f32 v13, v167, v219
    v_mul_f32 v8, v184, v216
    v_mfma_f32_16x16x32_bf16 v[240:243], v[160:163], v[180:183], 0
    v_mul_f32 v10, v185, v217
    v_mul_f32 v12, v186, v218
    v_mul_f32 v14, v187, v219
    v_fma_f32 v7, -v184, v220, v7
    v_fma_f32 v9, -v185, v221, v9
    v_fma_f32 v11, -v186, v222, v11
    v_fma_f32 v13, -v187, v223, v13
    v_fmac_f32 v8, v164, v220
    v_fmac_f32 v10, v165, v221
    v_fmac_f32 v12, v166, v222
    v_fmac_f32 v14, v167, v223
    v_cvt_pk_bf16_f32 v68, v7, v8
    v_cvt_pk_bf16_f32 v69, v9, v10
    v_cvt_pk_bf16_f32 v70, v11, v12
    v_cvt_pk_bf16_f32 v71, v13, v14
    v_mul_f32 v7, v168, v216
    v_mul_f32 v9, v169, v217
    v_mfma_f32_16x16x32_bf16 v[164:167], v[200:203], v[68:71], 0
    v_mul_f32 v11, v170, v218
    v_mul_f32 v13, v171, v219
    v_mul_f32 v8, v188, v216
    v_mfma_f32_16x16x32_bf16 v[184:187], v[204:207], v[68:71], 0
    v_mul_f32 v10, v189, v217
    v_mul_f32 v12, v190, v218
    v_mul_f32 v14, v191, v219
    v_fma_f32 v7, -v188, v220, v7
    v_fma_f32 v9, -v189, v221, v9
    v_fma_f32 v11, -v190, v222, v11
    v_fma_f32 v13, -v191, v223, v13
    v_fmac_f32 v8, v168, v220
    v_fmac_f32 v10, v169, v221
    v_fmac_f32 v12, v170, v222
    v_fmac_f32 v14, v171, v223
    v_cvt_pk_bf16_f32 v72, v7, v8
    v_cvt_pk_bf16_f32 v73, v9, v10
    v_cvt_pk_bf16_f32 v74, v11, v12
    v_cvt_pk_bf16_f32 v75, v13, v14
    v_mul_f32 v7, v172, v216
    v_mul_f32 v9, v173, v217
    v_mfma_f32_16x16x32_bf16 v[168:171], v[200:203], v[72:75], 0
    v_mul_f32 v11, v174, v218
    v_mul_f32 v13, v175, v219
    v_mul_f32 v8, v240, v216
    v_mfma_f32_16x16x32_bf16 v[188:191], v[204:207], v[72:75], 0
    v_mul_f32 v10, v241, v217
    v_mul_f32 v12, v242, v218
    v_mul_f32 v14, v243, v219
    v_fma_f32 v7, -v240, v220, v7
    v_fma_f32 v9, -v241, v221, v9
    v_fma_f32 v11, -v242, v222, v11
    v_fma_f32 v13, -v243, v223, v13
    v_fmac_f32 v8, v172, v220
    v_fmac_f32 v10, v173, v221
    v_fmac_f32 v12, v174, v222
    v_fmac_f32 v14, v175, v223
    v_cvt_pk_bf16_f32 v160, v7, v8
    v_cvt_pk_bf16_f32 v161, v9, v10
    v_cvt_pk_bf16_f32 v162, v11, v12
    v_cvt_pk_bf16_f32 v163, v13, v14
    v_cvt_pk_bf16_f32 v224, v184, v164
    v_cvt_pk_bf16_f32 v225, v185, v165
    v_mfma_f32_16x16x32_bf16 v[172:175], v[200:203], v[160:163], 0
    v_cvt_pk_bf16_f32 v226, v186, v166
    v_cvt_pk_bf16_f32 v15, v187, v167
    v_mfma_f32_16x16x32_bf16 v[240:243], v[204:207], v[160:163], 0
    ds_write_addtid_b32 v224 offset:0
    ds_write_addtid_b32 v225 offset:256
    ds_write_addtid_b32 v226 offset:512
    ds_write_addtid_b32 v15 offset:768
    v_cvt_pk_bf16_f32 v228, v188, v168
    v_cvt_pk_bf16_f32 v229, v189, v169
    v_cvt_pk_bf16_f32 v230, v190, v170
    v_cvt_pk_bf16_f32 v15, v191, v171
    ds_write_addtid_b32 v228 offset:1024
    ds_write_addtid_b32 v229 offset:1280
    ds_write_addtid_b32 v230 offset:1536
    ds_write_addtid_b32 v15 offset:1792
    v_cvt_pk_bf16_f32 v232, v240, v172
    v_cvt_pk_bf16_f32 v233, v241, v173
    v_cvt_pk_bf16_f32 v234, v242, v174
    v_cvt_pk_bf16_f32 v15, v243, v175
    ds_write_addtid_b32 v232 offset:2048
    ds_write_addtid_b32 v233 offset:2304
    ds_write_addtid_b32 v234 offset:2560
    ds_write_addtid_b32 v15 offset:2816
    s_waitcnt lgkmcnt(0)
    s_barrier
    ds_read2st64_b32 v[224:225], v141 offset0:0 offset1:4
    ds_read_b32 v226, v141 offset:2048
    ds_read2st64_b32 v[228:229], v141 offset0:1 offset1:5
    ds_read_b32 v230, v141 offset:2304
    ds_read2st64_b32 v[232:233], v141 offset0:2 offset1:6
    ds_read_b32 v234, v141 offset:2560
    ds_read2st64_b32 v[236:237], v141 offset0:3 offset1:7
    ds_read_b32 v238, v141 offset:2816
    s_waitcnt lgkmcnt(6)
    buffer_store_dwordx4 v[224:227], v18, s[36:39], s58 offen sc1
    s_waitcnt lgkmcnt(4)
    buffer_store_dwordx4 v[228:231], v18, s[36:39], s59 offen sc1
    s_waitcnt lgkmcnt(2)
    buffer_store_dwordx4 v[232:235], v18, s[36:39], s60 offen sc1
    s_waitcnt lgkmcnt(0)
    buffer_store_dwordx4 v[236:239], v18, s[36:39], s61 offen sc1
    s_cmp_lg_u32 s33, 0
    s_cbranch_scc1 Lfw7
    s_and_b32 s35, s2, 7
    s_lshl_b32 s66, s35, 5
    s_add_u32 s66, s66, s3
    s_lshl_b32 s66, s66, 2
    v_mov_b32 v15, 8192
    v_mov_b32 v16, s32
    buffer_store_dword v16, v15, s[76:79], s66 offen
Lfw7:
    s_setprio 0
    v_and_b32 v7, 3, v2
    v_and_b32 v8, 1, v2
    v_mul_u32_u24 v8, 0x0202, v8
    v_lshlrev_b32 v8, 16, v8
    v_add_u32 v18, 0x01000c0c, v8
    v_lshrrev_b32 v8, 2, v2
    v_lshl_add_u32 v8, v8, 2, v3
    s_lshl_b32 s56, s33, 7
    v_lshl_add_u32 v8, v8, 3, s56
    v_mul_u32_u24 v9, 327680, v7
    v_add_u32 v19, v9, v8
    v_lshrrev_b32 v9, 1, v7
    v_mul_u32_u24 v9, 2592, v9
    v_lshl_add_u32 v64, v8, 1, v9
    s_movk_i32 s56, 27648
    v_lshl_add_u32 v65, v0, 2, s56
    v_add_u32 v67, 32, v65
    s_min_u32 s56, s33, 1
    s_lshl_b32 s56, s56, 5
    v_add_u32 v66, s56, v65
    v_lshrrev_b32 v8, 1, v3
    v_mul_u32_u24 v9, 160, v3
    v_lshl_add_u32 v8, v8, 3, v9
    v_add_u32 v9, v8, v2
    v_lshl_add_u32 v68, v9, 2, s90
    v_and_b32 v9, 7, v2
    v_add_u32 v9, v8, v9
    v_lshl_add_u32 v69, v9, 2, s90
    v_add_u32 v7, 768, v0
    v_min_u32 v7, 855, v7
    v_lshlrev_b32 v70, 4, v7
    v_lshrrev_b32 v8, 2, v7
    v_and_b32 v7, 3, v7
    v_mul_u32_u24 v8, 12, v8
    v_mul_u32_u24 v7, 2592, v7
    v_add_u32 v72, v8, v7
    v_lshrrev_b32 v8, 2, v0
    v_and_b32 v9, 3, v0
    v_mul_u32_u24 v8, 12, v8
    v_mul_u32_u24 v9, 2592, v9
    v_add_u32 v71, v8, v9
    s_lshl_b32 s56, s91, 31
    s_xor_b32 s56, s56, 1.0
    v_mov_b32 v73, s56
    s_add_u32 s56, s90, 2592
    s_add_u32 s57, s90, 1280
    v_mov_b32 v74, 11392
    v_mov_b32 v161, 0
    v_mov_b32 v162, 0
    v_mov_b32 v163, 0
    ds_write_b32 v74, v161
    v_writelane_b32 v74, s56, 0
    v_writelane_b32 v74, s57, 32
    s_mov_b32 m0, s90
    s_cmp_lt_u32 s83, 3
    s_cselect_b32 s56, 27, 25
    s_and_b32 s35, s2, 7
    s_lshl_b32 s35, s35, 7
    v_min_u32 v75, 31, v1
    v_and_b32 v7, 7, v1
    v_lshlrev_b32 v75, 2, v75
    v_lshlrev_b32 v7, 4, v7
    v_add_u32 v7, 16384, v7
    s_mov_b32 exec_lo, 0
    v_mov_b32 v75, v7
    s_mov_b32 exec_lo, -1
    v_add_u32 v75, s35, v75
    s_and_b32 s35, s2, 7
    s_lshl_b32 s35, s35, 7
    v_min_u32 v141, s56, v1
    v_and_b32 v7, 7, v1
    v_lshlrev_b32 v141, 2, v141
    v_lshlrev_b32 v7, 4, v7
    v_add_u32 v7, 16384, v7
    s_mov_b32 exec_lo, 0
    v_mov_b32 v141, v7
    s_mov_b32 exec_lo, -1
    v_add_u32 v141, s35, v141
    s_mul_i32 s56, s34, 13696
    s_add_u32 s48, s30, 13631488
    s_addc_u32 s49, s31, 0
    s_add_u32 s48, s48, s56
    s_addc_u32 s49, s49, 0
    s_mov_b32 s50, 13696
    s_mov_b32 s51, 0x20000
    s_mov_b32 s52, s26
    s_mov_b32 s53, s27
    s_mov_b32 s54, 2621440
    s_mov_b32 s55, 0x20000
    s_movk_i32 s56, 6912
    s_movk_i32 s59, 10368
    s_movk_i32 s60, 12096
    s_movk_i32 s61, 4096
    s_movk_i32 s62, 8192
    s_add_u32 s63, s87, 1310720
    s_waitcnt lgkmcnt(0)
    s_movk_i32 s66, 8192
    s_mov_b32 s35, 0
Lq8:
    buffer_load_dword v44, v75, s[76:79], s66 offen sc1
    s_waitcnt vmcnt(0)
    v_cmp_ne_u32 vcc, s32, v44
    s_nop 0
    s_cbranch_vccz Lqd8
    s_add_u32 s35, s35, 1
    s_sleep 1
    s_cmp_lt_u32 s35, 24
    s_cbranch_scc1 Lq8
Lqd8:
    s_cmp_eq_u32 s35, 0
    s_cbranch_scc1 Lqe8
    s_sleep 4
Lqe8:
    s_mov_b32 s35, 0
Lp9:
    buffer_load_dwordx4 v[56:59], v136, s[44:47], s59 offen sc1
    buffer_load_dwordx4 v[60:63], v136, s[44:47], s60 offen sc1
    buffer_load_dwordx4 v[44:47], v137, s[44:47], 0 offen sc1
    buffer_load_dwordx4 v[48:51], v137, s[44:47], 0 offen offset:3456 sc1
    buffer_load_dwordx4 v[52:55], v137, s[44:47], s56 offen sc1
Lpc9:
    s_waitcnt vmcnt(0)
    v_cmp_ne_u32 s[64:65], s89, v47
    v_cmp_ne_u32 s[66:67], s89, v51
    v_cmp_ne_u32 s[68:69], s89, v55
    v_cmp_ne_u32 s[70:71], s89, v59
    v_cmp_ne_u32 s[72:73], s89, v63
    s_or_b64 s[64:65], s[64:65], s[66:67]
    s_or_b64 s[68:69], s[68:69], s[70:71]
    s_or_b64 s[64:65], s[64:65], s[68:69]
    s_or_b64 s[64:65], s[64:65], s[72:73]
    s_and_b64 exec, exec, s[64:65]
    s_cbranch_execz Lpd9
    s_add_u32 s35, s35, 1
    s_sleep 8
    s_cmp_lt_u32 s35, 300000
    s_cbranch_scc1 Lp9
Lpd9:
    s_mov_b64 exec, -1
    s_setprio 3
    ds_write_b32 v139, v44 offset:2816
    ds_write_b32 v138, v45 offset:2820
    ds_write_b32 v140, v46 offset:2824
    ds_write_b32 v139, v48 offset:5632
    ds_write_b32 v138, v49 offset:5636
    ds_write_b32 v140, v50 offset:5640
    ds_write_b32 v139, v52 offset:8448
    ds_write_b32 v138, v53 offset:8452
    ds_write_b32 v140, v54 offset:8456
    v_lshlrev_b32 v7, 16, v56
    v_lshlrev_b32 v9, 16, v60
    v_and_b32 v8, v6, v56
    v_and_b32 v10, v6, v60
    v_fmac_f32 v10, v73, v7
    v_fma_f32 v8, -v73, v9, v8
    v_cvt_pk_bf16_f32 v11, v10, v8
    v_lshlrev_b32 v7, 16, v57
    v_lshlrev_b32 v9, 16, v61
    v_and_b32 v8, v6, v57
    v_and_b32 v10, v6, v61
    v_fmac_f32 v10, v73, v7
    v_fma_f32 v8, -v73, v9, v8
    v_cvt_pk_bf16_f32 v12, v10, v8
    v_lshlrev_b32 v7, 16, v58
    v_lshlrev_b32 v9, 16, v62
    v_and_b32 v8, v6, v58
    v_and_b32 v10, v6, v62
    v_fmac_f32 v10, v73, v7
    v_fma_f32 v8, -v73, v9, v8
    v_cvt_pk_bf16_f32 v13, v10, v8
    ds_write_b32 v139, v11
    ds_write_b32 v138, v12 offset:4
    ds_write_b32 v140, v13 offset:8
    s_waitcnt lgkmcnt(0)
    s_barrier
    ds_read2_b32 v[188:189], v68 offset0:0 offset1:40
    ds_read2_b32 v[190:191], v68 offset0:80 offset1:120
    ds_read_b32 v160, v74
    ds_read2_b32 v[192:193], v68 offset0:16 offset1:56
    ds_read2_b32 v[194:195], v68 offset0:96 offset1:136
    ds_read2_b32 v[196:197], v69 offset0:32 offset1:72
    ds_read2_b32 v[198:199], v69 offset0:112 offset1:152
    s_waitcnt lgkmcnt(5)
    v_mfma_f32_16x16x32_bf16 v[164:167], v[188:191], v[152:155], 0
    v_mfma_f32_16x16x32_bf16 v[176:179], v[188:191], v[156:159], 0
    s_waitcnt lgkmcnt(4)
    v_mfma_f32_16x16x32_bf16 v[164:167], v[160:163], v[152:155], v[164:167]
    v_mfma_f32_16x16x32_bf16 v[176:179], v[160:163], v[156:159], v[176:179]
    s_waitcnt lgkmcnt(2)
    v_mfma_f32_16x16x32_bf16 v[168:171], v[192:195], v[152:155], 0
    v_mfma_f32_16x16x32_bf16 v[180:183], v[192:195], v[156:159], 0
    s_waitcnt lgkmcnt(0)
    v_mfma_f32_16x16x32_bf16 v[172:175], v[196:199], v[152:155], 0
    v_mfma_f32_16x16x32_bf16 v[184:187], v[196:199], v[156:159], 0
    s_nop 0
    v_mul_f32 v7, v164, v20
    v_mul_f32 v9, v165, v21
    v_mul_f32 v11, v166, v22
    v_mul_f32 v13, v167, v23
    v_mul_f32 v8, v176, v20
    v_mul_f32 v10, v177, v21
    v_mul_f32 v12, v178, v22
    v_mul_f32 v14, v179, v23
    v_fmac_f32 v7, v176, v32
    v_fmac_f32 v9, v177, v33
    v_fmac_f32 v11, v178, v34
    v_fmac_f32 v13, v179, v35
    v_fma_f32 v8, -v164, v32, v8
    v_fma_f32 v10, -v165, v33, v10
    v_fma_f32 v12, -v166, v34, v12
    v_fma_f32 v14, -v167, v35, v14
    v_cvt_pk_bf16_f32 v188, v7, v8
    v_cvt_pk_bf16_f32 v189, v9, v10
    v_cvt_pk_bf16_f32 v190, v11, v12
    v_cvt_pk_bf16_f32 v191, v13, v14
    s_nop 1
    v_mfma_f32_16x16x32_bf16 v[44:47], v[76:79], v[188:191], 0
    v_mul_f32 v7, v168, v24
    v_mul_f32 v9, v169, v25
    v_mul_f32 v11, v170, v26
    v_mul_f32 v13, v171, v27
    v_mfma_f32_16x16x32_bf16 v[48:51], v[88:91], v[188:191], 0
    v_mul_f32 v8, v180, v24
    v_mul_f32 v10, v181, v25
    v_mul_f32 v12, v182, v26
    v_mul_f32 v14, v183, v27
    v_mfma_f32_16x16x32_bf16 v[52:55], v[100:103], v[188:191], 0
    v_fmac_f32 v7, v180, v36
    v_fmac_f32 v9, v181, v37
    v_fmac_f32 v11, v182, v38
    v_fmac_f32 v13, v183, v39
    v_mfma_f32_16x16x32_bf16 v[56:59], v[112:115], v[188:191], 0
    v_fma_f32 v8, -v168, v36, v8
    v_fma_f32 v10, -v169, v37, v10
    v_fma_f32 v12, -v170, v38, v12
    v_fma_f32 v14, -v171, v39, v14
    v_mfma_f32_16x16x32_bf16 v[60:63], v[124:127], v[188:191], 0
    v_cvt_pk_bf16_f32 v192, v7, v8
    v_cvt_pk_bf16_f32 v193, v9, v10
    v_cvt_pk_bf16_f32 v194, v11, v12
    v_cvt_pk_bf16_f32 v195, v13, v14
    v_mul_f32 v7, v172, v28
    v_mul_f32 v9, v173, v29
    v_mul_f32 v11, v174, v30
    v_mul_f32 v13, v175, v31
    v_mfma_f32_16x16x32_bf16 v[44:47], v[80:83], v[192:195], v[44:47]
    v_mul_f32 v8, v184, v28
    v_mul_f32 v10, v185, v29
    v_mul_f32 v12, v186, v30
    v_mul_f32 v14, v187, v31
    v_mfma_f32_16x16x32_bf16 v[48:51], v[92:95], v[192:195], v[48:51]
    v_fmac_f32 v7, v184, v40
    v_fmac_f32 v9, v185, v41
    v_fmac_f32 v11, v186, v42
    v_fmac_f32 v13, v187, v43
    v_mfma_f32_16x16x32_bf16 v[52:55], v[104:107], v[192:195], v[52:55]
    v_fma_f32 v8, -v172, v40, v8
    v_fma_f32 v10, -v173, v41, v10
    v_fma_f32 v12, -v174, v42, v12
    v_fma_f32 v14, -v175, v43, v14
    v_mfma_f32_16x16x32_bf16 v[56:59], v[116:119], v[192:195], v[56:59]
    v_cvt_pk_bf16_f32 v196, v7, v8
    v_cvt_pk_bf16_f32 v197, v9, v10
    v_cvt_pk_bf16_f32 v198, v11, v12
    v_cvt_pk_bf16_f32 v199, v13, v14
    v_mfma_f32_16x16x32_bf16 v[60:63], v[128:131], v[192:195], v[60:63]
    s_nop 0
    v_mfma_f32_16x16x32_bf16 v[44:47], v[84:87], v[196:199], v[44:47]
    v_mfma_f32_16x16x32_bf16 v[48:51], v[96:99], v[196:199], v[48:51]
    v_mfma_f32_16x16x32_bf16 v[52:55], v[108:111], v[196:199], v[52:55]
    v_mfma_f32_16x16x32_bf16 v[56:59], v[120:123], v[196:199], v[56:59]
    v_mfma_f32_16x16x32_bf16 v[60:63], v[132:135], v[196:199], v[60:63]
    s_nop 3
    v_cvt_pk_bf16_f32 v7, v45, v44
    v_cvt_pk_bf16_f32 v8, v47, v46
    v_cvt_pk_bf16_f32 v9, v49, v48
    v_cvt_pk_bf16_f32 v10, v51, v50
    v_cvt_pk_bf16_f32 v11, v53, v52
    v_cvt_pk_bf16_f32 v12, v55, v54
    v_cvt_pk_bf16_f32 v13, v57, v56
    v_cvt_pk_bf16_f32 v14, v59, v58
    v_cvt_pk_bf16_f32 v15, v61, v60
    v_cvt_pk_bf16_f32 v16, v63, v62
    ds_write_addtid_b32 v7 offset:0
    ds_write_addtid_b32 v8 offset:256
    ds_write_addtid_b32 v9 offset:512
    ds_write_addtid_b32 v10 offset:768
    ds_write_addtid_b32 v11 offset:1024
    ds_write_addtid_b32 v12 offset:1312
    ds_write_addtid_b32 v13 offset:1568
    ds_write_addtid_b32 v14 offset:1824
    ds_write_addtid_b32 v15 offset:2080
    ds_write_addtid_b32 v16 offset:2336
    s_setprio 0
    s_movk_i32 s66, 12288
    s_mov_b32 s35, 0
Lq10:
    buffer_load_dword v224, v141, s[76:79], s66 offen sc1
    s_waitcnt vmcnt(0)
    v_cmp_ne_u32 vcc, s32, v224
    s_nop 0
    s_cbranch_vccz Lqd10
    s_add_u32 s35, s35, 1
    s_sleep 1
    s_cmp_lt_u32 s35, 24
    s_cbranch_scc1 Lq10
Lqd10:
    s_cmp_eq_u32 s35, 0
    s_cbranch_scc1 Lqe10
    s_sleep 4
Lqe10:
    buffer_load_dwordx4 v[224:227], v4, s[48:51], 0 offen sc1
    buffer_load_dwordx4 v[228:231], v4, s[48:51], s61 offen sc1
    buffer_load_dwordx4 v[232:235], v4, s[48:51], s62 offen sc1
    buffer_load_dwordx4 v[236:239], v70, s[48:51], 0 offen sc1
    s_mov_b32 s35, 0
    s_branch Lpc11
Lp11:
    buffer_load_dwordx4 v[224:227], v4, s[48:51], 0 offen sc1
    buffer_load_dwordx4 v[228:231], v4, s[48:51], s61 offen sc1
    buffer_load_dwordx4 v[232:235], v4, s[48:51], s62 offen sc1
    buffer_load_dwordx4 v[236:239], v70, s[48:51], 0 offen sc1
Lpc11:
    s_waitcnt vmcnt(0)
    v_cmp_ne_u32 s[64:65], s32, v227
    v_cmp_ne_u32 s[66:67], s32, v231
    v_cmp_ne_u32 s[68:69], s32, v235
    v_cmp_ne_u32 s[70:71], s32, v239
    s_or_b64 s[64:65], s[64:65], s[66:67]
    s_or_b64 s[68:69], s[68:69], s[70:71]
    s_or_b64 s[64:65], s[64:65], s[68:69]
    s_and_b64 exec, exec, s[64:65]
    s_cbranch_execz Lpd11
    s_add_u32 s35, s35, 1
    s_sleep 8
    s_cmp_lt_u32 s35, 300000
    s_cbranch_scc1 Lp11
Lpd11:
    s_mov_b64 exec, -1
    s_setprio 3
    ds_write_b32 v71, v224 offset:40192
    ds_write_b32 v71, v225 offset:40196
    ds_write_b32 v71, v226 offset:40200
    ds_write_b32 v71, v228 offset:40960
    ds_write_b32 v71, v229 offset:40964
    ds_write_b32 v71, v230 offset:40968
    ds_write_b32 v71, v232 offset:41728
    ds_write_b32 v71, v233 offset:41732
    ds_write_b32 v71, v234 offset:41736
    ds_write_b32 v72, v236 offset:40192
    ds_write_b32 v72, v237 offset:40196
    ds_write_b32 v72, v238 offset:40200
    s_waitcnt lgkmcnt(0)
    s_barrier
    ds_read_b128 v[164:167], v64 offset:40192
    ds_read_b128 v[176:179], v64 offset:45376
    ds_read2st64_b32 v[188:189], v65 offset0:0 offset1:11
    ds_read2st64_b32 v[190:191], v65 offset0:22 offset1:33
    ds_read_b128 v[168:171], v64 offset:41216
    ds_read_b128 v[180:183], v64 offset:46400
    ds_read2st64_b32 v[192:193], v66 offset0:4 offset1:15
    ds_read2st64_b32 v[194:195], v66 offset0:26 offset1:37
    ds_read_b128 v[172:175], v64 offset:42240
    ds_read_b128 v[184:187], v64 offset:47424
    ds_read2st64_b32 v[196:197], v67 offset0:8 offset1:19
    ds_read2st64_b32 v[198:199], v67 offset0:30 offset1:41
    s_waitcnt lgkmcnt(11)
    v_perm_b32 v164, v164, v164, v18
    v_perm_b32 v165, v165, v165, v18
    v_perm_b32 v166, v166, v166, v18
    v_perm_b32 v167, v167, v167, v18
    v_mul_f32 v164, v164, v17
    v_mul_f32 v165, v165, v17
    v_mul_f32 v166, v166, v17
    v_mul_f32 v167, v167, v17
    s_waitcnt lgkmcnt(10)
    v_perm_b32 v176, v176, v176, v18
    v_perm_b32 v177, v177, v177, v18
    v_perm_b32 v178, v178, v178, v18
    v_perm_b32 v179, v179, v179, v18
    v_mul_f32 v176, v176, v143
    v_mul_f32 v177, v177, v143
    v_mul_f32 v178, v178, v143
    v_mul_f32 v179, v179, v143
    s_waitcnt lgkmcnt(8)
    v_mfma_f32_16x16x32_bf16 v[164:167], v[188:191], v[144:147], v[164:167]
    v_mfma_f32_16x16x32_bf16 v[176:179], v[188:191], v[148:151], v[176:179]
    s_waitcnt lgkmcnt(7)
    v_perm_b32 v168, v168, v168, v18
    v_perm_b32 v169, v169, v169, v18
    v_perm_b32 v170, v170, v170, v18
    v_perm_b32 v171, v171, v171, v18
    v_mul_f32 v168, v168, v17
    v_mul_f32 v169, v169, v17
    v_mul_f32 v170, v170, v17
    v_mul_f32 v171, v171, v17
    s_waitcnt lgkmcnt(6)
    v_perm_b32 v180, v180, v180, v18
    v_perm_b32 v181, v181, v181, v18
    v_perm_b32 v182, v182, v182, v18
    v_perm_b32 v183, v183, v183, v18
    v_mul_f32 v180, v180, v143
    v_mul_f32 v181, v181, v143
    v_mul_f32 v182, v182, v143
    v_mul_f32 v183, v183, v143
    s_waitcnt lgkmcnt(4)
    v_mfma_f32_16x16x32_bf16 v[168:171], v[192:195], v[144:147], v[168:171]
    v_mfma_f32_16x16x32_bf16 v[180:183], v[192:195], v[148:151], v[180:183]
    v_cvt_pk_bf16_f32 v224, v164, v165
    v_cvt_pk_bf16_f32 v225, v166, v167
    buffer_store_dwordx2 v[224:225], v19, s[52:55], s87 offen offset:0 nt
    v_cvt_pk_bf16_f32 v228, v176, v177
    v_cvt_pk_bf16_f32 v229, v178, v179
    buffer_store_dwordx2 v[228:229], v19, s[52:55], s63 offen offset:0 nt
    s_cmp_ge_u32 s33, 2
    s_cbranch_scc1 LB_fin
    s_waitcnt lgkmcnt(3)
    v_perm_b32 v172, v172, v172, v18
    v_perm_b32 v173, v173, v173, v18
    v_perm_b32 v174, v174, v174, v18
    v_perm_b32 v175, v175, v175, v18
    v_mul_f32 v172, v172, v17
    v_mul_f32 v173, v173, v17
    v_mul_f32 v174, v174, v17
    v_mul_f32 v175, v175, v17
    s_waitcnt lgkmcnt(2)
    v_perm_b32 v184, v184, v184, v18
    v_perm_b32 v185, v185, v185, v18
    v_perm_b32 v186, v186, v186, v18
    v_perm_b32 v187, v187, v187, v18
    v_mul_f32 v184, v184, v143
    v_mul_f32 v185, v185, v143
    v_mul_f32 v186, v186, v143
    v_mul_f32 v187, v187, v143
    s_waitcnt lgkmcnt(0)
    v_mfma_f32_16x16x32_bf16 v[172:175], v[196:199], v[144:147], v[172:175]
    v_mfma_f32_16x16x32_bf16 v[184:187], v[196:199], v[148:151], v[184:187]
    v_cvt_pk_bf16_f32 v232, v168, v169
    v_cvt_pk_bf16_f32 v233, v170, v171
    buffer_store_dwordx2 v[232:233], v19, s[52:55], s87 offen offset:512 nt
    v_cvt_pk_bf16_f32 v236, v180, v181
    v_cvt_pk_bf16_f32 v237, v182, v183
    buffer_store_dwordx2 v[236:237], v19, s[52:55], s63 offen offset:512 nt
    s_nop 0
    v_cvt_pk_bf16_f32 v224, v172, v173
    v_cvt_pk_bf16_f32 v225, v174, v175
    buffer_store_dwordx2 v[224:225], v19, s[52:55], s87 offen offset:1024 nt
    v_cvt_pk_bf16_f32 v228, v184, v185
    v_cvt_pk_bf16_f32 v229, v186, v187
    buffer_store_dwordx2 v[228:229], v19, s[52:55], s63 offen offset:1024 nt
    s_branch LB_fin2
LB_fin:
    v_cvt_pk_bf16_f32 v232, v168, v169
    v_cvt_pk_bf16_f32 v233, v170, v171
    buffer_store_dwordx2 v[232:233], v19, s[52:55], s87 offen offset:512 nt
    v_cvt_pk_bf16_f32 v236, v180, v181
    v_cvt_pk_bf16_f32 v237, v182, v183
    buffer_store_dwordx2 v[236:237], v19, s[52:55], s63 offen offset:512 nt
LB_fin2:
    s_cmp_lg_u32 s2, 224
    s_cbranch_scc1 LB_noep
    v_mov_b32 v7, 0
    v_mov_b32 v8, s89
    global_store_dword v7, v8, s[30:31]
LB_noep:
    s_endpgm
LA_main:
    s_mul_i32 s57, s33, 4096
    s_add_u32 s57, s57, 64944
    v_lshl_add_u32 v5, v1, 4, s57
    v_mov_b32 v60, 0
    v_mov_b32 v61, 0
    v_mov_b32 v62, 0
    v_mov_b32 v63, 0
    ds_write_b128 v5, v[60:63] offset:0
    ds_write_b128 v5, v[60:63] offset:1024
    ds_write_b128 v5, v[60:63] offset:2048
    ds_write_b128 v5, v[60:63] offset:3072
    s_mul_i32 s58, s33, 4752
    s_add_u32 s58, s58, 50688
    s_mul_i32 s59, s33, 16896
    v_lshl_add_u32 v18, v1, 3, s59
    v_and_b32 v5, 31, v1
    v_lshrrev_b32 v6, 5, v1
    v_mul_u32_u24 v5, 528, v5
    v_lshl_add_u32 v5, v6, 4, v5
    v_add_u32 v19, s59, v5
    s_mov_b32 s96, s58
    s_mov_b32 s97, s57
    s_waitcnt vmcnt(0)
    v_lshlrev_b32 v15, 16, v15
    v_lshlrev_b32 v60, 16, v11
    v_and_b32 v61, v4, v11
    v_mul_f32 v15, 0x3fb8aa3b, v15
    v_mul_f32 v60, 0x3fb8aa3b, v60
    v_mul_f32 v61, 0x3fb8aa3b, v61
    v_exp_f32 v15, v15
    v_exp_f32 v60, v60
    v_exp_f32 v61, v61
    v_lshlrev_b32 v62, 16, v12
    v_and_b32 v63, v4, v12
    v_cvt_pk_bf16_f32 v15, v15, v15
    v_cvt_pk_bf16_f32 v5, v60, v61
    v_and_b32 v15, v4, v15
    v_lshlrev_b32 v60, 16, v5
    v_and_b32 v61, v4, v5
    v_lshlrev_b32 v64, 16, v13
    v_and_b32 v65, v4, v13
    v_lshlrev_b32 v66, 16, v14
    v_and_b32 v67, v4, v14
    v_add_f32 v5, v15, v15
    v_mul_f32 v60, v60, v15
    v_mul_f32 v62, v62, v15
    v_mul_f32 v64, v64, v5
    v_mul_f32 v66, v66, v5
    v_mul_f32 v60, 0xbfb8aa3b, v60
    v_mul_f32 v62, 0x3e22f983, v62
    v_mul_f32 v61, v61, v15
    v_mul_f32 v63, v63, v15
    v_mul_f32 v65, v65, v5
    v_mul_f32 v67, v67, v5
    v_mul_f32 v61, 0xbfb8aa3b, v61
    v_mul_f32 v63, 0x3e22f983, v63
    v_mul_f32 v6, 0x41000000, v60
    v_mul_f32 v7, 0x41000000, v62
    v_exp_f32 v6, v6
    v_fract_f32 v7, v7
    v_cos_f32 v72, v7
    v_sin_f32 v74, v7
    v_mul_f32 v72, v72, v6
    v_mul_f32 v74, v74, v6
    v_mul_f32 v6, 0x41000000, v61
    v_mul_f32 v7, 0x41000000, v63
    v_exp_f32 v6, v6
    v_fract_f32 v7, v7
    v_cos_f32 v73, v7
    v_sin_f32 v75, v7
    v_mul_f32 v73, v73, v6
    v_mul_f32 v75, v75, v6
    v_mov_b32 v90, 0x3f803f80
    v_mov_b32 v91, 0
    ds_write_b64 v18, v[90:91] offset:0
    v_pk_mul_f32 v[80:81], v[72:73], v[72:73]
    v_pk_mul_f32 v[82:83], v[74:75], v[72:73]
    v_cvt_pk_bf16_f32 v84, v72, v73
    v_pk_fma_f32 v[80:81], v[74:75], v[74:75], v[80:81] neg_lo:[1,0,0] neg_hi:[1,0,0]
    v_pk_fma_f32 v[82:83], v[72:73], v[74:75], v[82:83]
    v_cvt_pk_bf16_f32 v85, v74, v75
    ds_write_b64 v18, v[84:85] offset:528
    v_pk_mul_f32 v[76:77], v[80:81], v[72:73]
    v_pk_mul_f32 v[78:79], v[82:83], v[72:73]
    v_cvt_pk_bf16_f32 v86, v80, v81
    v_pk_fma_f32 v[76:77], v[82:83], v[74:75], v[76:77] neg_lo:[1,0,0] neg_hi:[1,0,0]
    v_pk_fma_f32 v[78:79], v[80:81], v[74:75], v[78:79]
    v_cvt_pk_bf16_f32 v87, v82, v83
    ds_write_b64 v18, v[86:87] offset:1056
    v_pk_mul_f32 v[80:81], v[76:77], v[72:73]
    v_pk_mul_f32 v[82:83], v[78:79], v[72:73]
    v_cvt_pk_bf16_f32 v88, v76, v77
    v_pk_fma_f32 v[80:81], v[78:79], v[74:75], v[80:81] neg_lo:[1,0,0] neg_hi:[1,0,0]
    v_pk_fma_f32 v[82:83], v[76:77], v[74:75], v[82:83]
    v_cvt_pk_bf16_f32 v89, v78, v79
    ds_write_b64 v18, v[88:89] offset:1584
    v_pk_mul_f32 v[76:77], v[80:81], v[72:73]
    v_pk_mul_f32 v[78:79], v[82:83], v[72:73]
    v_cvt_pk_bf16_f32 v90, v80, v81
    v_pk_fma_f32 v[76:77], v[82:83], v[74:75], v[76:77] neg_lo:[1,0,0] neg_hi:[1,0,0]
    v_pk_fma_f32 v[78:79], v[80:81], v[74:75], v[78:79]
    v_cvt_pk_bf16_f32 v91, v82, v83
    ds_write_b64 v18, v[90:91] offset:2112
    v_pk_mul_f32 v[80:81], v[76:77], v[72:73]
    v_pk_mul_f32 v[82:83], v[78:79], v[72:73]
    v_cvt_pk_bf16_f32 v84, v76, v77
    v_pk_fma_f32 v[80:81], v[78:79], v[74:75], v[80:81] neg_lo:[1,0,0] neg_hi:[1,0,0]
    v_pk_fma_f32 v[82:83], v[76:77], v[74:75], v[82:83]
    v_cvt_pk_bf16_f32 v85, v78, v79
    ds_write_b64 v18, v[84:85] offset:2640
    v_pk_mul_f32 v[76:77], v[80:81], v[72:73]
    v_pk_mul_f32 v[78:79], v[82:83], v[72:73]
    v_cvt_pk_bf16_f32 v86, v80, v81
    v_pk_fma_f32 v[76:77], v[82:83], v[74:75], v[76:77] neg_lo:[1,0,0] neg_hi:[1,0,0]
    v_pk_fma_f32 v[78:79], v[80:81], v[74:75], v[78:79]
    v_cvt_pk_bf16_f32 v87, v82, v83
    ds_write_b64 v18, v[86:87] offset:3168
    v_pk_mul_f32 v[80:81], v[76:77], v[72:73]
    v_pk_mul_f32 v[82:83], v[78:79], v[72:73]
    v_cvt_pk_bf16_f32 v88, v76, v77
    v_pk_fma_f32 v[80:81], v[78:79], v[74:75], v[80:81] neg_lo:[1,0,0] neg_hi:[1,0,0]
    v_pk_fma_f32 v[82:83], v[76:77], v[74:75], v[82:83]
    v_cvt_pk_bf16_f32 v89, v78, v79
    ds_write_b64 v18, v[88:89] offset:3696
    v_pk_mul_f32 v[76:77], v[80:81], v[72:73]
    v_pk_mul_f32 v[78:79], v[82:83], v[72:73]
    v_cvt_pk_bf16_f32 v90, v80, v81
    v_pk_fma_f32 v[76:77], v[82:83], v[74:75], v[76:77] neg_lo:[1,0,0] neg_hi:[1,0,0]
    v_pk_fma_f32 v[78:79], v[80:81], v[74:75], v[78:79]
    v_cvt_pk_bf16_f32 v91, v82, v83
    ds_write_b64 v18, v[90:91] offset:4224
    v_pk_mul_f32 v[80:81], v[76:77], v[72:73]
    v_pk_mul_f32 v[82:83], v[78:79], v[72:73]
    v_cvt_pk_bf16_f32 v84, v76, v77
    v_pk_fma_f32 v[80:81], v[78:79], v[74:75], v[80:81] neg_lo:[1,0,0] neg_hi:[1,0,0]
    v_pk_fma_f32 v[82:83], v[76:77], v[74:75], v[82:83]
    v_cvt_pk_bf16_f32 v85, v78, v79
    ds_write_b64 v18, v[84:85] offset:4752
    v_pk_mul_f32 v[76:77], v[80:81], v[72:73]
    v_pk_mul_f32 v[78:79], v[82:83], v[72:73]
    v_cvt_pk_bf16_f32 v86, v80, v81
    v_pk_fma_f32 v[76:77], v[82:83], v[74:75], v[76:77] neg_lo:[1,0,0] neg_hi:[1,0,0]
    v_pk_fma_f32 v[78:79], v[80:81], v[74:75], v[78:79]
    v_cvt_pk_bf16_f32 v87, v82, v83
    ds_write_b64 v18, v[86:87] offset:5280
    v_pk_mul_f32 v[80:81], v[76:77], v[72:73]
    v_pk_mul_f32 v[82:83], v[78:79], v[72:73]
    v_cvt_pk_bf16_f32 v88, v76, v77
    v_pk_fma_f32 v[80:81], v[78:79], v[74:75], v[80:81] neg_lo:[1,0,0] neg_hi:[1,0,0]
    v_pk_fma_f32 v[82:83], v[76:77], v[74:75], v[82:83]
    v_cvt_pk_bf16_f32 v89, v78, v79
    ds_write_b64 v18, v[88:89] offset:5808
    v_pk_mul_f32 v[76:77], v[80:81], v[72:73]
    v_pk_mul_f32 v[78:79], v[82:83], v[72:73]
    v_cvt_pk_bf16_f32 v90, v80, v81
    v_pk_fma_f32 v[76:77], v[82:83], v[74:75], v[76:77] neg_lo:[1,0,0] neg_hi:[1,0,0]
    v_pk_fma_f32 v[78:79], v[80:81], v[74:75], v[78:79]
    v_cvt_pk_bf16_f32 v91, v82, v83
    ds_write_b64 v18, v[90:91] offset:6336
    v_pk_mul_f32 v[80:81], v[76:77], v[72:73]
    v_pk_mul_f32 v[82:83], v[78:79], v[72:73]
    v_cvt_pk_bf16_f32 v84, v76, v77
    v_pk_fma_f32 v[80:81], v[78:79], v[74:75], v[80:81] neg_lo:[1,0,0] neg_hi:[1,0,0]
    v_pk_fma_f32 v[82:83], v[76:77], v[74:75], v[82:83]
    v_cvt_pk_bf16_f32 v85, v78, v79
    ds_write_b64 v18, v[84:85] offset:6864
    v_pk_mul_f32 v[76:77], v[80:81], v[72:73]
    v_pk_mul_f32 v[78:79], v[82:83], v[72:73]
    v_cvt_pk_bf16_f32 v86, v80, v81
    v_pk_fma_f32 v[76:77], v[82:83], v[74:75], v[76:77] neg_lo:[1,0,0] neg_hi:[1,0,0]
    v_pk_fma_f32 v[78:79], v[80:81], v[74:75], v[78:79]
    v_cvt_pk_bf16_f32 v87, v82, v83
    ds_write_b64 v18, v[86:87] offset:7392
    v_pk_mul_f32 v[80:81], v[76:77], v[72:73]
    v_pk_mul_f32 v[82:83], v[78:79], v[72:73]
    v_cvt_pk_bf16_f32 v88, v76, v77
    v_pk_fma_f32 v[80:81], v[78:79], v[74:75], v[80:81] neg_lo:[1,0,0] neg_hi:[1,0,0]
    v_pk_fma_f32 v[82:83], v[76:77], v[74:75], v[82:83]
    v_cvt_pk_bf16_f32 v89, v78, v79
    ds_write_b64 v18, v[88:89] offset:7920
    v_pk_mul_f32 v[76:77], v[80:81], v[72:73]
    v_pk_mul_f32 v[78:79], v[82:83], v[72:73]
    v_cvt_pk_bf16_f32 v90, v80, v81
    v_pk_fma_f32 v[76:77], v[82:83], v[74:75], v[76:77] neg_lo:[1,0,0] neg_hi:[1,0,0]
    v_pk_fma_f32 v[78:79], v[80:81], v[74:75], v[78:79]
    v_cvt_pk_bf16_f32 v91, v82, v83
    ds_write_b64 v18, v[90:91] offset:8448
    v_pk_mul_f32 v[80:81], v[76:77], v[72:73]
    v_pk_mul_f32 v[82:83], v[78:79], v[72:73]
    v_cvt_pk_bf16_f32 v84, v76, v77
    v_pk_fma_f32 v[80:81], v[78:79], v[74:75], v[80:81] neg_lo:[1,0,0] neg_hi:[1,0,0]
    v_pk_fma_f32 v[82:83], v[76:77], v[74:75], v[82:83]
    v_cvt_pk_bf16_f32 v85, v78, v79
    ds_write_b64 v18, v[84:85] offset:8976
    v_pk_mul_f32 v[76:77], v[80:81], v[72:73]
    v_pk_mul_f32 v[78:79], v[82:83], v[72:73]
    v_cvt_pk_bf16_f32 v86, v80, v81
    v_pk_fma_f32 v[76:77], v[82:83], v[74:75], v[76:77] neg_lo:[1,0,0] neg_hi:[1,0,0]
    v_pk_fma_f32 v[78:79], v[80:81], v[74:75], v[78:79]
    v_cvt_pk_bf16_f32 v87, v82, v83
    ds_write_b64 v18, v[86:87] offset:9504
    v_pk_mul_f32 v[80:81], v[76:77], v[72:73]
    v_pk_mul_f32 v[82:83], v[78:79], v[72:73]
    v_cvt_pk_bf16_f32 v88, v76, v77
    v_pk_fma_f32 v[80:81], v[78:79], v[74:75], v[80:81] neg_lo:[1,0,0] neg_hi:[1,0,0]
    v_pk_fma_f32 v[82:83], v[76:77], v[74:75], v[82:83]
    v_cvt_pk_bf16_f32 v89, v78, v79
    ds_write_b64 v18, v[88:89] offset:10032
    v_pk_mul_f32 v[76:77], v[80:81], v[72:73]
    v_pk_mul_f32 v[78:79], v[82:83], v[72:73]
    v_cvt_pk_bf16_f32 v90, v80, v81
    v_pk_fma_f32 v[76:77], v[82:83], v[74:75], v[76:77] neg_lo:[1,0,0] neg_hi:[1,0,0]
    v_pk_fma_f32 v[78:79], v[80:81], v[74:75], v[78:79]
    v_cvt_pk_bf16_f32 v91, v82, v83
    ds_write_b64 v18, v[90:91] offset:10560
    v_pk_mul_f32 v[80:81], v[76:77], v[72:73]
    v_pk_mul_f32 v[82:83], v[78:79], v[72:73]
    v_cvt_pk_bf16_f32 v84, v76, v77
    v_pk_fma_f32 v[80:81], v[78:79], v[74:75], v[80:81] neg_lo:[1,0,0] neg_hi:[1,0,0]
    v_pk_fma_f32 v[82:83], v[76:77], v[74:75], v[82:83]
    v_cvt_pk_bf16_f32 v85, v78, v79
    ds_write_b64 v18, v[84:85] offset:11088
    v_pk_mul_f32 v[76:77], v[80:81], v[72:73]
    v_pk_mul_f32 v[78:79], v[82:83], v[72:73]
    v_cvt_pk_bf16_f32 v86, v80, v81
    v_pk_fma_f32 v[76:77], v[82:83], v[74:75], v[76:77] neg_lo:[1,0,0] neg_hi:[1,0,0]
    v_pk_fma_f32 v[78:79], v[80:81], v[74:75], v[78:79]
    v_cvt_pk_bf16_f32 v87, v82, v83
    ds_write_b64 v18, v[86:87] offset:11616
    v_pk_mul_f32 v[80:81], v[76:77], v[72:73]
    v_pk_mul_f32 v[82:83], v[78:79], v[72:73]
    v_cvt_pk_bf16_f32 v88, v76, v77
    v_pk_fma_f32 v[80:81], v[78:79], v[74:75], v[80:81] neg_lo:[1,0,0] neg_hi:[1,0,0]
    v_pk_fma_f32 v[82:83], v[76:77], v[74:75], v[82:83]
    v_cvt_pk_bf16_f32 v89, v78, v79
    ds_write_b64 v18, v[88:89] offset:12144
    v_pk_mul_f32 v[76:77], v[80:81], v[72:73]
    v_pk_mul_f32 v[78:79], v[82:83], v[72:73]
    v_cvt_pk_bf16_f32 v90, v80, v81
    v_pk_fma_f32 v[76:77], v[82:83], v[74:75], v[76:77] neg_lo:[1,0,0] neg_hi:[1,0,0]
    v_pk_fma_f32 v[78:79], v[80:81], v[74:75], v[78:79]
    v_cvt_pk_bf16_f32 v91, v82, v83
    ds_write_b64 v18, v[90:91] offset:12672
    v_pk_mul_f32 v[80:81], v[76:77], v[72:73]
    v_pk_mul_f32 v[82:83], v[78:79], v[72:73]
    v_cvt_pk_bf16_f32 v84, v76, v77
    v_pk_fma_f32 v[80:81], v[78:79], v[74:75], v[80:81] neg_lo:[1,0,0] neg_hi:[1,0,0]
    v_pk_fma_f32 v[82:83], v[76:77], v[74:75], v[82:83]
    v_cvt_pk_bf16_f32 v85, v78, v79
    ds_write_b64 v18, v[84:85] offset:13200
    v_pk_mul_f32 v[76:77], v[80:81], v[72:73]
    v_pk_mul_f32 v[78:79], v[82:83], v[72:73]
    v_cvt_pk_bf16_f32 v86, v80, v81
    v_pk_fma_f32 v[76:77], v[82:83], v[74:75], v[76:77] neg_lo:[1,0,0] neg_hi:[1,0,0]
    v_pk_fma_f32 v[78:79], v[80:81], v[74:75], v[78:79]
    v_cvt_pk_bf16_f32 v87, v82, v83
    ds_write_b64 v18, v[86:87] offset:13728
    v_pk_mul_f32 v[80:81], v[76:77], v[72:73]
    v_pk_mul_f32 v[82:83], v[78:79], v[72:73]
    v_cvt_pk_bf16_f32 v88, v76, v77
    v_pk_fma_f32 v[80:81], v[78:79], v[74:75], v[80:81] neg_lo:[1,0,0] neg_hi:[1,0,0]
    v_pk_fma_f32 v[82:83], v[76:77], v[74:75], v[82:83]
    v_cvt_pk_bf16_f32 v89, v78, v79
    ds_write_b64 v18, v[88:89] offset:14256
    v_pk_mul_f32 v[76:77], v[80:81], v[72:73]
    v_pk_mul_f32 v[78:79], v[82:83], v[72:73]
    v_cvt_pk_bf16_f32 v90, v80, v81
    v_pk_fma_f32 v[76:77], v[82:83], v[74:75], v[76:77] neg_lo:[1,0,0] neg_hi:[1,0,0]
    v_pk_fma_f32 v[78:79], v[80:81], v[74:75], v[78:79]
    v_cvt_pk_bf16_f32 v91, v82, v83
    ds_write_b64 v18, v[90:91] offset:14784
    v_pk_mul_f32 v[80:81], v[76:77], v[72:73]
    v_pk_mul_f32 v[82:83], v[78:79], v[72:73]
    v_cvt_pk_bf16_f32 v84, v76, v77
    v_pk_fma_f32 v[80:81], v[78:79], v[74:75], v[80:81] neg_lo:[1,0,0] neg_hi:[1,0,0]
    v_pk_fma_f32 v[82:83], v[76:77], v[74:75], v[82:83]
    v_cvt_pk_bf16_f32 v85, v78, v79
    ds_write_b64 v18, v[84:85] offset:15312
    v_pk_mul_f32 v[76:77], v[80:81], v[72:73]
    v_pk_mul_f32 v[78:79], v[82:83], v[72:73]
    v_cvt_pk_bf16_f32 v86, v80, v81
    v_pk_fma_f32 v[76:77], v[82:83], v[74:75], v[76:77] neg_lo:[1,0,0] neg_hi:[1,0,0]
    v_pk_fma_f32 v[78:79], v[80:81], v[74:75], v[78:79]
    v_cvt_pk_bf16_f32 v87, v82, v83
    ds_write_b64 v18, v[86:87] offset:15840
    v_pk_mul_f32 v[80:81], v[76:77], v[72:73]
    v_pk_mul_f32 v[82:83], v[78:79], v[72:73]
    v_cvt_pk_bf16_f32 v88, v76, v77
    v_pk_fma_f32 v[80:81], v[78:79], v[74:75], v[80:81] neg_lo:[1,0,0] neg_hi:[1,0,0]
    v_pk_fma_f32 v[82:83], v[76:77], v[74:75], v[82:83]
    v_cvt_pk_bf16_f32 v89, v78, v79
    ds_write_b64 v18, v[88:89] offset:16368
    v_lshlrev_b32 v10, 4, v1
    s_waitcnt lgkmcnt(0)
    s_barrier
    ds_read_b128 v[92:95], v19 offset:0
    ds_read_b128 v[96:99], v19 offset:32
    ds_read_b128 v[100:103], v19 offset:64
    ds_read_b128 v[104:107], v19 offset:96
    ds_read_b128 v[108:111], v19 offset:128
    ds_read_b128 v[112:115], v19 offset:160
    ds_read_b128 v[116:119], v19 offset:192
    ds_read_b128 v[120:123], v19 offset:224
    ds_read_b128 v[124:127], v19 offset:256
    ds_read_b128 v[128:131], v19 offset:288
    ds_read_b128 v[132:135], v19 offset:320
    ds_read_b128 v[136:139], v19 offset:352
    ds_read_b128 v[140:143], v19 offset:384
    ds_read_b128 v[144:147], v19 offset:416
    v_mul_f32 v6, 0x3f800000, v60
    v_mul_f32 v7, 0x3f800000, v62
    v_exp_f32 v6, v6
    v_fract_f32 v7, v7
    v_cos_f32 v68, v7
    v_sin_f32 v70, v7
    v_mul_f32 v68, v68, v6
    v_mul_f32 v70, v70, v6
    v_mul_f32 v6, 0x3f800000, v61
    v_mul_f32 v7, 0x3f800000, v63
    v_exp_f32 v6, v6
    v_fract_f32 v7, v7
    v_cos_f32 v69, v7
    v_sin_f32 v71, v7
    v_mul_f32 v69, v69, v6
    v_mul_f32 v71, v71, v6
    s_waitcnt lgkmcnt(3)
    ds_read_b128 v[148:151], v19 offset:448
    ds_read_b128 v[152:155], v19 offset:480
    ds_read_b128 v[44:47], v10 offset:51712
    ds_read_b128 v[48:51], v10 offset:52736
    ds_read_b128 v[52:55], v10 offset:53760
    ds_read_b128 v[56:59], v10 offset:54784
    ds_read_b128 v[20:23], v10 offset:55808
    ds_read_b128 v[24:27], v10 offset:56832
    ds_read_b128 v[28:31], v10 offset:57856
    ds_read_b128 v[32:35], v10 offset:58880
    ds_read_b128 v[36:39], v10 offset:59904
    ds_read_b128 v[40:43], v10 offset:60928
    v_pk_mul_f32 v[156:157], v[64:65], v[68:69]
    v_pk_mul_f32 v[158:159], v[66:67], v[68:69]
    v_pk_fma_f32 v[156:157], v[66:67], v[70:71], v[156:157] neg_lo:[1,0,0] neg_hi:[1,0,0]
    v_pk_fma_f32 v[158:159], v[64:65], v[70:71], v[158:159]
    s_waitcnt lgkmcnt(10)
    v_cvt_pk_bf16_f32 v90, v64, v65
    v_cvt_pk_bf16_f32 v91, -v66, -v67
    ds_write_b64 v18, v[90:91] offset:0
    v_pk_mul_f32 v[160:161], v[156:157], v[68:69]
    v_pk_mul_f32 v[162:163], v[158:159], v[68:69]
    v_cvt_pk_bf16_f32 v84, v156, v157
    v_pk_fma_f32 v[160:161], v[158:159], v[70:71], v[160:161] neg_lo:[1,0,0] neg_hi:[1,0,0]
    v_pk_fma_f32 v[162:163], v[156:157], v[70:71], v[162:163]
    v_cvt_pk_bf16_f32 v85, -v158, -v159
    ds_write_b64 v18, v[84:85] offset:528
    v_pk_mul_f32 v[164:165], v[160:161], v[68:69]
    v_pk_mul_f32 v[166:167], v[162:163], v[68:69]
    v_cvt_pk_bf16_f32 v86, v160, v161
    v_pk_fma_f32 v[164:165], v[162:163], v[70:71], v[164:165] neg_lo:[1,0,0] neg_hi:[1,0,0]
    v_pk_fma_f32 v[166:167], v[160:161], v[70:71], v[166:167]
    v_cvt_pk_bf16_f32 v87, -v162, -v163
    ds_write_b64 v18, v[86:87] offset:1056
    s_waitcnt lgkmcnt(3)
    v_pk_mul_f32 v[168:169], v[164:165], v[68:69]
    v_pk_mul_f32 v[170:171], v[166:167], v[68:69]
    v_cvt_pk_bf16_f32 v88, v164, v165
    v_pk_fma_f32 v[168:169], v[166:167], v[70:71], v[168:169] neg_lo:[1,0,0] neg_hi:[1,0,0]
    v_pk_fma_f32 v[170:171], v[164:165], v[70:71], v[170:171]
    v_cvt_pk_bf16_f32 v89, -v166, -v167
    ds_write_b64 v18, v[88:89] offset:1584
    v_pk_mul_f32 v[172:173], v[168:169], v[68:69]
    v_pk_mul_f32 v[174:175], v[170:171], v[68:69]
    v_cvt_pk_bf16_f32 v90, v168, v169
    v_pk_fma_f32 v[172:173], v[170:171], v[70:71], v[172:173] neg_lo:[1,0,0] neg_hi:[1,0,0]
    v_pk_fma_f32 v[174:175], v[168:169], v[70:71], v[174:175]
    v_cvt_pk_bf16_f32 v91, -v170, -v171
    ds_write_b64 v18, v[90:91] offset:4224
    v_pk_mul_f32 v[176:177], v[172:173], v[68:69]
    v_pk_mul_f32 v[178:179], v[174:175], v[68:69]
    v_cvt_pk_bf16_f32 v84, v172, v173
    v_pk_fma_f32 v[176:177], v[174:175], v[70:71], v[176:177] neg_lo:[1,0,0] neg_hi:[1,0,0]
    v_pk_fma_f32 v[178:179], v[172:173], v[70:71], v[178:179]
    v_cvt_pk_bf16_f32 v85, -v174, -v175
    ds_write_b64 v18, v[84:85] offset:4752
    v_pk_mul_f32 v[180:181], v[176:177], v[68:69]
    v_pk_mul_f32 v[182:183], v[178:179], v[68:69]
    v_cvt_pk_bf16_f32 v86, v176, v177
    v_pk_fma_f32 v[180:181], v[178:179], v[70:71], v[180:181] neg_lo:[1,0,0] neg_hi:[1,0,0]
    v_pk_fma_f32 v[182:183], v[176:177], v[70:71], v[182:183]
    v_cvt_pk_bf16_f32 v87, -v178, -v179
    ds_write_b64 v18, v[86:87] offset:5280
    v_pk_mul_f32 v[184:185], v[180:181], v[68:69]
    v_pk_mul_f32 v[186:187], v[182:183], v[68:69]
    v_cvt_pk_bf16_f32 v88, v180, v181
    v_pk_fma_f32 v[184:185], v[182:183], v[70:71], v[184:185] neg_lo:[1,0,0] neg_hi:[1,0,0]
    v_pk_fma_f32 v[186:187], v[180:181], v[70:71], v[186:187]
    v_cvt_pk_bf16_f32 v89, -v182, -v183
    ds_write_b64 v18, v[88:89] offset:5808
    v_cvt_pk_bf16_f32 v90, v184, v185
    v_cvt_pk_bf16_f32 v91, -v186, -v187
    ds_write_b64 v18, v[90:91] offset:8448
    v_pk_mul_f32 v[156:157], v[64:65], v[80:81]
    v_pk_mul_f32 v[158:159], v[66:67], v[80:81]
    v_pk_fma_f32 v[156:157], v[66:67], v[82:83], v[156:157] neg_lo:[1,0,0] neg_hi:[1,0,0]
    v_pk_fma_f32 v[158:159], v[64:65], v[82:83], v[158:159]
    v_pk_mul_f32 v[164:165], v[160:161], v[80:81]
    v_pk_mul_f32 v[166:167], v[162:163], v[80:81]
    v_cvt_pk_bf16_f32 v84, v156, v157
    v_pk_fma_f32 v[164:165], v[162:163], v[82:83], v[164:165] neg_lo:[1,0,0] neg_hi:[1,0,0]
    v_pk_fma_f32 v[166:167], v[160:161], v[82:83], v[166:167]
    v_cvt_pk_bf16_f32 v85, -v158, -v159
    ds_write_b64 v18, v[84:85] offset:2112
    ds_write_b64 v18, v[84:85] offset:2640
    v_pk_mul_f32 v[172:173], v[168:169], v[80:81]
    v_pk_mul_f32 v[174:175], v[170:171], v[80:81]
    v_cvt_pk_bf16_f32 v86, v164, v165
    v_pk_fma_f32 v[172:173], v[170:171], v[82:83], v[172:173] neg_lo:[1,0,0] neg_hi:[1,0,0]
    v_pk_fma_f32 v[174:175], v[168:169], v[82:83], v[174:175]
    v_cvt_pk_bf16_f32 v87, -v166, -v167
    ds_write_b64 v18, v[86:87] offset:3168
    v_pk_mul_f32 v[180:181], v[176:177], v[80:81]
    v_pk_mul_f32 v[182:183], v[178:179], v[80:81]
    v_cvt_pk_bf16_f32 v88, v172, v173
    v_pk_fma_f32 v[180:181], v[178:179], v[82:83], v[180:181] neg_lo:[1,0,0] neg_hi:[1,0,0]
    v_pk_fma_f32 v[182:183], v[176:177], v[82:83], v[182:183]
    v_cvt_pk_bf16_f32 v89, -v174, -v175
    ds_write_b64 v18, v[88:89] offset:3696
    ds_write_b64 v18, v[88:89] offset:6336
    ds_write_b64 v18, v[88:89] offset:6864
    v_pk_mul_f32 v[68:69], v[184:185], v[80:81]
    v_pk_mul_f32 v[70:71], v[186:187], v[80:81]
    v_cvt_pk_bf16_f32 v90, v180, v181
    v_pk_fma_f32 v[68:69], v[186:187], v[82:83], v[68:69] neg_lo:[1,0,0] neg_hi:[1,0,0]
    v_pk_fma_f32 v[70:71], v[184:185], v[82:83], v[70:71]
    v_cvt_pk_bf16_f32 v91, -v182, -v183
    ds_write_b64 v18, v[90:91] offset:7392
    v_pk_mul_f32 v[64:65], v[172:173], v[80:81]
    v_pk_mul_f32 v[66:67], v[174:175], v[80:81]
    v_cvt_pk_bf16_f32 v84, v68, v69
    v_pk_fma_f32 v[64:65], v[174:175], v[82:83], v[64:65] neg_lo:[1,0,0] neg_hi:[1,0,0]
    v_pk_fma_f32 v[66:67], v[172:173], v[82:83], v[66:67]
    v_cvt_pk_bf16_f32 v85, -v70, -v71
    ds_write_b64 v18, v[84:85] offset:7920
    ds_write_b64 v18, v[84:85] offset:10560
    v_pk_mul_f32 v[160:161], v[68:69], v[80:81]
    v_pk_mul_f32 v[162:163], v[70:71], v[80:81]
    v_cvt_pk_bf16_f32 v86, v64, v65
    v_pk_fma_f32 v[160:161], v[70:71], v[82:83], v[160:161] neg_lo:[1,0,0] neg_hi:[1,0,0]
    v_pk_fma_f32 v[162:163], v[68:69], v[82:83], v[162:163]
    v_cvt_pk_bf16_f32 v87, -v66, -v67
    ds_write_b64 v18, v[86:87] offset:8976
    v_pk_mul_f32 v[168:169], v[64:65], v[80:81]
    v_pk_mul_f32 v[170:171], v[66:67], v[80:81]
    v_cvt_pk_bf16_f32 v88, v160, v161
    v_pk_fma_f32 v[168:169], v[66:67], v[82:83], v[168:169] neg_lo:[1,0,0] neg_hi:[1,0,0]
    v_pk_fma_f32 v[170:171], v[64:65], v[82:83], v[170:171]
    v_cvt_pk_bf16_f32 v89, -v162, -v163
    ds_write_b64 v18, v[88:89] offset:10032
    v_pk_mul_f32 v[176:177], v[160:161], v[80:81]
    v_pk_mul_f32 v[178:179], v[162:163], v[80:81]
    v_cvt_pk_bf16_f32 v90, v168, v169
    v_pk_fma_f32 v[176:177], v[162:163], v[82:83], v[176:177] neg_lo:[1,0,0] neg_hi:[1,0,0]
    v_pk_fma_f32 v[178:179], v[160:161], v[82:83], v[178:179]
    v_cvt_pk_bf16_f32 v91, -v170, -v171
    ds_write_b64 v18, v[90:91] offset:9504
    v_pk_mul_f32 v[184:185], v[176:177], v[80:81]
    v_pk_mul_f32 v[186:187], v[178:179], v[80:81]
    v_cvt_pk_bf16_f32 v84, v176, v177
    v_pk_fma_f32 v[184:185], v[178:179], v[82:83], v[184:185] neg_lo:[1,0,0] neg_hi:[1,0,0]
    v_pk_fma_f32 v[186:187], v[176:177], v[82:83], v[186:187]
    v_cvt_pk_bf16_f32 v85, -v178, -v179
    ds_write_b64 v18, v[84:85] offset:12672
    v_pk_mul_f32 v[156:157], v[184:185], v[80:81]
    v_pk_mul_f32 v[158:159], v[186:187], v[80:81]
    v_cvt_pk_bf16_f32 v86, v184, v185
    v_pk_fma_f32 v[156:157], v[186:187], v[82:83], v[156:157] neg_lo:[1,0,0] neg_hi:[1,0,0]
    v_pk_fma_f32 v[158:159], v[184:185], v[82:83], v[158:159]
    v_cvt_pk_bf16_f32 v87, -v186, -v187
    ds_write_b64 v18, v[86:87] offset:11088
    v_pk_mul_f32 v[164:165], v[156:157], v[80:81]
    v_pk_mul_f32 v[166:167], v[158:159], v[80:81]
    v_cvt_pk_bf16_f32 v88, v156, v157
    v_pk_fma_f32 v[164:165], v[158:159], v[82:83], v[164:165] neg_lo:[1,0,0] neg_hi:[1,0,0]
    v_pk_fma_f32 v[166:167], v[156:157], v[82:83], v[166:167]
    v_cvt_pk_bf16_f32 v89, -v158, -v159
    ds_write_b64 v18, v[88:89] offset:11616
    v_pk_mul_f32 v[180:181], v[164:165], v[80:81]
    v_pk_mul_f32 v[182:183], v[166:167], v[80:81]
    v_cvt_pk_bf16_f32 v90, v164, v165
    v_pk_fma_f32 v[180:181], v[166:167], v[82:83], v[180:181] neg_lo:[1,0,0] neg_hi:[1,0,0]
    v_pk_fma_f32 v[182:183], v[164:165], v[82:83], v[182:183]
    v_cvt_pk_bf16_f32 v91, -v166, -v167
    ds_write_b64 v18, v[90:91] offset:12144
    v_cvt_pk_bf16_f32 v84, v180, v181
    v_cvt_pk_bf16_f32 v85, -v182, -v183
    ds_write_b64 v18, v[84:85] offset:14784
    v_mov_b32 v5, s96
    v_mov_b32 v6, s97
    s_waitcnt lgkmcnt(0)
    s_barrier
    ds_read_b128 v[12:15], v19 offset:0
    ds_read_b128 v[60:63], v19 offset:32
    ds_read_b128 v[64:67], v19 offset:64
    ds_read_b128 v[68:71], v19 offset:96
    ds_read_b128 v[72:75], v19 offset:128
    ds_read_b128 v[76:79], v19 offset:160
    v_add_u32 v52, v5, v52
    v_add_u32 v53, v5, v53
    v_add_u32 v54, v5, v54
    v_add_u32 v55, v5, v55
    v_add_u32 v56, v5, v56
    v_add_u32 v57, v5, v57
    v_add_u32 v58, v5, v58
    v_add_u32 v59, v5, v59
    v_add_u32 v44, v5, v44
    v_add_u32 v45, v6, v45
    v_add_u32 v46, v6, v46
    v_add_u32 v47, v6, v47
    v_add_u32 v48, v6, v48
    v_add_u32 v49, v6, v49
    v_add_u32 v50, v6, v50
    v_add_u32 v17, 1024, v45
    s_waitcnt lgkmcnt(5)
    v_mfma_f32_32x32x16_bf16 v[156:171], v[12:15], v[92:95], 0
    ds_read_b128 v[12:15], v19 offset:192
    s_waitcnt lgkmcnt(5)
    v_mfma_f32_32x32x16_bf16 v[156:171], v[60:63], v[96:99], v[156:171]
    ds_read_b128 v[60:63], v19 offset:224
    s_waitcnt lgkmcnt(5)
    v_mfma_f32_32x32x16_bf16 v[156:171], v[64:67], v[100:103], v[156:171]
    ds_read_b128 v[64:67], v19 offset:256
    s_waitcnt lgkmcnt(5)
    v_mfma_f32_32x32x16_bf16 v[156:171], v[68:71], v[104:107], v[156:171]
    ds_read_b128 v[68:71], v19 offset:288
    s_waitcnt lgkmcnt(5)
    v_mfma_f32_32x32x16_bf16 v[156:171], v[72:75], v[108:111], v[156:171]
    ds_read_b128 v[72:75], v19 offset:320
    s_waitcnt lgkmcnt(5)
    v_mfma_f32_32x32x16_bf16 v[156:171], v[76:79], v[112:115], v[156:171]
    ds_read_b128 v[76:79], v19 offset:352
    s_waitcnt lgkmcnt(5)
    v_mfma_f32_32x32x16_bf16 v[156:171], v[12:15], v[116:119], v[156:171]
    ds_read_b128 v[12:15], v19 offset:384
    s_waitcnt lgkmcnt(5)
    v_mfma_f32_32x32x16_bf16 v[156:171], v[60:63], v[120:123], v[156:171]
    ds_read_b128 v[60:63], v19 offset:416
    s_waitcnt lgkmcnt(5)
    v_mfma_f32_32x32x16_bf16 v[156:171], v[64:67], v[124:127], v[156:171]
    ds_read_b128 v[64:67], v19 offset:448
    s_waitcnt lgkmcnt(5)
    v_mfma_f32_32x32x16_bf16 v[156:171], v[68:71], v[128:131], v[156:171]
    ds_read_b128 v[68:71], v19 offset:480
    s_waitcnt lgkmcnt(5)
    v_mfma_f32_32x32x16_bf16 v[156:171], v[72:75], v[132:135], v[156:171]
    s_waitcnt lgkmcnt(4)
    v_mfma_f32_32x32x16_bf16 v[156:171], v[76:79], v[136:139], v[156:171]
    s_waitcnt lgkmcnt(3)
    v_mfma_f32_32x32x16_bf16 v[156:171], v[12:15], v[140:143], v[156:171]
    s_waitcnt lgkmcnt(2)
    v_mfma_f32_32x32x16_bf16 v[156:171], v[60:63], v[144:147], v[156:171]
    s_waitcnt lgkmcnt(1)
    v_mfma_f32_32x32x16_bf16 v[156:171], v[64:67], v[148:151], v[156:171]
    s_waitcnt lgkmcnt(0)
    v_mfma_f32_32x32x16_bf16 v[156:171], v[68:71], v[152:155], v[156:171]
    s_mov_b64 exec, 1
    s_nop 10
    v_add_f32 v156, v156, v16
    s_mov_b64 exec, -1
    v_cvt_pk_bf16_f32 v7, v164, v164
    v_cvt_pk_bf16_f32 v8, v156, v156
    v_cvt_pk_bf16_f32 v9, v168, v168
    v_cvt_pk_bf16_f32 v5, v165, v166
    v_readlane_b32 s56, v7, 63
    v_readlane_b32 s57, v8, 0
    v_readlane_b32 s58, v9, 31
    v_cvt_pk_bf16_f32 v6, v167, v168
    v_cvt_pk_bf16_f32 v12, v164, v163
    v_cvt_pk_bf16_f32 v13, v162, v161
    v_cvt_pk_bf16_f32 v14, v160, v159
    v_cvt_pk_bf16_f32 v15, v158, v157
    v_mov_b32 v7, s58
    v_writelane_b32 v7, s56, 0
    v_writelane_b32 v7, s56, 1
    v_writelane_b32 v7, s56, 2
    v_writelane_b32 v7, s57, 3
    v_cvt_pk_bf16_f32 v60, v163, v162
    v_cvt_pk_bf16_f32 v61, v161, v160
    v_cvt_pk_bf16_f32 v62, v159, v158
    v_cvt_pk_bf16_f32 v63, v157, v156
    v_and_b32 v7, v7, v51
    ds_write_b128 v47, v[12:15]
    ds_write_b128 v47, v[60:63] offset:1216
    ds_write_b32 v50, v7
    ds_write_b16 v48, v5 offset:32
    ds_write_b16_d16_hi v48, v5
    ds_write_b16 v48, v5 offset:862
    ds_write_b16_d16_hi v48, v5 offset:830
    ds_write_b16 v49, v6 offset:32
    ds_write_b16_d16_hi v49, v6
    ds_write_b16 v49, v6 offset:862
    ds_write_b16_d16_hi v49, v6 offset:830
    s_branch LA_join
LA_w3:
    s_sub_u32 s56, s2, 0
    s_and_b32 s57, s56, 7
    s_lshr_b32 s56, s56, 3
    s_lshr_b32 s58, s57, 1
    s_add_u32 s58, s58, 1
    s_sub_u32 s59, s57, 6
    s_lshl_b32 s59, s59, 2
    s_and_b32 s60, s57, 1
    s_cmp_ge_u32 s57, 6
    s_cselect_b32 s58, s59, s58
    s_cselect_b32 s60, 0, s60
    s_mul_i32 s58, s58, 14336
    s_mul_i32 s59, s56, 640
    s_add_u32 s58, s58, s59
    v_min_u32 v5, 4, v1
    v_lshl_add_u32 v5, v5, 7, s58
    v_min_u32 v5, LtabEnd-TabP-4, v5
    s_add_u32 s64, s94, TabP-Lbase
    s_addc_u32 s65, s95, 0
    global_load_dword v254, v5, s[64:65]
    s_add_u32 s76, s30, 524288
    s_addc_u32 s77, s31, 0
    s_mov_b32 s78, 32768
    s_mov_b32 s79, 0x20000
    s_lshr_b32 s3, s2, 3
    s_sub_u32 s3, s3, 0
    s_and_b32 s35, s2, 7
    s_lshl_b32 s35, s35, 7
    v_and_b32 v5, 3, v1
    v_lshl_add_u32 v5, v5, 12, s35
    buffer_load_dword v254, v5, s[76:79], 0 offen
    v_lshlrev_b32 v11, 4, v1
    v_lshlrev_b32 v5, 5, v2
    v_lshl_add_u32 v5, v3, 4, v5
    v_subrev_u32 v6, 32, v5
    v_ashrrev_i32 v7, 31, v6
    v_lshl_add_u32 v6, v7, 4, v6
    v_add_u32 v12, 528, v6
    v_subrev_u32 v6, 96, v5
    v_ashrrev_i32 v7, 31, v6
    v_lshl_add_u32 v6, v7, 4, v6
    v_add_u32 v13, 528, v6
    v_subrev_u32 v6, 160, v5
    v_ashrrev_i32 v7, 31, v6
    v_lshl_add_u32 v6, v7, 4, v6
    v_add_u32 v14, 528, v6
    v_subrev_u32 v6, 224, v5
    v_ashrrev_i32 v7, 31, v6
    v_lshl_add_u32 v6, v7, 4, v6
    v_add_u32 v15, 528, v6
    ds_write_b128 v11, v[12:15] offset:53760
    v_subrev_u32 v6, 288, v5
    v_ashrrev_i32 v7, 31, v6
    v_lshl_add_u32 v6, v7, 4, v6
    v_add_u32 v12, 528, v6
    v_subrev_u32 v6, 352, v5
    v_ashrrev_i32 v7, 31, v6
    v_lshl_add_u32 v6, v7, 4, v6
    v_add_u32 v13, 528, v6
    v_subrev_u32 v6, 416, v5
    v_ashrrev_i32 v7, 31, v6
    v_lshl_add_u32 v6, v7, 4, v6
    v_add_u32 v14, 528, v6
    v_subrev_u32 v6, 480, v5
    v_ashrrev_i32 v7, 31, v6
    v_lshl_add_u32 v6, v7, 4, v6
    v_add_u32 v15, 528, v6
    ds_write_b128 v11, v[12:15] offset:54784
    v_subrev_u32 v6, 48, v5
    v_ashrrev_i32 v7, 31, v6
    v_lshl_add_u32 v6, v7, 4, v6
    v_add_u32 v12, 528, v6
    v_add_u32 v5, 1, v2
    v_lshrrev_b32 v5, 1, v5
    v_and_b32 v6, 1, v2
    v_lshlrev_b32 v7, 2, v3
    v_sub_u32 v7, v7, v5
    v_mul_u32_u24 v8, 304, v6
    v_add3_u32 v7, v7, v8, 8
    v_lshlrev_b32 v13, 2, v7
    v_lshlrev_b32 v7, 1, v3
    v_sub_u32 v7, v7, v5
    v_mul_u32_u24 v8, 208, v6
    v_add_u32 v7, v7, v8
    v_add_u32 v7, 616, v7
    v_lshlrev_b32 v14, 2, v7
    v_sub_u32 v15, 1072, v11
    ds_write_b128 v11, v[12:15] offset:51712
    v_lshrrev_b32 v6, 5, v1
    v_and_b32 v7, 1, v1
    v_and_b32 v5, 30, v1
    v_mul_u32_u24 v8, 96, v6
    v_sub_u32 v8, 256, v8
    v_mul_u32_u24 v8, v8, v7
    v_mul_u32_u24 v9, 544, v6
    v_add_u32 v8, v8, v9
    v_sub_u32 v8, v8, v5
    v_add_u32 v12, 2496, v8
    v_mul_u32_u24 v9, 192, v6
    v_sub_u32 v9, 128, v9
    v_add_u32 v13, v12, v9
    v_mov_b32 v14, 4092
    v_mov_b32 v15, 0
    s_movk_i32 s59, 60
    v_writelane_b32 v14, s59, 0
    s_mov_b32 s59, 0xffffffff
    v_writelane_b32 v15, s59, 0
    s_movk_i32 s59, 1276
    v_writelane_b32 v14, s59, 1
    s_mov_b32 s59, 0xffffffff
    v_writelane_b32 v15, s59, 1
    s_movk_i32 s59, 1272
    v_writelane_b32 v14, s59, 2
    s_mov_b32 s59, 0xffff0000
    v_writelane_b32 v15, s59, 2
    s_movk_i32 s59, 1088
    v_writelane_b32 v14, s59, 3
    s_mov_b32 s59, 0xffff
    v_writelane_b32 v15, s59, 3
    s_movk_i32 s59, 1176
    v_writelane_b32 v14, s59, 4
    s_mov_b32 s59, 0xffffffff
    v_writelane_b32 v15, s59, 4
    s_movk_i32 s59, 2388
    v_writelane_b32 v14, s59, 5
    s_mov_b32 s59, 0xffff0000
    v_writelane_b32 v15, s59, 5
    s_movk_i32 s59, 2392
    v_writelane_b32 v14, s59, 6
    s_mov_b32 s59, 0xffff
    v_writelane_b32 v15, s59, 6
    ds_write_b128 v11, v[12:15] offset:52736
    v_lshlrev_b32 v5, 3, v3
    v_sub_u32 v5, v2, v5
    v_mov_b32 v8, 0x00010001
    v_add_u32 v6, 21, v5
    v_med3_i32 v6, v6, 0, 18
    v_mov_b32 v7, 7
    v_lshlrev_b32 v6, v6, v7
    v_bfe_u32 v12, v6, 10, 2
    v_bfe_u32 v13, v6, 12, 2
    v_bfe_u32 v14, v6, 14, 2
    v_bfe_u32 v15, v6, 16, 2
    v_mul_u32_u24 v12, 0x8001, v12
    v_mul_u32_u24 v13, 0x8001, v13
    v_mul_u32_u24 v14, 0x8001, v14
    v_mul_u32_u24 v15, 0x8001, v15
    v_and_b32 v12, v8, v12
    v_and_b32 v13, v8, v13
    v_and_b32 v14, v8, v14
    v_and_b32 v15, v8, v15
    v_mul_u32_u24 v12, 0x3f80, v12
    v_mul_u32_u24 v13, 0x3f80, v13
    v_mul_u32_u24 v14, 0x3f80, v14
    v_mul_u32_u24 v15, 0x3f80, v15
    ds_write_b128 v11, v[12:15] offset:55808
    v_add_u32 v6, 16, v5
    v_med3_i32 v6, v6, 0, 18
    v_mov_b32 v7, 31
    v_lshlrev_b32 v6, v6, v7
    v_bfe_u32 v12, v6, 10, 2
    v_bfe_u32 v13, v6, 12, 2
    v_bfe_u32 v14, v6, 14, 2
    v_bfe_u32 v15, v6, 16, 2
    v_mul_u32_u24 v12, 0x8001, v12
    v_mul_u32_u24 v13, 0x8001, v13
    v_mul_u32_u24 v14, 0x8001, v14
    v_mul_u32_u24 v15, 0x8001, v15
    v_and_b32 v12, v8, v12
    v_and_b32 v13, v8, v13
    v_and_b32 v14, v8, v14
    v_and_b32 v15, v8, v15
    v_mul_u32_u24 v12, 0x3f80, v12
    v_mul_u32_u24 v13, 0x3f80, v13
    v_mul_u32_u24 v14, 0x3f80, v14
    v_mul_u32_u24 v15, 0x3f80, v15
    ds_write_b128 v11, v[12:15] offset:56832
    v_add_u32 v6, 13, v5
    v_med3_i32 v6, v6, 0, 18
    v_mov_b32 v7, 7
    v_lshlrev_b32 v6, v6, v7
    v_bfe_u32 v12, v6, 10, 2
    v_bfe_u32 v13, v6, 12, 2
    v_bfe_u32 v14, v6, 14, 2
    v_bfe_u32 v15, v6, 16, 2
    v_mul_u32_u24 v12, 0x8001, v12
    v_mul_u32_u24 v13, 0x8001, v13
    v_mul_u32_u24 v14, 0x8001, v14
    v_mul_u32_u24 v15, 0x8001, v15
    v_and_b32 v12, v8, v12
    v_and_b32 v13, v8, v13
    v_and_b32 v14, v8, v14
    v_and_b32 v15, v8, v15
    v_mul_u32_u24 v12, 0x3f80, v12
    v_mul_u32_u24 v13, 0x3f80, v13
    v_mul_u32_u24 v14, 0x3f80, v14
    v_mul_u32_u24 v15, 0x3f80, v15
    ds_write_b128 v11, v[12:15] offset:57856
    v_add_u32 v6, 16, v5
    v_med3_i32 v6, v6, 0, 18
    v_mov_b32 v7, 31
    v_lshlrev_b32 v6, v6, v7
    v_bfe_u32 v12, v6, 10, 2
    v_bfe_u32 v13, v6, 12, 2
    v_bfe_u32 v14, v6, 14, 2
    v_bfe_u32 v15, v6, 16, 2
    v_mul_u32_u24 v12, 0x8001, v12
    v_mul_u32_u24 v13, 0x8001, v13
    v_mul_u32_u24 v14, 0x8001, v14
    v_mul_u32_u24 v15, 0x8001, v15
    v_and_b32 v12, v8, v12
    v_and_b32 v13, v8, v13
    v_and_b32 v14, v8, v14
    v_and_b32 v15, v8, v15
    v_mul_u32_u24 v12, 0x3f80, v12
    v_mul_u32_u24 v13, 0x3f80, v13
    v_mul_u32_u24 v14, 0x3f80, v14
    v_mul_u32_u24 v15, 0x3f80, v15
    ds_write_b128 v11, v[12:15] offset:58880
    v_add_u32 v6, 15, v5
    v_med3_i32 v6, v6, 0, 18
    v_mov_b32 v7, 127
    v_lshlrev_b32 v6, v6, v7
    v_bfe_u32 v12, v6, 10, 2
    v_bfe_u32 v13, v6, 12, 2
    v_bfe_u32 v14, v6, 14, 2
    v_bfe_u32 v15, v6, 16, 2
    v_mul_u32_u24 v12, 0x8001, v12
    v_mul_u32_u24 v13, 0x8001, v13
    v_mul_u32_u24 v14, 0x8001, v14
    v_mul_u32_u24 v15, 0x8001, v15
    v_and_b32 v12, v8, v12
    v_and_b32 v13, v8, v13
    v_and_b32 v14, v8, v14
    v_and_b32 v15, v8, v15
    v_mul_u32_u24 v12, 0x3f80, v12
    v_mul_u32_u24 v13, 0x3f80, v13
    v_mul_u32_u24 v14, 0x3f80, v14
    v_mul_u32_u24 v15, 0x3f80, v15
    ds_write_b128 v11, v[12:15] offset:59904
    v_add_u32 v6, 14, v5
    v_med3_i32 v6, v6, 0, 18
    v_mov_b32 v7, 511
    v_lshlrev_b32 v6, v6, v7
    v_bfe_u32 v12, v6, 10, 2
    v_bfe_u32 v13, v6, 12, 2
    v_bfe_u32 v14, v6, 14, 2
    v_bfe_u32 v15, v6, 16, 2
    v_mul_u32_u24 v12, 0x8001, v12
    v_mul_u32_u24 v13, 0x8001, v13
    v_mul_u32_u24 v14, 0x8001, v14
    v_mul_u32_u24 v15, 0x8001, v15
    v_and_b32 v12, v8, v12
    v_and_b32 v13, v8, v13
    v_and_b32 v14, v8, v14
    v_and_b32 v15, v8, v15
    v_mul_u32_u24 v12, 0x3f80, v12
    v_mul_u32_u24 v13, 0x3f80, v13
    v_mul_u32_u24 v14, 0x3f80, v14
    v_mul_u32_u24 v15, 0x3f80, v15
    ds_write_b128 v11, v[12:15] offset:60928
    v_lshrrev_b32 v5, 3, v1
    v_and_b32 v6, 7, v1
    v_mul_u32_u24 v7, 54784, v5
    v_lshl_add_u32 v152, v6, 4, v7
    v_mul_u32_u24 v6, 528, v6
    v_lshl_add_u32 v153, v5, 3, v6
    v_mov_b32 v178, 0
    v_mov_b32 v179, 0
    v_lshlrev_b32 v5, 3, v1
    s_lshl_b32 s56, s84, 7
    s_mov_b32 s57, 0x05040100
    s_mov_b32 s58, 0x07060302
    s_add_u32 s40, s30, 1048576
    s_addc_u32 s41, s31, 0
    s_add_u32 s40, s40, s56
    s_addc_u32 s41, s41, 0
    s_mov_b32 s42, 3506176
    s_mov_b32 s43, 0x20000
    s_sub_u32 s42, s42, s56
    s_waitcnt lgkmcnt(0)
    s_or_b32 s32, s32, 1
    s_add_u32 s32, s32, 1
    s_barrier
    s_barrier
    s_and_b32 s35, s2, 7
    s_lshl_b32 s35, s35, 7
    v_min_u32 v10, 31, v1
    v_and_b32 v9, 7, v1
    v_lshlrev_b32 v10, 2, v10
    v_lshlrev_b32 v9, 4, v9
    v_add_u32 v9, 16384, v9
    s_mov_b32 exec_lo, 0
    v_mov_b32 v10, v9
    s_mov_b32 exec_lo, -1
    v_add_u32 v10, s35, v10
    s_movk_i32 s66, 0
    s_mov_b32 s35, 0
Lq12:
    buffer_load_dword v154, v10, s[76:79], s66 offen sc1
    s_waitcnt vmcnt(0)
    v_cmp_ne_u32 vcc, s32, v154
    s_nop 0
    s_cbranch_vccz Lqd12
    s_add_u32 s35, s35, 1
    s_sleep 1
    s_cmp_lt_u32 s35, 24
    s_cbranch_scc1 Lq12
Lqd12:
    s_cmp_eq_u32 s35, 0
    s_cbranch_scc1 Lqe12
    s_sleep 4
Lqe12:
    s_setprio 3
    s_mov_b32 s35, 0
Lp13:
    s_mov_b32 s59, 0
    buffer_load_dwordx4 v[24:27], v152, s[40:43], s59 offen sc1
    s_mov_b32 s59, 13696
    buffer_load_dwordx4 v[28:31], v152, s[40:43], s59 offen sc1
    s_mov_b32 s59, 27392
    buffer_load_dwordx4 v[32:35], v152, s[40:43], s59 offen sc1
    s_mov_b32 s59, 41088
    buffer_load_dwordx4 v[36:39], v152, s[40:43], s59 offen sc1
    s_mov_b32 s59, 438272
    buffer_load_dwordx4 v[40:43], v152, s[40:43], s59 offen sc1
    s_mov_b32 s59, 451968
    buffer_load_dwordx4 v[44:47], v152, s[40:43], s59 offen sc1
    s_mov_b32 s59, 465664
    buffer_load_dwordx4 v[48:51], v152, s[40:43], s59 offen sc1
    s_mov_b32 s59, 479360
    buffer_load_dwordx4 v[52:55], v152, s[40:43], s59 offen sc1
    s_mov_b32 s59, 876544
    buffer_load_dwordx4 v[56:59], v152, s[40:43], s59 offen sc1
    s_mov_b32 s59, 890240
    buffer_load_dwordx4 v[60:63], v152, s[40:43], s59 offen sc1
    s_mov_b32 s59, 903936
    buffer_load_dwordx4 v[64:67], v152, s[40:43], s59 offen sc1
    s_mov_b32 s59, 917632
    buffer_load_dwordx4 v[68:71], v152, s[40:43], s59 offen sc1
    s_mov_b32 s59, 1314816
    buffer_load_dwordx4 v[72:75], v152, s[40:43], s59 offen sc1
    s_mov_b32 s59, 1328512
    buffer_load_dwordx4 v[76:79], v152, s[40:43], s59 offen sc1
    s_mov_b32 s59, 1342208
    buffer_load_dwordx4 v[80:83], v152, s[40:43], s59 offen sc1
    s_mov_b32 s59, 1355904
    buffer_load_dwordx4 v[84:87], v152, s[40:43], s59 offen sc1
    s_mov_b32 s59, 1753088
    buffer_load_dwordx4 v[88:91], v152, s[40:43], s59 offen sc1
    s_mov_b32 s59, 1766784
    buffer_load_dwordx4 v[92:95], v152, s[40:43], s59 offen sc1
    s_mov_b32 s59, 1780480
    buffer_load_dwordx4 v[96:99], v152, s[40:43], s59 offen sc1
    s_mov_b32 s59, 1794176
    buffer_load_dwordx4 v[100:103], v152, s[40:43], s59 offen sc1
    s_mov_b32 s59, 2191360
    buffer_load_dwordx4 v[104:107], v152, s[40:43], s59 offen sc1
    s_mov_b32 s59, 2205056
    buffer_load_dwordx4 v[108:111], v152, s[40:43], s59 offen sc1
    s_mov_b32 s59, 2218752
    buffer_load_dwordx4 v[112:115], v152, s[40:43], s59 offen sc1
    s_mov_b32 s59, 2232448
    buffer_load_dwordx4 v[116:119], v152, s[40:43], s59 offen sc1
    s_mov_b32 s59, 2629632
    buffer_load_dwordx4 v[120:123], v152, s[40:43], s59 offen sc1
    s_mov_b32 s59, 2643328
    buffer_load_dwordx4 v[124:127], v152, s[40:43], s59 offen sc1
    s_mov_b32 s59, 2657024
    buffer_load_dwordx4 v[128:131], v152, s[40:43], s59 offen sc1
    s_mov_b32 s59, 2670720
    buffer_load_dwordx4 v[132:135], v152, s[40:43], s59 offen sc1
    s_mov_b32 s59, 3067904
    buffer_load_dwordx4 v[136:139], v152, s[40:43], s59 offen sc1
    s_mov_b32 s59, 3081600
    buffer_load_dwordx4 v[140:143], v152, s[40:43], s59 offen sc1
    s_mov_b32 s59, 3095296
    buffer_load_dwordx4 v[144:147], v152, s[40:43], s59 offen sc1
    s_mov_b32 s59, 3108992
    buffer_load_dwordx4 v[148:151], v152, s[40:43], s59 offen sc1
    s_waitcnt vmcnt(0)
    v_xor_b32 v6, s32, v27
    v_mov_b32 v7, s32
    v_xor_b32 v8, v7, v31
    v_xor_b32 v9, v7, v35
    v_or3_b32 v6, v6, v8, v9
    v_xor_b32 v8, v7, v39
    v_xor_b32 v9, v7, v43
    v_or3_b32 v6, v6, v8, v9
    v_xor_b32 v8, v7, v47
    v_xor_b32 v9, v7, v51
    v_or3_b32 v6, v6, v8, v9
    v_xor_b32 v8, v7, v55
    v_xor_b32 v9, v7, v59
    v_or3_b32 v6, v6, v8, v9
    v_xor_b32 v8, v7, v63
    v_xor_b32 v9, v7, v67
    v_or3_b32 v6, v6, v8, v9
    v_xor_b32 v8, v7, v71
    v_xor_b32 v9, v7, v75
    v_or3_b32 v6, v6, v8, v9
    v_xor_b32 v8, v7, v79
    v_xor_b32 v9, v7, v83
    v_or3_b32 v6, v6, v8, v9
    v_xor_b32 v8, v7, v87
    v_xor_b32 v9, v7, v91
    v_or3_b32 v6, v6, v8, v9
    v_xor_b32 v8, v7, v95
    v_xor_b32 v9, v7, v99
    v_or3_b32 v6, v6, v8, v9
    v_xor_b32 v8, v7, v103
    v_xor_b32 v9, v7, v107
    v_or3_b32 v6, v6, v8, v9
    v_xor_b32 v8, v7, v111
    v_xor_b32 v9, v7, v115
    v_or3_b32 v6, v6, v8, v9
    v_xor_b32 v8, v7, v119
    v_xor_b32 v9, v7, v123
    v_or3_b32 v6, v6, v8, v9
    v_xor_b32 v8, v7, v127
    v_xor_b32 v9, v7, v131
    v_or3_b32 v6, v6, v8, v9
    v_xor_b32 v8, v7, v135
    v_xor_b32 v9, v7, v139
    v_or3_b32 v6, v6, v8, v9
    v_xor_b32 v8, v7, v143
    v_xor_b32 v9, v7, v147
    v_or3_b32 v6, v6, v8, v9
    v_xor_b32 v8, v7, v151
    v_or_b32 v6, v6, v8
    v_cmp_ne_u32 vcc, 0, v6
    s_nop 0
    s_and_b64 exec, exec, vcc
    s_cbranch_execz Lpd13
    s_add_u32 s35, s35, 1
    s_sleep 2
    s_cmp_lt_u32 s35, 300000
    s_cbranch_scc1 Lp13
Lpd13:
    s_mov_b64 exec, -1
    s_cmp_eq_u32 s85, 1
    s_cbranch_scc1 LA_odd
    v_perm_b32 v154, v28, v24, s57
    v_perm_b32 v155, v36, v32, s57
    v_perm_b32 v156, v28, v24, s58
    v_perm_b32 v157, v36, v32, s58
    v_perm_b32 v158, v29, v25, s57
    v_perm_b32 v159, v37, v33, s57
    v_perm_b32 v160, v44, v40, s57
    v_perm_b32 v161, v52, v48, s57
    v_perm_b32 v162, v44, v40, s58
    v_perm_b32 v163, v52, v48, s58
    v_perm_b32 v164, v45, v41, s57
    v_perm_b32 v165, v53, v49, s57
    ds_write_b64 v5, v[178:179] offset:50688
    ds_write_b64 v5, v[178:179] offset:55440
    ds_write_b64 v5, v[178:179] offset:60192
    ds_write_b64 v153, v[154:155] offset:51216
    ds_write_b64 v153, v[156:157] offset:55968
    ds_write_b64 v153, v[158:159] offset:60720
    ds_write_b64 v153, v[160:161] offset:51280
    ds_write_b64 v153, v[162:163] offset:56032
    ds_write_b64 v153, v[164:165] offset:60784
    v_perm_b32 v166, v60, v56, s57
    v_perm_b32 v167, v68, v64, s57
    v_perm_b32 v168, v60, v56, s58
    v_perm_b32 v169, v68, v64, s58
    v_perm_b32 v170, v61, v57, s57
    v_perm_b32 v171, v69, v65, s57
    v_perm_b32 v172, v76, v72, s57
    v_perm_b32 v173, v84, v80, s57
    v_perm_b32 v174, v76, v72, s58
    v_perm_b32 v175, v84, v80, s58
    v_perm_b32 v176, v77, v73, s57
    v_perm_b32 v177, v85, v81, s57
    ds_write_b64 v153, v[166:167] offset:51344
    ds_write_b64 v153, v[168:169] offset:56096
    ds_write_b64 v153, v[170:171] offset:60848
    ds_write_b64 v153, v[172:173] offset:51408
    ds_write_b64 v153, v[174:175] offset:56160
    ds_write_b64 v153, v[176:177] offset:60912
    v_perm_b32 v154, v92, v88, s57
    v_perm_b32 v155, v100, v96, s57
    v_perm_b32 v156, v92, v88, s58
    v_perm_b32 v157, v100, v96, s58
    v_perm_b32 v158, v93, v89, s57
    v_perm_b32 v159, v101, v97, s57
    v_perm_b32 v160, v108, v104, s57
    v_perm_b32 v161, v116, v112, s57
    v_perm_b32 v162, v108, v104, s58
    v_perm_b32 v163, v116, v112, s58
    v_perm_b32 v164, v109, v105, s57
    v_perm_b32 v165, v117, v113, s57
    ds_write_b64 v153, v[154:155] offset:51472
    ds_write_b64 v153, v[156:157] offset:56224
    ds_write_b64 v153, v[158:159] offset:60976
    ds_write_b64 v153, v[160:161] offset:51536
    ds_write_b64 v153, v[162:163] offset:56288
    ds_write_b64 v153, v[164:165] offset:61040
    v_perm_b32 v166, v124, v120, s57
    v_perm_b32 v167, v132, v128, s57
    v_perm_b32 v168, v124, v120, s58
    v_perm_b32 v169, v132, v128, s58
    v_perm_b32 v170, v125, v121, s57
    v_perm_b32 v171, v133, v129, s57
    v_perm_b32 v172, v140, v136, s57
    v_perm_b32 v173, v148, v144, s57
    v_perm_b32 v174, v140, v136, s58
    v_perm_b32 v175, v148, v144, s58
    v_perm_b32 v176, v141, v137, s57
    v_perm_b32 v177, v149, v145, s57
    ds_write_b64 v153, v[166:167] offset:51600
    ds_write_b64 v153, v[168:169] offset:56352
    ds_write_b64 v153, v[170:171] offset:61104
    ds_write_b64 v153, v[172:173] offset:51664
    ds_write_b64 v153, v[174:175] offset:56416
    ds_write_b64 v153, v[176:177] offset:61168
    s_branch LA_join
LA_odd:
    v_perm_b32 v154, v29, v25, s58
    v_perm_b32 v155, v37, v33, s58
    v_perm_b32 v156, v30, v26, s57
    v_perm_b32 v157, v38, v34, s57
    v_perm_b32 v158, v30, v26, s58
    v_perm_b32 v159, v38, v34, s58
    v_perm_b32 v160, v45, v41, s58
    v_perm_b32 v161, v53, v49, s58
    v_perm_b32 v162, v46, v42, s57
    v_perm_b32 v163, v54, v50, s57
    v_perm_b32 v164, v46, v42, s58
    v_perm_b32 v165, v54, v50, s58
    ds_write_b64 v5, v[178:179] offset:50688
    ds_write_b64 v5, v[178:179] offset:55440
    ds_write_b64 v5, v[178:179] offset:60192
    ds_write_b64 v153, v[154:155] offset:51216
    ds_write_b64 v153, v[156:157] offset:55968
    ds_write_b64 v153, v[158:159] offset:60720
    ds_write_b64 v153, v[160:161] offset:51280
    ds_write_b64 v153, v[162:163] offset:56032
    ds_write_b64 v153, v[164:165] offset:60784
    v_perm_b32 v166, v61, v57, s58
    v_perm_b32 v167, v69, v65, s58
    v_perm_b32 v168, v62, v58, s57
    v_perm_b32 v169, v70, v66, s57
    v_perm_b32 v170, v62, v58, s58
    v_perm_b32 v171, v70, v66, s58
    v_perm_b32 v172, v77, v73, s58
    v_perm_b32 v173, v85, v81, s58
    v_perm_b32 v174, v78, v74, s57
    v_perm_b32 v175, v86, v82, s57
    v_perm_b32 v176, v78, v74, s58
    v_perm_b32 v177, v86, v82, s58
    ds_write_b64 v153, v[166:167] offset:51344
    ds_write_b64 v153, v[168:169] offset:56096
    ds_write_b64 v153, v[170:171] offset:60848
    ds_write_b64 v153, v[172:173] offset:51408
    ds_write_b64 v153, v[174:175] offset:56160
    ds_write_b64 v153, v[176:177] offset:60912
    v_perm_b32 v154, v93, v89, s58
    v_perm_b32 v155, v101, v97, s58
    v_perm_b32 v156, v94, v90, s57
    v_perm_b32 v157, v102, v98, s57
    v_perm_b32 v158, v94, v90, s58
    v_perm_b32 v159, v102, v98, s58
    v_perm_b32 v160, v109, v105, s58
    v_perm_b32 v161, v117, v113, s58
    v_perm_b32 v162, v110, v106, s57
    v_perm_b32 v163, v118, v114, s57
    v_perm_b32 v164, v110, v106, s58
    v_perm_b32 v165, v118, v114, s58
    ds_write_b64 v153, v[154:155] offset:51472
    ds_write_b64 v153, v[156:157] offset:56224
    ds_write_b64 v153, v[158:159] offset:60976
    ds_write_b64 v153, v[160:161] offset:51536
    ds_write_b64 v153, v[162:163] offset:56288
    ds_write_b64 v153, v[164:165] offset:61040
    v_perm_b32 v166, v125, v121, s58
    v_perm_b32 v167, v133, v129, s58
    v_perm_b32 v168, v126, v122, s57
    v_perm_b32 v169, v134, v130, s57
    v_perm_b32 v170, v126, v122, s58
    v_perm_b32 v171, v134, v130, s58
    v_perm_b32 v172, v141, v137, s58
    v_perm_b32 v173, v149, v145, s58
    v_perm_b32 v174, v142, v138, s57
    v_perm_b32 v175, v150, v146, s57
    v_perm_b32 v176, v142, v138, s58
    v_perm_b32 v177, v150, v146, s58
    ds_write_b64 v153, v[166:167] offset:51600
    ds_write_b64 v153, v[168:169] offset:56352
    ds_write_b64 v153, v[170:171] offset:61104
    ds_write_b64 v153, v[172:173] offset:51664
    ds_write_b64 v153, v[174:175] offset:56416
    ds_write_b64 v153, v[176:177] offset:61168
LA_join:
    v_and_b32 v5, 3, v0
    v_lshrrev_b32 v6, 2, v1
    v_mul_u32_u24 v7, 776, v5
    s_lshl_b32 s56, s33, 6
    v_add_u32 v7, v7, v6
    v_lshl_add_u32 v11, v7, 2, s56
    v_mul_u32_u24 v6, 13696, v6
    v_lshl_add_u32 v16, v5, 4, v6
    s_lshl_b32 s56, s33, 10
    s_add_u32 m0, s56, 0
    s_lshl_b32 s60, s83, 6
    s_mul_i32 s56, s33, 876544
    s_add_u32 s56, s56, s60
    s_add_u32 s57, s56, 219136
    s_add_u32 s58, s57, 219136
    s_add_u32 s59, s58, 219136
    s_add_u32 s44, s30, 13631488
    s_addc_u32 s45, s31, 0
    s_mov_b32 s46, 3506176
    s_mov_b32 s47, 0x20000
    s_add_u32 s76, s30, 524288
    s_addc_u32 s77, s31, 0
    s_mov_b32 s78, 32768
    s_mov_b32 s79, 0x20000
    s_lshr_b32 s3, s2, 3
    s_sub_u32 s3, s3, 0
    s_cmp_eq_u32 s33, 3
    s_cbranch_scc1 LA_w3b
    s_or_b32 s32, s32, 1
    s_add_u32 s32, s32, 1
    s_waitcnt lgkmcnt(0)
    s_barrier
    ds_read2_b32 v[156:157], v45 offset0:240 offset1:241
    ds_read2_b32 v[158:159], v45 offset0:242 offset1:243
    ds_read_b128 v[116:119], v53 offset:0
    ds_read2_b32 v[160:161], v45 offset0:112 offset1:113
    ds_read2_b32 v[162:163], v45 offset0:114 offset1:115
    ds_read_b128 v[120:123], v53 offset:528
    ds_read_b128 v[124:127], v53 offset:1056
    ds_read_b128 v[128:131], v53 offset:1584
    ds_read_b128 v[132:135], v53 offset:2112
    ds_read_b128 v[136:139], v53 offset:2640
    ds_read_b128 v[140:143], v53 offset:3168
    ds_read_b128 v[144:147], v53 offset:3696
    s_waitcnt lgkmcnt(9)
    v_mfma_f32_16x16x32_bf16 v[84:87], v[116:119], v[156:159], 0
    ds_read2_b32 v[148:149], v45 offset0:224 offset1:225
    s_waitcnt lgkmcnt(8)
    v_mfma_f32_16x16x32_bf16 v[88:91], v[116:119], v[160:163], 0
    ds_read2_b32 v[150:151], v45 offset0:226 offset1:227
    s_waitcnt lgkmcnt(8)
    v_mfma_f32_16x16x32_bf16 v[88:91], v[120:123], v[156:159], v[88:91]
    ds_read_b128 v[12:15], v54 offset:0
    v_mfma_f32_16x16x32_bf16 v[92:95], v[120:123], v[160:163], 0
    ds_read2_b32 v[152:153], v45 offset0:96 offset1:97
    s_waitcnt lgkmcnt(9)
    v_mfma_f32_16x16x32_bf16 v[92:95], v[124:127], v[156:159], v[92:95]
    ds_read2_b32 v[154:155], v45 offset0:98 offset1:99
    v_mfma_f32_16x16x32_bf16 v[96:99], v[124:127], v[160:163], 0
    ds_read_b128 v[48:51], v54 offset:528
    s_waitcnt lgkmcnt(10)
    v_mfma_f32_16x16x32_bf16 v[96:99], v[128:131], v[156:159], v[96:99]
    ds_read_b128 v[60:63], v54 offset:1056
    v_mfma_f32_16x16x32_bf16 v[100:103], v[128:131], v[160:163], 0
    ds_read_b128 v[64:67], v54 offset:1584
    s_waitcnt lgkmcnt(11)
    v_mfma_f32_16x16x32_bf16 v[100:103], v[132:135], v[156:159], v[100:103]
    ds_read_b128 v[68:71], v54 offset:2112
    v_mfma_f32_16x16x32_bf16 v[104:107], v[132:135], v[160:163], 0
    ds_read_b128 v[72:75], v54 offset:2640
    s_waitcnt lgkmcnt(12)
    v_mfma_f32_16x16x32_bf16 v[104:107], v[136:139], v[156:159], v[104:107]
    ds_read_b128 v[76:79], v54 offset:3168
    v_mfma_f32_16x16x32_bf16 v[108:111], v[136:139], v[160:163], 0
    ds_read_b128 v[80:83], v54 offset:3696
    s_waitcnt lgkmcnt(13)
    v_mfma_f32_16x16x32_bf16 v[108:111], v[140:143], v[156:159], v[108:111]
    v_mfma_f32_16x16x32_bf16 v[112:115], v[140:143], v[160:163], 0
    s_waitcnt lgkmcnt(12)
    v_mfma_f32_16x16x32_bf16 v[112:115], v[144:147], v[156:159], v[112:115]
    s_waitcnt lgkmcnt(9)
    v_mfma_f32_16x16x32_bf16 v[84:87], v[12:15], v[148:151], v[84:87]
    ds_read2_b32 v[156:157], v45 offset0:208 offset1:209
    s_waitcnt lgkmcnt(8)
    v_mfma_f32_16x16x32_bf16 v[88:91], v[12:15], v[152:155], v[88:91]
    ds_read2_b32 v[158:159], v45 offset0:210 offset1:211
    s_waitcnt lgkmcnt(8)
    v_mfma_f32_16x16x32_bf16 v[88:91], v[48:51], v[148:151], v[88:91]
    ds_read_b128 v[116:119], v55 offset:0
    v_mfma_f32_16x16x32_bf16 v[92:95], v[48:51], v[152:155], v[92:95]
    ds_read2_b32 v[160:161], v45 offset0:80 offset1:81
    s_waitcnt lgkmcnt(9)
    v_mfma_f32_16x16x32_bf16 v[92:95], v[60:63], v[148:151], v[92:95]
    ds_read2_b32 v[162:163], v45 offset0:82 offset1:83
    v_mfma_f32_16x16x32_bf16 v[96:99], v[60:63], v[152:155], v[96:99]
    ds_read_b128 v[120:123], v55 offset:528
    s_waitcnt lgkmcnt(10)
    v_mfma_f32_16x16x32_bf16 v[96:99], v[64:67], v[148:151], v[96:99]
    ds_read_b128 v[124:127], v55 offset:1056
    v_mfma_f32_16x16x32_bf16 v[100:103], v[64:67], v[152:155], v[100:103]
    ds_read_b128 v[128:131], v55 offset:1584
    s_waitcnt lgkmcnt(11)
    v_mfma_f32_16x16x32_bf16 v[100:103], v[68:71], v[148:151], v[100:103]
    ds_read_b128 v[132:135], v55 offset:2112
    v_mfma_f32_16x16x32_bf16 v[104:107], v[68:71], v[152:155], v[104:107]
    ds_read_b128 v[136:139], v55 offset:2640
    s_waitcnt lgkmcnt(12)
    v_mfma_f32_16x16x32_bf16 v[104:107], v[72:75], v[148:151], v[104:107]
    ds_read_b128 v[140:143], v55 offset:3168
    v_mfma_f32_16x16x32_bf16 v[108:111], v[72:75], v[152:155], v[108:111]
    ds_read_b128 v[144:147], v55 offset:3696
    s_waitcnt lgkmcnt(13)
    v_mfma_f32_16x16x32_bf16 v[108:111], v[76:79], v[148:151], v[108:111]
    v_mfma_f32_16x16x32_bf16 v[112:115], v[76:79], v[152:155], v[112:115]
    s_waitcnt lgkmcnt(12)
    v_mfma_f32_16x16x32_bf16 v[112:115], v[80:83], v[148:151], v[112:115]
    s_waitcnt lgkmcnt(9)
    v_mfma_f32_16x16x32_bf16 v[84:87], v[116:119], v[156:159], v[84:87]
    ds_read2_b32 v[148:149], v45 offset0:192 offset1:193
    s_waitcnt lgkmcnt(8)
    v_mfma_f32_16x16x32_bf16 v[88:91], v[116:119], v[160:163], v[88:91]
    ds_read2_b32 v[150:151], v45 offset0:194 offset1:195
    s_waitcnt lgkmcnt(8)
    v_mfma_f32_16x16x32_bf16 v[88:91], v[120:123], v[156:159], v[88:91]
    ds_read_b128 v[12:15], v56 offset:0
    v_mfma_f32_16x16x32_bf16 v[92:95], v[120:123], v[160:163], v[92:95]
    ds_read2_b32 v[152:153], v45 offset0:64 offset1:65
    s_waitcnt lgkmcnt(9)
    v_mfma_f32_16x16x32_bf16 v[92:95], v[124:127], v[156:159], v[92:95]
    ds_read2_b32 v[154:155], v45 offset0:66 offset1:67
    v_mfma_f32_16x16x32_bf16 v[96:99], v[124:127], v[160:163], v[96:99]
    ds_read_b128 v[48:51], v56 offset:528
    s_waitcnt lgkmcnt(10)
    v_mfma_f32_16x16x32_bf16 v[96:99], v[128:131], v[156:159], v[96:99]
    ds_read_b128 v[60:63], v56 offset:1056
    v_mfma_f32_16x16x32_bf16 v[100:103], v[128:131], v[160:163], v[100:103]
    ds_read_b128 v[64:67], v56 offset:1584
    s_waitcnt lgkmcnt(11)
    v_mfma_f32_16x16x32_bf16 v[100:103], v[132:135], v[156:159], v[100:103]
    ds_read_b128 v[68:71], v56 offset:2112
    v_mfma_f32_16x16x32_bf16 v[104:107], v[132:135], v[160:163], v[104:107]
    ds_read_b128 v[72:75], v56 offset:2640
    s_waitcnt lgkmcnt(12)
    v_mfma_f32_16x16x32_bf16 v[104:107], v[136:139], v[156:159], v[104:107]
    ds_read_b128 v[76:79], v56 offset:3168
    v_mfma_f32_16x16x32_bf16 v[108:111], v[136:139], v[160:163], v[108:111]
    ds_read_b128 v[80:83], v56 offset:3696
    s_waitcnt lgkmcnt(13)
    v_mfma_f32_16x16x32_bf16 v[108:111], v[140:143], v[156:159], v[108:111]
    v_mfma_f32_16x16x32_bf16 v[112:115], v[140:143], v[160:163], v[112:115]
    s_waitcnt lgkmcnt(12)
    v_mfma_f32_16x16x32_bf16 v[112:115], v[144:147], v[156:159], v[112:115]
    s_waitcnt lgkmcnt(9)
    v_mfma_f32_16x16x32_bf16 v[84:87], v[12:15], v[148:151], v[84:87]
    ds_read2_b32 v[156:157], v45 offset0:176 offset1:177
    s_waitcnt lgkmcnt(8)
    v_mfma_f32_16x16x32_bf16 v[88:91], v[12:15], v[152:155], v[88:91]
    ds_read2_b32 v[158:159], v45 offset0:178 offset1:179
    s_waitcnt lgkmcnt(8)
    v_mfma_f32_16x16x32_bf16 v[88:91], v[48:51], v[148:151], v[88:91]
    ds_read_b128 v[116:119], v57 offset:0
    v_mfma_f32_16x16x32_bf16 v[92:95], v[48:51], v[152:155], v[92:95]
    ds_read2_b32 v[160:161], v45 offset0:48 offset1:49
    s_waitcnt lgkmcnt(9)
    v_mfma_f32_16x16x32_bf16 v[92:95], v[60:63], v[148:151], v[92:95]
    ds_read2_b32 v[162:163], v45 offset0:50 offset1:51
    v_mfma_f32_16x16x32_bf16 v[96:99], v[60:63], v[152:155], v[96:99]
    ds_read_b128 v[120:123], v57 offset:528
    s_waitcnt lgkmcnt(10)
    v_mfma_f32_16x16x32_bf16 v[96:99], v[64:67], v[148:151], v[96:99]
    ds_read_b128 v[124:127], v57 offset:1056
    v_mfma_f32_16x16x32_bf16 v[100:103], v[64:67], v[152:155], v[100:103]
    ds_read_b128 v[128:131], v57 offset:1584
    s_waitcnt lgkmcnt(11)
    v_mfma_f32_16x16x32_bf16 v[100:103], v[68:71], v[148:151], v[100:103]
    ds_read_b128 v[132:135], v57 offset:2112
    v_mfma_f32_16x16x32_bf16 v[104:107], v[68:71], v[152:155], v[104:107]
    ds_read_b128 v[136:139], v57 offset:2640
    s_waitcnt lgkmcnt(12)
    v_mfma_f32_16x16x32_bf16 v[104:107], v[72:75], v[148:151], v[104:107]
    ds_read_b128 v[140:143], v57 offset:3168
    v_mfma_f32_16x16x32_bf16 v[108:111], v[72:75], v[152:155], v[108:111]
    ds_read_b128 v[144:147], v57 offset:3696
    s_waitcnt lgkmcnt(13)
    v_mfma_f32_16x16x32_bf16 v[108:111], v[76:79], v[148:151], v[108:111]
    v_mfma_f32_16x16x32_bf16 v[112:115], v[76:79], v[152:155], v[112:115]
    s_waitcnt lgkmcnt(12)
    v_mfma_f32_16x16x32_bf16 v[112:115], v[80:83], v[148:151], v[112:115]
    s_waitcnt lgkmcnt(9)
    v_mfma_f32_16x16x32_bf16 v[84:87], v[116:119], v[156:159], v[84:87]
    ds_read2_b32 v[148:149], v45 offset0:160 offset1:161
    s_waitcnt lgkmcnt(8)
    v_mfma_f32_16x16x32_bf16 v[88:91], v[116:119], v[160:163], v[88:91]
    ds_read2_b32 v[150:151], v45 offset0:162 offset1:163
    s_waitcnt lgkmcnt(8)
    v_mfma_f32_16x16x32_bf16 v[88:91], v[120:123], v[156:159], v[88:91]
    ds_read_b128 v[12:15], v58 offset:0
    v_mfma_f32_16x16x32_bf16 v[92:95], v[120:123], v[160:163], v[92:95]
    ds_read2_b32 v[152:153], v45 offset0:32 offset1:33
    s_waitcnt lgkmcnt(9)
    v_mfma_f32_16x16x32_bf16 v[92:95], v[124:127], v[156:159], v[92:95]
    ds_read2_b32 v[154:155], v45 offset0:34 offset1:35
    v_mfma_f32_16x16x32_bf16 v[96:99], v[124:127], v[160:163], v[96:99]
    ds_read_b128 v[48:51], v58 offset:528
    s_waitcnt lgkmcnt(10)
    v_mfma_f32_16x16x32_bf16 v[96:99], v[128:131], v[156:159], v[96:99]
    ds_read_b128 v[60:63], v58 offset:1056
    v_mfma_f32_16x16x32_bf16 v[100:103], v[128:131], v[160:163], v[100:103]
    ds_read_b128 v[64:67], v58 offset:1584
    s_waitcnt lgkmcnt(11)
    v_mfma_f32_16x16x32_bf16 v[100:103], v[132:135], v[156:159], v[100:103]
    ds_read_b128 v[68:71], v58 offset:2112
    v_mfma_f32_16x16x32_bf16 v[104:107], v[132:135], v[160:163], v[104:107]
    ds_read_b128 v[72:75], v58 offset:2640
    s_waitcnt lgkmcnt(12)
    v_mfma_f32_16x16x32_bf16 v[104:107], v[136:139], v[156:159], v[104:107]
    ds_read_b128 v[76:79], v58 offset:3168
    v_mfma_f32_16x16x32_bf16 v[108:111], v[136:139], v[160:163], v[108:111]
    ds_read_b128 v[80:83], v58 offset:3696
    s_waitcnt lgkmcnt(13)
    v_mfma_f32_16x16x32_bf16 v[108:111], v[140:143], v[156:159], v[108:111]
    v_mfma_f32_16x16x32_bf16 v[112:115], v[140:143], v[160:163], v[112:115]
    s_waitcnt lgkmcnt(12)
    v_mfma_f32_16x16x32_bf16 v[112:115], v[144:147], v[156:159], v[112:115]
    s_waitcnt lgkmcnt(9)
    v_mfma_f32_16x16x32_bf16 v[84:87], v[12:15], v[148:151], v[84:87]
    ds_read2_b32 v[156:157], v45 offset0:144 offset1:145
    s_waitcnt lgkmcnt(8)
    v_mfma_f32_16x16x32_bf16 v[88:91], v[12:15], v[152:155], v[88:91]
    ds_read2_b32 v[158:159], v45 offset0:146 offset1:147
    s_waitcnt lgkmcnt(8)
    v_mfma_f32_16x16x32_bf16 v[88:91], v[48:51], v[148:151], v[88:91]
    ds_read_b128 v[116:119], v59 offset:0
    v_mfma_f32_16x16x32_bf16 v[92:95], v[48:51], v[152:155], v[92:95]
    ds_read2_b32 v[160:161], v45 offset0:16 offset1:17
    s_waitcnt lgkmcnt(9)
    v_mfma_f32_16x16x32_bf16 v[92:95], v[60:63], v[148:151], v[92:95]
    ds_read2_b32 v[162:163], v45 offset0:18 offset1:19
    v_mfma_f32_16x16x32_bf16 v[96:99], v[60:63], v[152:155], v[96:99]
    ds_read_b128 v[120:123], v59 offset:528
    s_waitcnt lgkmcnt(10)
    v_mfma_f32_16x16x32_bf16 v[96:99], v[64:67], v[148:151], v[96:99]
    ds_read_b128 v[124:127], v59 offset:1056
    v_mfma_f32_16x16x32_bf16 v[100:103], v[64:67], v[152:155], v[100:103]
    ds_read_b128 v[128:131], v59 offset:1584
    s_waitcnt lgkmcnt(11)
    v_mfma_f32_16x16x32_bf16 v[100:103], v[68:71], v[148:151], v[100:103]
    ds_read_b128 v[132:135], v59 offset:2112
    v_mfma_f32_16x16x32_bf16 v[104:107], v[68:71], v[152:155], v[104:107]
    ds_read_b128 v[136:139], v59 offset:2640
    s_waitcnt lgkmcnt(12)
    v_mfma_f32_16x16x32_bf16 v[104:107], v[72:75], v[148:151], v[104:107]
    ds_read_b128 v[140:143], v59 offset:3168
    v_mfma_f32_16x16x32_bf16 v[108:111], v[72:75], v[152:155], v[108:111]
    ds_read_b128 v[144:147], v59 offset:3696
    s_waitcnt lgkmcnt(13)
    v_mfma_f32_16x16x32_bf16 v[108:111], v[76:79], v[148:151], v[108:111]
    v_mfma_f32_16x16x32_bf16 v[112:115], v[76:79], v[152:155], v[112:115]
    s_waitcnt lgkmcnt(12)
    v_mfma_f32_16x16x32_bf16 v[112:115], v[80:83], v[148:151], v[112:115]
    s_waitcnt lgkmcnt(9)
    v_mfma_f32_16x16x32_bf16 v[84:87], v[116:119], v[156:159], v[84:87]
    ds_read2_b32 v[148:149], v17 offset0:0 offset1:1
    s_waitcnt lgkmcnt(8)
    v_mfma_f32_16x16x32_bf16 v[88:91], v[116:119], v[160:163], v[88:91]
    ds_read2_b32 v[150:151], v17 offset0:2 offset1:3
    s_waitcnt lgkmcnt(8)
    v_mfma_f32_16x16x32_bf16 v[88:91], v[120:123], v[156:159], v[88:91]
    ds_read_b128 v[12:15], v52 offset:0
    v_mfma_f32_16x16x32_bf16 v[92:95], v[120:123], v[160:163], v[92:95]
    ds_read2_b32 v[152:153], v45 offset0:128 offset1:129
    s_waitcnt lgkmcnt(9)
    v_mfma_f32_16x16x32_bf16 v[92:95], v[124:127], v[156:159], v[92:95]
    ds_read2_b32 v[154:155], v45 offset0:130 offset1:131
    v_mfma_f32_16x16x32_bf16 v[96:99], v[124:127], v[160:163], v[96:99]
    ds_read_b128 v[48:51], v52 offset:528
    s_waitcnt lgkmcnt(10)
    v_mfma_f32_16x16x32_bf16 v[96:99], v[128:131], v[156:159], v[96:99]
    ds_read_b128 v[60:63], v52 offset:1056
    v_mfma_f32_16x16x32_bf16 v[100:103], v[128:131], v[160:163], v[100:103]
    ds_read_b128 v[64:67], v52 offset:1584
    s_waitcnt lgkmcnt(11)
    v_mfma_f32_16x16x32_bf16 v[100:103], v[132:135], v[156:159], v[100:103]
    ds_read_b128 v[68:71], v52 offset:2112
    v_mfma_f32_16x16x32_bf16 v[104:107], v[132:135], v[160:163], v[104:107]
    ds_read_b128 v[72:75], v52 offset:2640
    s_waitcnt lgkmcnt(12)
    v_mfma_f32_16x16x32_bf16 v[104:107], v[136:139], v[156:159], v[104:107]
    ds_read_b128 v[76:79], v52 offset:3168
    v_mfma_f32_16x16x32_bf16 v[108:111], v[136:139], v[160:163], v[108:111]
    ds_read_b128 v[80:83], v52 offset:3696
    s_waitcnt lgkmcnt(13)
    v_mfma_f32_16x16x32_bf16 v[108:111], v[140:143], v[156:159], v[108:111]
    v_mfma_f32_16x16x32_bf16 v[112:115], v[140:143], v[160:163], v[112:115]
    s_waitcnt lgkmcnt(12)
    v_mfma_f32_16x16x32_bf16 v[112:115], v[144:147], v[156:159], v[112:115]
    ds_read_b128 v[116:119], v44 offset:0
    ds_read_b128 v[120:123], v44 offset:528
    ds_read_b128 v[124:127], v44 offset:1056
    s_waitcnt lgkmcnt(11)
    ds_read_b128 v[128:131], v44 offset:1584
    ds_read_b128 v[132:135], v44 offset:2112
    v_mfma_f32_16x16x32_bf16 v[228:231], v[12:15], v[20:23], 0
    ds_read_b128 v[136:139], v44 offset:2640
    ds_read2_b32 v[156:157], v45 offset0:0 offset1:1
    v_mfma_f32_16x16x32_bf16 v[232:235], v[12:15], v[24:27], 0
    s_waitcnt lgkmcnt(11)
    ds_read2_b32 v[158:159], v45 offset0:2 offset1:3
    ds_read2_b32 v[160:161], v17 offset0:24 offset1:25
    v_mfma_f32_16x16x32_bf16 v[236:239], v[12:15], v[28:31], 0
    ds_read2_b32 v[162:163], v17 offset0:26 offset1:27
    v_mfma_f32_16x16x32_bf16 v[240:243], v[12:15], v[36:39], 0
    v_cvt_pk_bf16_f32 v164, v228, v229
    v_cvt_pk_bf16_f32 v165, v230, v231
    v_mfma_f32_16x16x32_bf16 v[228:231], v[48:51], v[20:23], 0
    v_cvt_pk_bf16_f32 v166, v232, v233
    v_cvt_pk_bf16_f32 v167, v234, v235
    v_mfma_f32_16x16x32_bf16 v[232:235], v[48:51], v[24:27], 0
    v_cvt_pk_bf16_f32 v188, v236, v237
    v_cvt_pk_bf16_f32 v189, v238, v239
    v_mfma_f32_16x16x32_bf16 v[236:239], v[48:51], v[28:31], 0
    v_cvt_pk_bf16_f32 v212, v240, v241
    v_cvt_pk_bf16_f32 v213, v242, v243
    v_mfma_f32_16x16x32_bf16 v[240:243], v[48:51], v[36:39], 0
    v_cvt_pk_bf16_f32 v168, v228, v229
    v_cvt_pk_bf16_f32 v169, v230, v231
    v_mfma_f32_16x16x32_bf16 v[228:231], v[60:63], v[20:23], 0
    v_cvt_pk_bf16_f32 v170, v232, v233
    v_cvt_pk_bf16_f32 v171, v234, v235
    v_mfma_f32_16x16x32_bf16 v[232:235], v[60:63], v[24:27], 0
    v_cvt_pk_bf16_f32 v192, v236, v237
    v_cvt_pk_bf16_f32 v193, v238, v239
    v_mfma_f32_16x16x32_bf16 v[236:239], v[60:63], v[28:31], 0
    v_cvt_pk_bf16_f32 v216, v240, v241
    v_cvt_pk_bf16_f32 v217, v242, v243
    v_mfma_f32_16x16x32_bf16 v[240:243], v[60:63], v[36:39], 0
    v_cvt_pk_bf16_f32 v172, v228, v229
    v_cvt_pk_bf16_f32 v173, v230, v231
    v_mfma_f32_16x16x32_bf16 v[228:231], v[64:67], v[20:23], 0
    v_cvt_pk_bf16_f32 v174, v232, v233
    v_cvt_pk_bf16_f32 v175, v234, v235
    v_mfma_f32_16x16x32_bf16 v[232:235], v[64:67], v[24:27], 0
    v_cvt_pk_bf16_f32 v196, v236, v237
    v_cvt_pk_bf16_f32 v197, v238, v239
    v_mfma_f32_16x16x32_bf16 v[236:239], v[64:67], v[28:31], 0
    v_cvt_pk_bf16_f32 v220, v240, v241
    v_cvt_pk_bf16_f32 v221, v242, v243
    v_mfma_f32_16x16x32_bf16 v[240:243], v[64:67], v[36:39], 0
    v_cvt_pk_bf16_f32 v176, v228, v229
    v_cvt_pk_bf16_f32 v177, v230, v231
    s_waitcnt lgkmcnt(13)
    v_mfma_f32_16x16x32_bf16 v[228:231], v[68:71], v[20:23], 0
    v_cvt_pk_bf16_f32 v178, v232, v233
    v_cvt_pk_bf16_f32 v179, v234, v235
    v_mfma_f32_16x16x32_bf16 v[232:235], v[68:71], v[24:27], 0
    v_cvt_pk_bf16_f32 v200, v236, v237
    v_cvt_pk_bf16_f32 v201, v238, v239
    v_mfma_f32_16x16x32_bf16 v[236:239], v[68:71], v[28:31], 0
    v_cvt_pk_bf16_f32 v224, v240, v241
    v_cvt_pk_bf16_f32 v225, v242, v243
    s_waitcnt lgkmcnt(12)
    v_mfma_f32_16x16x32_bf16 v[240:243], v[72:75], v[20:23], 0
    v_cvt_pk_bf16_f32 v180, v228, v229
    v_cvt_pk_bf16_f32 v181, v230, v231
    v_mfma_f32_16x16x32_bf16 v[228:231], v[72:75], v[24:27], 0
    v_cvt_pk_bf16_f32 v182, v232, v233
    v_cvt_pk_bf16_f32 v183, v234, v235
    v_mfma_f32_16x16x32_bf16 v[232:235], v[72:75], v[28:31], 0
    v_cvt_pk_bf16_f32 v204, v236, v237
    v_cvt_pk_bf16_f32 v205, v238, v239
    s_waitcnt lgkmcnt(9)
    v_mfma_f32_16x16x32_bf16 v[236:239], v[116:119], v[32:35], 0
    v_cvt_pk_bf16_f32 v184, v240, v241
    v_cvt_pk_bf16_f32 v185, v242, v243
    v_mfma_f32_16x16x32_bf16 v[240:243], v[116:119], v[40:43], 0
    v_cvt_pk_bf16_f32 v186, v228, v229
    v_cvt_pk_bf16_f32 v187, v230, v231
    s_waitcnt lgkmcnt(8)
    v_mfma_f32_16x16x32_bf16 v[228:231], v[120:123], v[32:35], 0
    v_cvt_pk_bf16_f32 v208, v232, v233
    v_cvt_pk_bf16_f32 v209, v234, v235
    v_mfma_f32_16x16x32_bf16 v[232:235], v[120:123], v[40:43], 0
    v_cvt_pk_bf16_f32 v190, v236, v237
    v_cvt_pk_bf16_f32 v191, v238, v239
    s_waitcnt lgkmcnt(7)
    v_mfma_f32_16x16x32_bf16 v[236:239], v[124:127], v[32:35], 0
    v_cvt_pk_bf16_f32 v214, v240, v241
    v_cvt_pk_bf16_f32 v215, v242, v243
    v_mfma_f32_16x16x32_bf16 v[240:243], v[124:127], v[40:43], 0
    v_cvt_pk_bf16_f32 v194, v228, v229
    v_cvt_pk_bf16_f32 v195, v230, v231
    s_waitcnt lgkmcnt(6)
    v_mfma_f32_16x16x32_bf16 v[228:231], v[128:131], v[32:35], 0
    v_cvt_pk_bf16_f32 v218, v232, v233
    v_cvt_pk_bf16_f32 v219, v234, v235
    v_mfma_f32_16x16x32_bf16 v[232:235], v[128:131], v[40:43], 0
    v_cvt_pk_bf16_f32 v198, v236, v237
    v_cvt_pk_bf16_f32 v199, v238, v239
    s_waitcnt lgkmcnt(5)
    v_mfma_f32_16x16x32_bf16 v[236:239], v[132:135], v[32:35], 0
    v_cvt_pk_bf16_f32 v222, v240, v241
    v_cvt_pk_bf16_f32 v223, v242, v243
    s_waitcnt lgkmcnt(4)
    v_mfma_f32_16x16x32_bf16 v[240:243], v[136:139], v[32:35], 0
    v_cvt_pk_bf16_f32 v202, v228, v229
    v_cvt_pk_bf16_f32 v203, v230, v231
    s_lshl_b32 s35, s3, 2
    s_add_u32 s35, s35, s33
    s_cmp_lg_u32 s35, 100
    s_cbranch_scc1 Lfw14
    s_and_b32 s35, s2, 7
    s_lshl_b32 s35, s35, 4
    s_add_u32 s35, s35, 28672
    v_mov_b32 v10, s32
    v_and_b32 v9, 7, v0
    v_lshlrev_b32 v9, 7, v9
    buffer_store_dword v10, v9, s[76:79], s35 offen sc1
Lfw14:
    v_mfma_f32_16x16x32_bf16 v[84:87], v[12:15], v[148:151], v[84:87]
    v_cvt_pk_bf16_f32 v226, v232, v233
    v_cvt_pk_bf16_f32 v227, v234, v235
    v_mfma_f32_16x16x32_bf16 v[88:91], v[12:15], v[152:155], v[88:91]
    v_cvt_pk_bf16_f32 v206, v236, v237
    v_cvt_pk_bf16_f32 v207, v238, v239
    v_mfma_f32_16x16x32_bf16 v[88:91], v[48:51], v[148:151], v[88:91]
    v_cvt_pk_bf16_f32 v210, v240, v241
    v_cvt_pk_bf16_f32 v211, v242, v243
    v_mfma_f32_16x16x32_bf16 v[92:95], v[48:51], v[152:155], v[92:95]
    ds_read2_b32 v[20:21], v46 offset0:16 offset1:17
    v_mfma_f32_16x16x32_bf16 v[92:95], v[60:63], v[148:151], v[92:95]
    ds_read2_b32 v[22:23], v46 offset0:48 offset1:49
    v_mfma_f32_16x16x32_bf16 v[96:99], v[60:63], v[152:155], v[96:99]
    ds_read2_b32 v[24:25], v46 offset0:80 offset1:81
    v_mfma_f32_16x16x32_bf16 v[96:99], v[64:67], v[148:151], v[96:99]
    ds_read2_b32 v[26:27], v46 offset0:112 offset1:113
    v_mfma_f32_16x16x32_bf16 v[100:103], v[64:67], v[152:155], v[100:103]
    ds_read2_b32 v[28:29], v46 offset0:8 offset1:9
    v_mfma_f32_16x16x32_bf16 v[100:103], v[68:71], v[148:151], v[100:103]
    ds_read2_b32 v[30:31], v46 offset0:40 offset1:41
    v_mfma_f32_16x16x32_bf16 v[104:107], v[68:71], v[152:155], v[104:107]
    ds_read2_b32 v[32:33], v46 offset0:72 offset1:73
    v_mfma_f32_16x16x32_bf16 v[104:107], v[72:75], v[148:151], v[104:107]
    ds_read2_b32 v[34:35], v46 offset0:104 offset1:105
    v_mfma_f32_16x16x32_bf16 v[108:111], v[72:75], v[152:155], v[108:111]
    ds_read2_b32 v[36:37], v46 offset0:0 offset1:1
    v_mfma_f32_16x16x32_bf16 v[108:111], v[76:79], v[148:151], v[108:111]
    ds_read2_b32 v[38:39], v46 offset0:32 offset1:33
    v_mfma_f32_16x16x32_bf16 v[112:115], v[76:79], v[152:155], v[112:115]
    ds_read2_b32 v[40:41], v46 offset0:64 offset1:65
    v_mfma_f32_16x16x32_bf16 v[112:115], v[80:83], v[148:151], v[112:115]
    s_waitcnt lgkmcnt(11)
    ds_read2_b32 v[42:43], v46 offset0:96 offset1:97
    v_mfma_f32_16x16x32_bf16 v[92:95], v[12:15], v[156:159], v[92:95]
    ds_read2_b32 v[228:229], v46 offset0:152 offset1:153
    v_mfma_f32_16x16x32_bf16 v[96:99], v[48:51], v[156:159], v[96:99]
    ds_read2_b32 v[230:231], v46 offset0:192 offset1:193
    v_mfma_f32_16x16x32_bf16 v[100:103], v[60:63], v[156:159], v[100:103]
    ds_read2_b32 v[232:233], v46 offset0:144 offset1:145
    v_mfma_f32_16x16x32_bf16 v[104:107], v[64:67], v[156:159], v[104:107]
    s_waitcnt lgkmcnt(11)
    ds_read2_b32 v[234:235], v46 offset0:184 offset1:185
    v_mfma_f32_16x16x32_bf16 v[108:111], v[68:71], v[156:159], v[108:111]
    ds_read2_b32 v[236:237], v46 offset0:136 offset1:137
    v_mfma_f32_16x16x32_bf16 v[112:115], v[72:75], v[156:159], v[112:115]
    ds_read2_b32 v[238:239], v46 offset0:176 offset1:177
    v_mfma_f32_16x16x32_bf16 v[100:103], v[12:15], v[160:163], v[100:103]
    ds_read2_b32 v[240:241], v46 offset0:128 offset1:129
    v_mfma_f32_16x16x32_bf16 v[104:107], v[48:51], v[160:163], v[104:107]
    s_waitcnt lgkmcnt(11)
    ds_read2_b32 v[242:243], v46 offset0:168 offset1:169
    v_mfma_f32_16x16x32_bf16 v[108:111], v[60:63], v[160:163], v[108:111]
    v_mfma_f32_16x16x32_bf16 v[112:115], v[64:67], v[160:163], v[112:115]
    v_mfma_f32_16x16x32_bf16 v[92:95], v[20:23], v[164:167], v[92:95]
    v_mfma_f32_16x16x32_bf16 v[92:95], v[24:27], v[188:191], v[92:95]
    v_mfma_f32_16x16x32_bf16 v[96:99], v[20:23], v[168:171], v[96:99]
    v_cvt_pk_bf16_f32 v12, v84, v88
    v_cvt_pk_bf16_f32 v13, v85, v89
    v_mfma_f32_16x16x32_bf16 v[96:99], v[24:27], v[192:195], v[96:99]
    v_cvt_pk_bf16_f32 v14, v86, v90
    v_cvt_pk_bf16_f32 v15, v87, v91
    v_mfma_f32_16x16x32_bf16 v[96:99], v[28:31], v[164:167], v[96:99]
    ds_write_addtid_b32 v12 offset:0
    ds_write_addtid_b32 v13 offset:256
    ds_write_addtid_b32 v14 offset:512
    s_waitcnt lgkmcnt(11)
    ds_write_addtid_b32 v15 offset:768
    v_mfma_f32_16x16x32_bf16 v[96:99], v[32:35], v[188:191], v[96:99]
    v_mfma_f32_16x16x32_bf16 v[100:103], v[20:23], v[172:175], v[100:103]
    v_mfma_f32_16x16x32_bf16 v[100:103], v[24:27], v[196:199], v[100:103]
    v_mfma_f32_16x16x32_bf16 v[100:103], v[28:31], v[168:171], v[100:103]
    v_mfma_f32_16x16x32_bf16 v[100:103], v[32:35], v[192:195], v[100:103]
    s_nop 3
    v_cvt_pk_bf16_f32 v48, v92, v96
    v_cvt_pk_bf16_f32 v49, v93, v97
    v_mfma_f32_16x16x32_bf16 v[100:103], v[36:39], v[164:167], v[100:103]
    v_cvt_pk_bf16_f32 v50, v94, v98
    v_cvt_pk_bf16_f32 v51, v95, v99
    v_mfma_f32_16x16x32_bf16 v[100:103], v[40:43], v[188:191], v[100:103]
    ds_write_addtid_b32 v48 offset:3104
    ds_write_addtid_b32 v49 offset:3360
    ds_write_addtid_b32 v50 offset:3616
    s_waitcnt lgkmcnt(11)
    ds_write_addtid_b32 v51 offset:3872
    v_mfma_f32_16x16x32_bf16 v[100:103], v[228:231], v[212:215], v[100:103]
    v_mfma_f32_16x16x32_bf16 v[104:107], v[20:23], v[176:179], v[104:107]
    v_mfma_f32_16x16x32_bf16 v[104:107], v[24:27], v[200:203], v[104:107]
    v_mfma_f32_16x16x32_bf16 v[104:107], v[28:31], v[172:175], v[104:107]
    v_mfma_f32_16x16x32_bf16 v[104:107], v[32:35], v[196:199], v[104:107]
    v_mfma_f32_16x16x32_bf16 v[104:107], v[36:39], v[168:171], v[104:107]
    v_mfma_f32_16x16x32_bf16 v[104:107], v[40:43], v[192:195], v[104:107]
    v_mfma_f32_16x16x32_bf16 v[104:107], v[228:231], v[216:219], v[104:107]
    v_mfma_f32_16x16x32_bf16 v[104:107], v[232:235], v[212:215], v[104:107]
    v_mfma_f32_16x16x32_bf16 v[108:111], v[20:23], v[180:183], v[108:111]
    v_mfma_f32_16x16x32_bf16 v[108:111], v[24:27], v[204:207], v[108:111]
    v_mfma_f32_16x16x32_bf16 v[108:111], v[28:31], v[176:179], v[108:111]
    v_mfma_f32_16x16x32_bf16 v[108:111], v[32:35], v[200:203], v[108:111]
    s_nop 3
    v_cvt_pk_bf16_f32 v60, v100, v104
    v_cvt_pk_bf16_f32 v61, v101, v105
    v_mfma_f32_16x16x32_bf16 v[108:111], v[36:39], v[172:175], v[108:111]
    v_cvt_pk_bf16_f32 v62, v102, v106
    v_cvt_pk_bf16_f32 v63, v103, v107
    v_mfma_f32_16x16x32_bf16 v[108:111], v[40:43], v[196:199], v[108:111]
    ds_write_addtid_b32 v60 offset:6208
    ds_write_addtid_b32 v61 offset:6464
    ds_write_addtid_b32 v62 offset:6720
    s_waitcnt lgkmcnt(11)
    ds_write_addtid_b32 v63 offset:6976
    v_mfma_f32_16x16x32_bf16 v[108:111], v[228:231], v[220:223], v[108:111]
    v_mfma_f32_16x16x32_bf16 v[108:111], v[232:235], v[216:219], v[108:111]
    v_mfma_f32_16x16x32_bf16 v[108:111], v[236:239], v[212:215], v[108:111]
    v_mfma_f32_16x16x32_bf16 v[112:115], v[20:23], v[184:187], v[112:115]
    v_mfma_f32_16x16x32_bf16 v[112:115], v[24:27], v[208:211], v[112:115]
    v_mfma_f32_16x16x32_bf16 v[112:115], v[28:31], v[180:183], v[112:115]
    v_mfma_f32_16x16x32_bf16 v[112:115], v[32:35], v[204:207], v[112:115]
    v_mfma_f32_16x16x32_bf16 v[112:115], v[36:39], v[176:179], v[112:115]
    v_mfma_f32_16x16x32_bf16 v[112:115], v[40:43], v[200:203], v[112:115]
    v_mfma_f32_16x16x32_bf16 v[112:115], v[228:231], v[224:227], v[112:115]
    v_mfma_f32_16x16x32_bf16 v[112:115], v[232:235], v[220:223], v[112:115]
    v_mfma_f32_16x16x32_bf16 v[112:115], v[236:239], v[216:219], v[112:115]
    v_mfma_f32_16x16x32_bf16 v[112:115], v[240:243], v[212:215], v[112:115]
    s_nop 7
    v_cvt_pk_bf16_f32 v64, v108, v112
    v_cvt_pk_bf16_f32 v65, v109, v113
    v_cvt_pk_bf16_f32 v66, v110, v114
    v_cvt_pk_bf16_f32 v67, v111, v115
    ds_write_addtid_b32 v64 offset:9312
    ds_write_addtid_b32 v65 offset:9568
    ds_write_addtid_b32 v66 offset:9824
    s_waitcnt lgkmcnt(11)
    ds_write_addtid_b32 v67 offset:10080
    s_branch LA_noconv
LA_w3b:
    s_setprio 0
    s_waitcnt lgkmcnt(0)
    s_barrier
LA_noconv:
    v_mov_b32 v15, s32
    v_mov_b32 v51, s32
    v_mov_b32 v63, s32
    v_mov_b32 v67, s32
    s_waitcnt lgkmcnt(0)
    s_barrier
    ds_read2st64_b32 v[12:13], v11 offset0:0 offset1:4
    ds_read_b32 v14, v11 offset:2048
    ds_read2st64_b32 v[48:49], v11 offset0:1 offset1:5
    ds_read_b32 v50, v11 offset:2304
    ds_read2st64_b32 v[60:61], v11 offset0:2 offset1:6
    ds_read_b32 v62, v11 offset:2560
    ds_read2st64_b32 v[64:65], v11 offset0:3 offset1:7
    ds_read_b32 v66, v11 offset:2816
    s_waitcnt lgkmcnt(6)
    buffer_store_dwordx4 v[12:15], v16, s[44:47], s56 offen sc1
    s_waitcnt lgkmcnt(4)
    buffer_store_dwordx4 v[48:51], v16, s[44:47], s57 offen sc1
    s_waitcnt lgkmcnt(2)
    buffer_store_dwordx4 v[60:63], v16, s[44:47], s58 offen sc1
    s_waitcnt lgkmcnt(0)
    buffer_store_dwordx4 v[64:67], v16, s[44:47], s59 offen sc1
    s_cmp_lg_u32 s33, 0
    s_cbranch_scc1 Lfw15
    s_and_b32 s35, s2, 7
    s_lshl_b32 s66, s35, 5
    s_add_u32 s66, s66, s3
    s_lshl_b32 s66, s66, 2
    v_mov_b32 v5, 12288
    v_mov_b32 v6, s32
    buffer_store_dword v6, v5, s[76:79], s66 offen
Lfw15:
Lend:
    s_endpgm
Lcode_end:
.p2align 8
TabP:
.long 0x3f80,0x3f80,0x3f80,0x3f80,0x3f80,0x3ec43f6d,0x3f353f35,0x3f6d3ec4
.long 0x3f80,0x3f353f35,0x3f80248d,0x3f35bf35,0x3f80,0x3f6d3ec4,0x3f35bf35,0xbec4bf6d
.long 0x3f80,0x3f80248d,0x250dbf80,0xbf80a554,0x3f80,0x3f6dbec4,0xbf35bf35,0xbec43f6d
.long 0x3f80,0x3f35bf35,0xbf80a554,0x3f353f35,0x3f80,0x3ec4bf6d,0xbf353f35,0x3f6dbec4
.long 0x3f80,0x250dbf80,0x3f80,0x250dbf80,0x3f80,0xbec4bf6d,0x3f353f35,0xbf6dbec4
.long 0x3f80,0xbf35bf35,0x3f80248d,0xbf353f35,0x3f80,0xbf6dbec4,0x3f35bf35,0x3ec43f6d
.long 0x3f80,0xbf80a554,0x250dbf80,0x3f80248d,0x3f80,0xbf6d3ec4,0xbf35bf35,0x3ec4bf6d
.long 0x3f80,0xbf353f35,0xbf80a554,0xbf35bf35,0x3f80,0xbec43f6d,0xbf353f35,0xbf6d3ec4
.long 0x3f80,0x3f80,0x3f80,0x3f80,0x3f80248d,0x3f6dbec4,0x3f35bf35,0x3ec4bf6d
.long 0x250dbf80,0xbf35bf35,0xbf80a554,0xbf353f35,0xbf80a554,0xbec43f6d,0x3f353f35,0x3f6dbec4
.long 0x3f80,0x3f80248d,0x250dbf80,0xbf80a554,0x3f80248d,0xbec4bf6d,0xbf353f35,0x3f6d3ec4
.long 0x250dbf80,0xbf353f35,0x3f80248d,0xbf35bf35,0xbf80a554,0x3f6d3ec4,0xbf35bf35,0x3ec43f6d
.long 0x3f80,0x250dbf80,0x3f80,0x250dbf80,0x3f80248d,0xbf6d3ec4,0x3f35bf35,0xbec43f6d
.long 0x250dbf80,0x3f353f35,0xbf80a554,0x3f35bf35,0xbf80a554,0x3ec4bf6d,0x3f353f35,0xbf6d3ec4
.long 0x3f80,0xbf80a554,0x250dbf80,0x3f80248d,0x3f80248d,0x3ec43f6d,0xbf353f35,0xbf6dbec4
.long 0x250dbf80,0x3f35bf35,0x3f80248d,0x3f353f35,0xbf80a554,0xbf6dbec4,0xbf35bf35,0xbec4bf6d
.long 0x3f80,0x3f80,0x3f80,0x3f80,0x250dbf80,0xbec4bf6d,0xbf35bf35,0xbf6dbec4
.long 0x3f80,0x3f353f35,0x3f80248d,0x3f35bf35,0x250dbf80,0xbf6dbec4,0xbf353f35,0x3ec43f6d
.long 0x3f80,0x3f80248d,0x250dbf80,0xbf80a554,0x250dbf80,0xbf6d3ec4,0x3f353f35,0x3ec4bf6d
.long 0x3f80,0x3f35bf35,0xbf80a554,0x3f353f35,0x250dbf80,0xbec43f6d,0x3f35bf35,0xbf6d3ec4
.long 0x3f80,0x250dbf80,0x3f80,0x250dbf80,0x250dbf80,0x3ec43f6d,0xbf35bf35,0x3f6d3ec4
.long 0x3f80,0xbf35bf35,0x3f80248d,0xbf353f35,0x250dbf80,0x3f6d3ec4,0xbf353f35,0xbec4bf6d
.long 0x3f80,0xbf80a554,0x250dbf80,0x3f80248d,0x250dbf80,0x3f6dbec4,0x3f353f35,0xbec43f6d
.long 0x3f80,0xbf353f35,0xbf80a554,0xbf35bf35,0x250dbf80,0x3ec4bf6d,0x3f35bf35,0x3f6dbec4
.long 0x3f80,0x3f80,0x3f80,0x3f80,0xbf80a554,0xbf6d3ec4,0xbf353f35,0xbec43f6d
.long 0x250dbf80,0xbf35bf35,0xbf80a554,0xbf353f35,0x3f80248d,0x3ec4bf6d,0xbf35bf35,0xbf6d3ec4
.long 0x3f80,0x3f80248d,0x250dbf80,0xbf80a554,0xbf80a554,0x3ec43f6d,0x3f35bf35,0xbf6dbec4
.long 0x250dbf80,0xbf353f35,0x3f80248d,0xbf35bf35,0x3f80248d,0xbf6dbec4,0x3f353f35,0xbec4bf6d
.long 0x3f80,0x250dbf80,0x3f80,0x250dbf80,0xbf80a554,0x3f6dbec4,0xbf353f35,0x3ec4bf6d
.long 0x250dbf80,0x3f353f35,0xbf80a554,0x3f35bf35,0x3f80248d,0xbec43f6d,0xbf35bf35,0x3f6dbec4
.long 0x3f80,0xbf80a554,0x250dbf80,0x3f80248d,0xbf80a554,0xbec4bf6d,0x3f35bf35,0x3f6d3ec4
.long 0x250dbf80,0x3f35bf35,0x3f80248d,0x3f353f35,0x3f80248d,0x3f6d3ec4,0x3f353f35,0x3ec43f6d
.long 0x3f808000,0x3f808000,0x3f808000,0x3f808000,0x3f808000,0x3f6dbec4,0x3f35bf35,0x3ec4bf6d
.long 0x3f808000,0x3f35bf35,0x248dbf80,0xbf35bf35,0x3f808000,0x3ec4bf6d,0xbf35bf35,0xbf6d3ec4
.long 0x3f808000,0x248dbf80,0xbf80a50d,0xa5543f80,0x3f808000,0xbec4bf6d,0xbf353f35,0x3f6d3ec4
.long 0x3f808000,0xbf35bf35,0xa5543f80,0x3f35bf35,0x3f808000,0xbf6dbec4,0x3f353f35,0xbec4bf6d
.long 0x3f808000,0xbf80a50d,0x3f808000,0xbf80a50d,0x3f808000,0xbf6d3ec4,0x3f35bf35,0xbec43f6d
.long 0x3f808000,0xbf353f35,0x248dbf80,0x3f353f35,0x3f808000,0xbec43f6d,0xbf35bf35,0x3f6dbec4
.long 0x3f808000,0xa5543f80,0xbf80a50d,0x248dbf80,0x3f808000,0x3ec43f6d,0xbf353f35,0xbf6dbec4
.long 0x3f808000,0x3f353f35,0xa5543f80,0xbf353f35,0x3f808000,0x3f6d3ec4,0x3f353f35,0x3ec43f6d
.long 0x3f808000,0x3f808000,0x3f808000,0x3f808000,0x248dbf80,0xbec4bf6d,0xbf35bf35,0xbf6dbec4
.long 0xbf80a50d,0xbf353f35,0xa5543f80,0x3f353f35,0xa5543f80,0x3f6d3ec4,0x3f35bf35,0xbec4bf6d
.long 0x3f808000,0x248dbf80,0xbf80a50d,0xa5543f80,0x248dbf80,0xbf6d3ec4,0x3f353f35,0x3ec4bf6d
.long 0xbf80a50d,0x3f353f35,0x248dbf80,0xbf353f35,0xa5543f80,0x3ec4bf6d,0xbf353f35,0x3f6dbec4
.long 0x3f808000,0xbf80a50d,0x3f808000,0xbf80a50d,0x248dbf80,0x3ec43f6d,0xbf35bf35,0x3f6d3ec4
.long 0xbf80a50d,0x3f35bf35,0xa5543f80,0xbf35bf35,0xa5543f80,0xbf6dbec4,0x3f35bf35,0x3ec43f6d
.long 0x3f808000,0xa5543f80,0xbf80a50d,0x248dbf80,0x248dbf80,0x3f6dbec4,0x3f353f35,0xbec43f6d
.long 0xbf80a50d,0xbf35bf35,0x248dbf80,0x3f35bf35,0xa5543f80,0xbec43f6d,0xbf353f35,0xbf6d3ec4
.long 0x3f808000,0x3f808000,0x3f808000,0x3f808000,0xbf80a50d,0xbf6d3ec4,0xbf353f35,0xbec43f6d
.long 0x3f808000,0x3f35bf35,0x248dbf80,0xbf35bf35,0xbf80a50d,0xbec43f6d,0x3f353f35,0x3f6dbec4
.long 0x3f808000,0x248dbf80,0xbf80a50d,0xa5543f80,0xbf80a50d,0x3ec43f6d,0x3f35bf35,0xbf6dbec4
.long 0x3f808000,0xbf35bf35,0xa5543f80,0x3f35bf35,0xbf80a50d,0x3f6d3ec4,0xbf35bf35,0x3ec43f6d
.long 0x3f808000,0xbf80a50d,0x3f808000,0xbf80a50d,0xbf80a50d,0x3f6dbec4,0xbf353f35,0x3ec4bf6d
.long 0x3f808000,0xbf353f35,0x248dbf80,0x3f353f35,0xbf80a50d,0x3ec4bf6d,0x3f353f35,0xbf6d3ec4
.long 0x3f808000,0xa5543f80,0xbf80a50d,0x248dbf80,0xbf80a50d,0xbec4bf6d,0x3f35bf35,0x3f6d3ec4
.long 0x3f808000,0x3f353f35,0xa5543f80,0xbf353f35,0xbf80a50d,0xbf6dbec4,0xbf35bf35,0xbec4bf6d
.long 0x3f808000,0x3f808000,0x3f808000,0x3f808000,0xa5543f80,0x3ec43f6d,0x3f353f35,0x3f6d3ec4
.long 0xbf80a50d,0xbf353f35,0xa5543f80,0x3f353f35,0x248dbf80,0xbf6dbec4,0xbf353f35,0x3ec43f6d
.long 0x3f808000,0x248dbf80,0xbf80a50d,0xa5543f80,0xa5543f80,0x3f6dbec4,0xbf35bf35,0xbec43f6d
.long 0xbf80a50d,0x3f353f35,0x248dbf80,0xbf353f35,0x248dbf80,0xbec43f6d,0x3f35bf35,0xbf6d3ec4
.long 0x3f808000,0xbf80a50d,0x3f808000,0xbf80a50d,0xa5543f80,0xbec4bf6d,0x3f353f35,0xbf6dbec4
.long 0xbf80a50d,0x3f35bf35,0xa5543f80,0xbf35bf35,0x248dbf80,0x3f6d3ec4,0xbf353f35,0xbec4bf6d
.long 0x3f808000,0xa5543f80,0xbf80a50d,0x248dbf80,0xa5543f80,0xbf6d3ec4,0xbf35bf35,0x3ec4bf6d
.long 0xbf80a50d,0xbf35bf35,0x248dbf80,0x3f35bf35,0x248dbf80,0x3ec4bf6d,0x3f35bf35,0x3f6dbec4
.long 0x80003f80,0x80003f80,0x80003f80,0x80003f80,0x80003f80,0xbec43f6d,0xbf353f35,0xbf6d3ec4
.long 0x80003f80,0xbf353f35,0xbf80248d,0xbf35bf35,0x80003f80,0xbf6d3ec4,0xbf35bf35,0x3ec4bf6d
.long 0x80003f80,0xbf80248d,0xa50dbf80,0x3f80a554,0x80003f80,0xbf6dbec4,0x3f35bf35,0x3ec43f6d
.long 0x80003f80,0xbf35bf35,0x3f80a554,0xbf353f35,0x80003f80,0xbec4bf6d,0x3f353f35,0xbf6dbec4
.long 0x80003f80,0xa50dbf80,0x80003f80,0xa50dbf80,0x80003f80,0x3ec4bf6d,0xbf353f35,0x3f6dbec4
.long 0x80003f80,0x3f35bf35,0xbf80248d,0x3f353f35,0x80003f80,0x3f6dbec4,0xbf35bf35,0xbec43f6d
.long 0x80003f80,0x3f80a554,0xa50dbf80,0xbf80248d,0x80003f80,0x3f6d3ec4,0x3f35bf35,0xbec4bf6d
.long 0x80003f80,0x3f353f35,0x3f80a554,0x3f35bf35,0x80003f80,0x3ec43f6d,0x3f353f35,0x3f6d3ec4
.long 0x80003f80,0x80003f80,0x80003f80,0x80003f80,0xbf80248d,0xbf6dbec4,0xbf35bf35,0xbec4bf6d
.long 0xa50dbf80,0x3f35bf35,0x3f80a554,0x3f353f35,0x3f80a554,0x3ec43f6d,0xbf353f35,0xbf6dbec4
.long 0x80003f80,0xbf80248d,0xa50dbf80,0x3f80a554,0xbf80248d,0x3ec4bf6d,0x3f353f35,0xbf6d3ec4
.long 0xa50dbf80,0x3f353f35,0xbf80248d,0x3f35bf35,0x3f80a554,0xbf6d3ec4,0x3f35bf35,0xbec43f6d
.long 0x80003f80,0xa50dbf80,0x80003f80,0xa50dbf80,0xbf80248d,0x3f6d3ec4,0xbf35bf35,0x3ec43f6d
.long 0xa50dbf80,0xbf353f35,0x3f80a554,0xbf35bf35,0x3f80a554,0xbec4bf6d,0xbf353f35,0x3f6d3ec4
.long 0x80003f80,0x3f80a554,0xa50dbf80,0xbf80248d,0xbf80248d,0xbec43f6d,0x3f353f35,0x3f6dbec4
.long 0xa50dbf80,0xbf35bf35,0xbf80248d,0xbf353f35,0x3f80a554,0x3f6dbec4,0x3f35bf35,0x3ec4bf6d
.long 0x80003f80,0x80003f80,0x80003f80,0x80003f80,0xa50dbf80,0x3ec4bf6d,0x3f35bf35,0x3f6dbec4
.long 0x80003f80,0xbf353f35,0xbf80248d,0xbf35bf35,0xa50dbf80,0x3f6dbec4,0x3f353f35,0xbec43f6d
.long 0x80003f80,0xbf80248d,0xa50dbf80,0x3f80a554,0xa50dbf80,0x3f6d3ec4,0xbf353f35,0xbec4bf6d
.long 0x80003f80,0xbf35bf35,0x3f80a554,0xbf353f35,0xa50dbf80,0x3ec43f6d,0xbf35bf35,0x3f6d3ec4
.long 0x80003f80,0xa50dbf80,0x80003f80,0xa50dbf80,0xa50dbf80,0xbec43f6d,0x3f35bf35,0xbf6d3ec4
.long 0x80003f80,0x3f35bf35,0xbf80248d,0x3f353f35,0xa50dbf80,0xbf6d3ec4,0x3f353f35,0x3ec4bf6d
.long 0x80003f80,0x3f80a554,0xa50dbf80,0xbf80248d,0xa50dbf80,0xbf6dbec4,0xbf353f35,0x3ec43f6d
.long 0x80003f80,0x3f353f35,0x3f80a554,0x3f35bf35,0xa50dbf80,0xbec4bf6d,0xbf35bf35,0xbf6dbec4
.long 0x80003f80,0x80003f80,0x80003f80,0x80003f80,0x3f80a554,0x3f6d3ec4,0x3f353f35,0x3ec43f6d
.long 0xa50dbf80,0x3f35bf35,0x3f80a554,0x3f353f35,0xbf80248d,0xbec4bf6d,0x3f35bf35,0x3f6d3ec4
.long 0x80003f80,0xbf80248d,0xa50dbf80,0x3f80a554,0x3f80a554,0xbec43f6d,0xbf35bf35,0x3f6dbec4
.long 0xa50dbf80,0x3f353f35,0xbf80248d,0x3f35bf35,0xbf80248d,0x3f6dbec4,0xbf353f35,0x3ec4bf6d
.long 0x80003f80,0xa50dbf80,0x80003f80,0xa50dbf80,0x3f80a554,0xbf6dbec4,0x3f353f35,0xbec4bf6d
.long 0xa50dbf80,0xbf353f35,0x3f80a554,0xbf35bf35,0xbf80248d,0x3ec43f6d,0x3f35bf35,0xbf6dbec4
.long 0x80003f80,0x3f80a554,0xa50dbf80,0xbf80248d,0x3f80a554,0x3ec4bf6d,0xbf35bf35,0xbf6d3ec4
.long 0xa50dbf80,0xbf35bf35,0xbf80248d,0xbf353f35,0xbf80248d,0xbf6d3ec4,0xbf353f35,0xbec43f6d
.long 0x3f800000,0x3f800000,0x3f800000,0x3f800000,0x3f800000,0x3f6d3ec4,0x3f353f35,0x3ec43f6d
.long 0x3f800000,0x3f353f35,0x248d3f80,0xbf353f35,0x3f800000,0x3ec43f6d,0xbf353f35,0xbf6dbec4
.long 0x3f800000,0x248d3f80,0xbf80250d,0xa554bf80,0x3f800000,0xbec43f6d,0xbf35bf35,0x3f6dbec4
.long 0x3f800000,0xbf353f35,0xa554bf80,0x3f353f35,0x3f800000,0xbf6d3ec4,0x3f35bf35,0xbec43f6d
.long 0x3f800000,0xbf80250d,0x3f800000,0xbf80250d,0x3f800000,0xbf6dbec4,0x3f353f35,0xbec4bf6d
.long 0x3f800000,0xbf35bf35,0x248d3f80,0x3f35bf35,0x3f800000,0xbec4bf6d,0xbf353f35,0x3f6d3ec4
.long 0x3f800000,0xa554bf80,0xbf80250d,0x248d3f80,0x3f800000,0x3ec4bf6d,0xbf35bf35,0xbf6d3ec4
.long 0x3f800000,0x3f35bf35,0xa554bf80,0xbf35bf35,0x3f800000,0x3f6dbec4,0x3f35bf35,0x3ec4bf6d
.long 0x3f800000,0x3f800000,0x3f800000,0x3f800000,0x248d3f80,0xbec43f6d,0xbf353f35,0xbf6d3ec4
.long 0xbf80250d,0xbf35bf35,0xa554bf80,0x3f35bf35,0xa554bf80,0x3f6dbec4,0x3f353f35,0xbec43f6d
.long 0x3f800000,0x248d3f80,0xbf80250d,0xa554bf80,0x248d3f80,0xbf6dbec4,0x3f35bf35,0x3ec43f6d
.long 0xbf80250d,0x3f35bf35,0x248d3f80,0xbf35bf35,0xa554bf80,0x3ec43f6d,0xbf35bf35,0x3f6d3ec4
.long 0x3f800000,0xbf80250d,0x3f800000,0xbf80250d,0x248d3f80,0x3ec4bf6d,0xbf353f35,0x3f6dbec4
.long 0xbf80250d,0x3f353f35,0xa554bf80,0xbf353f35,0xa554bf80,0xbf6d3ec4,0x3f353f35,0x3ec4bf6d
.long 0x3f800000,0xa554bf80,0xbf80250d,0x248d3f80,0x248d3f80,0x3f6d3ec4,0x3f35bf35,0xbec4bf6d
.long 0xbf80250d,0xbf353f35,0x248d3f80,0x3f353f35,0xa554bf80,0xbec4bf6d,0xbf35bf35,0xbf6dbec4
.long 0x3f800000,0x3f800000,0x3f800000,0x3f800000,0xbf80250d,0xbf6dbec4,0xbf35bf35,0xbec4bf6d
.long 0x3f800000,0x3f353f35,0x248d3f80,0xbf353f35,0xbf80250d,0xbec4bf6d,0x3f35bf35,0x3f6d3ec4
.long 0x3f800000,0x248d3f80,0xbf80250d,0xa554bf80,0xbf80250d,0x3ec4bf6d,0x3f353f35,0xbf6d3ec4
.long 0x3f800000,0xbf353f35,0xa554bf80,0x3f353f35,0xbf80250d,0x3f6dbec4,0xbf353f35,0x3ec4bf6d
.long 0x3f800000,0xbf80250d,0x3f800000,0xbf80250d,0xbf80250d,0x3f6d3ec4,0xbf35bf35,0x3ec43f6d
.long 0x3f800000,0xbf35bf35,0x248d3f80,0x3f35bf35,0xbf80250d,0x3ec43f6d,0x3f35bf35,0xbf6dbec4
.long 0x3f800000,0xa554bf80,0xbf80250d,0x248d3f80,0xbf80250d,0xbec43f6d,0x3f353f35,0x3f6dbec4
.long 0x3f800000,0x3f35bf35,0xa554bf80,0xbf35bf35,0xbf80250d,0xbf6d3ec4,0xbf353f35,0xbec43f6d
.long 0x3f800000,0x3f800000,0x3f800000,0x3f800000,0xa554bf80,0x3ec4bf6d,0x3f35bf35,0x3f6dbec4
.long 0xbf80250d,0xbf35bf35,0xa554bf80,0x3f35bf35,0x248d3f80,0xbf6d3ec4,0xbf35bf35,0x3ec4bf6d
.long 0x3f800000,0x248d3f80,0xbf80250d,0xa554bf80,0xa554bf80,0x3f6d3ec4,0xbf353f35,0xbec4bf6d
.long 0xbf80250d,0x3f35bf35,0x248d3f80,0xbf35bf35,0x248d3f80,0xbec4bf6d,0x3f353f35,0xbf6dbec4
.long 0x3f800000,0xbf80250d,0x3f800000,0xbf80250d,0xa554bf80,0xbec43f6d,0x3f35bf35,0xbf6d3ec4
.long 0xbf80250d,0x3f353f35,0xa554bf80,0xbf353f35,0x248d3f80,0x3f6dbec4,0xbf35bf35,0xbec43f6d
.long 0x3f800000,0xa554bf80,0xbf80250d,0x248d3f80,0xa554bf80,0xbf6dbec4,0xbf353f35,0x3ec43f6d
.long 0xbf80250d,0xbf353f35,0x248d3f80,0x3f353f35,0x248d3f80,0x3ec43f6d,0x3f353f35,0x3f6d3ec4
.long 0x3f800000,0x3f800000,0x40000000,0x80000000,0x3f800000,0xbf800000,0x3fb504f3,0xbfb504f3
.long 0x3f800000,0x3f800000,0,0xc0000000,0x3f800000,0xbf800000,0xbfb504f3,0xbfb504f3
.long 0,0,0,0,0,0,0,0
.long 0,0,0,0,0,0,0,0
.long 0,0,0,0,0,0,0,0
.long 0,0,0,0,0,0,0,0
.long 0,0,0,0,0,0,0,0
.long 0,0,0,0,0,0,0,0
.long 0,0,0,0,0,0,0,0
.long 0,0,0,0,0,0,0,0
.long 0x3f800000,0x3f800000,0x40000000,0x80000000,0x3f800000,0xbf800000,0x3fb504f3,0xbfb504f3
.long 0x3f800000,0x3f800000,0,0xc0000000,0x3f800000,0xbf800000,0xbfb504f3,0xbfb504f3
.long 0,0,0,0,0,0,0,0
.long 0,0,0,0,0,0,0,0
.long 0,0,0,0,0,0,0,0
.long 0,0,0,0,0,0,0,0
.long 0,0,0,0,0,0,0,0
.long 0,0,0,0,0,0,0,0
.long 0,0,0,0,0,0,0,0
.long 0,0,0,0,0,0,0,0
.long 0x3f800000,0x3f800000,0x40000000,0x80000000,0x3f800000,0xbf800000,0x3fb504f3,0xbfb504f3
.long 0x3f800000,0x3f800000,0,0xc0000000,0x3f800000,0xbf800000,0xbfb504f3,0xbfb504f3
.long 0,0,0,0,0,0,0,0
.long 0,0,0,0,0,0,0,0
.long 0,0,0,0,0,0,0,0
.long 0,0,0,0,0,0,0,0
.long 0,0,0,0,0,0,0,0
.long 0,0,0,0,0,0,0,0
.long 0,0,0,0,0,0,0,0
.long 0,0,0,0,0,0,0,0
.long 0x3f800000,0x3f800000,0x40000000,0x80000000,0x3f800000,0xbf800000,0x3fb504f3,0xbfb504f3
.long 0x3f800000,0x3f800000,0,0xc0000000,0x3f800000,0xbf800000,0xbfb504f3,0xbfb504f3
.long 0x40000000,0x80000000,0x40000000,0x80000000,0,0xc0000000,0xbfb504f3,0xbfb504f3
.long 0xc0000000,0x80000000,0x80000000,0x40000000,0x80000000,0x40000000,0x3fb504f3,0xbfb504f3
.long 0,0,0,0,0,0,0,0
.long 0,0,0,0,0,0,0,0
.long 0,0,0,0,0,0,0,0
.long 0,0,0,0,0,0,0,0
.long 0,0,0,0,0,0,0,0
.long 0,0,0,0,0,0,0,0
.long 0,0,0,0,0,0,0,0
.long 0,0,0,0,0,0,0,0
.long 0x40000000,0x80000000,0x40000000,0x80000000,0,0xc0000000,0xbfb504f3,0xbfb504f3
.long 0xc0000000,0x80000000,0x80000000,0x40000000,0x80000000,0x40000000,0x3fb504f3,0xbfb504f3
.long 0,0,0,0,0,0,0,0
.long 0,0,0,0,0,0,0,0
.long 0,0,0,0,0,0,0,0
.long 0,0,0,0,0,0,0,0
.long 0,0,0,0,0,0,0,0
.long 0,0,0,0,0,0,0,0
.long 0,0,0,0,0,0,0,0
.long 0,0,0,0,0,0,0,0
.long 0x40000000,0x80000000,0x40000000,0x80000000,0,0xc0000000,0xbfb504f3,0xbfb504f3
.long 0xc0000000,0x80000000,0x80000000,0x40000000,0x80000000,0x40000000,0x3fb504f3,0xbfb504f3
.long 0,0,0,0,0,0,0,0
.long 0,0,0,0,0,0,0,0
.long 0,0,0,0,0,0,0,0
.long 0,0,0,0,0,0,0,0
.long 0,0,0,0,0,0,0,0
.long 0,0,0,0,0,0,0,0
.long 0,0,0,0,0,0,0,0
.long 0,0,0,0,0,0,0,0
.long 0x40000000,0x80000000,0x40000000,0x80000000,0,0xc0000000,0xbfb504f3,0xbfb504f3
.long 0xc0000000,0x80000000,0x80000000,0x40000000,0x80000000,0x40000000,0x3fb504f3,0xbfb504f3
.long 0x3f80,0x3f80,0x3f80,0x3f80,0x3f80,0x3ec43f6d,0x3f353f35,0x3f6d3ec4
.long 0x3f80,0x3f353f35,0x3f80248d,0x3f35bf35,0x3f80,0x3f6d3ec4,0x3f35bf35,0xbec4bf6d
.long 0x3f80,0x3f80248d,0x250dbf80,0xbf80a554,0x3f80,0x3f6dbec4,0xbf35bf35,0xbec43f6d
.long 0x3f80,0x3f35bf35,0xbf80a554,0x3f353f35,0x3f80,0x3ec4bf6d,0xbf353f35,0x3f6dbec4
.long 0x3f80,0x250dbf80,0xa58d3f80,0x25d4bf80,0x3f80,0xbec4bf6d,0x3f353f35,0xbf6dbec4
.long 0x3f80,0xbf35bf35,0x3f8025b0,0xbf353f35,0x3f80,0xbf6dbec4,0x3f35bf35,0x3ec43f6d
.long 0x3f80,0xbf80a554,0x25d4bf80,0x3f80261f,0x3f80,0xbf6d3ec4,0xbf35bf35,0x3ec4bf6d
.long 0x3f80,0xbf353f35,0xbf80a5f7,0xbf35bf35,0x3f80,0xbec43f6d,0xbf353f35,0xbf6d3ec4
.long 0x3f80,0x3f80,0x3f80,0x3f80,0x3f80248d,0x3f6dbec4,0x3f35bf35,0x3ec4bf6d
.long 0x250dbf80,0xbf35bf35,0xbf80a554,0xbf353f35,0xbf80a554,0xbec43f6d,0x3f353f35,0x3f6dbec4
.long 0xa58d3f80,0x3f8025b0,0x25d4bf80,0xbf80a5f7,0x3f8025b0,0xbec4bf6d,0xbf353f35,0x3f6d3ec4
.long 0x25d4bf80,0xbf353f35,0x3f80261f,0xbf35bf35,0xbf80a5f7,0x3f6d3ec4,0xbf35bf35,0x3ec43f6d
.long 0xa60d3f80,0x2630bf80,0xa6543f80,0x2677bf80,0x3f80261f,0xbf6d3ec4,0x3f35bf35,0xbec43f6d
.long 0x2630bf80,0x3f353f35,0xbf80a742,0x3f35bf35,0xbf80a731,0x3ec4bf6d,0x3f353f35,0xbf6d3ec4
.long 0xa6543f80,0xbf80a742,0x269fbf80,0x3f80a60d,0x3f80a68d,0x3ec43f6d,0xbf353f35,0xbf6dbec4
.long 0x2677bf80,0x3f35bf35,0x3f80a60d,0x3f353f35,0xbf80a742,0xbf6dbec4,0xbf35bf35,0xbec4bf6d
.long 0x3f80,0x3f80,0x3f80,0x3f80,0x250dbf80,0xbec4bf6d,0xbf35bf35,0xbf6dbec4
.long 0xa58d3f80,0x3f353f35,0x3f8025b0,0x3f35bf35,0x25d4bf80,0xbf6dbec4,0xbf353f35,0x3ec43f6d
.long 0xa60d3f80,0x3f80261f,0x2630bf80,0xbf80a731,0x2630bf80,0xbf6d3ec4,0x3f353f35,0x3ec4bf6d
.long 0xa6543f80,0x3f35bf35,0xbf80a742,0x3f353f35,0x2677bf80,0xbec43f6d,0x3f35bf35,0xbf6d3ec4
.long 0xa68d3f80,0x269fbf80,0xa6b03f80,0x27b1bf80,0x269fbf80,0x3ec43f6d,0xbf35bf35,0x3f6d3ec4
.long 0xa6b03f80,0xbf35bf35,0x3f80a58e,0xbf353f35,0x27b1bf80,0x3f6d3ec4,0xbf353f35,0xbec4bf6d
.long 0xa6d43f80,0xbf80a777,0x27c2bf80,0x3f80258d,0xa70dbf80,0x3f6dbec4,0x3f353f35,0xbec43f6d
.long 0xa6f73f80,0xbf353f35,0xbf80a78d,0xbf35bf35,0x27c2bf80,0x3ec4bf6d,0x3f35bf35,0x3f6dbec4
.long 0x3f80,0x3f80,0x3f80,0x3f80,0xbf80a554,0xbf6d3ec4,0xbf353f35,0xbec43f6d
.long 0x25d4bf80,0xbf35bf35,0xbf80a5f7,0xbf353f35,0x3f80261f,0x3ec4bf6d,0xbf35bf35,0xbf6d3ec4
.long 0xa6543f80,0x3f80a68d,0x2677bf80,0xbf80a742,0xbf80a742,0x3ec43f6d,0x3f35bf35,0xbf6dbec4
.long 0x269fbf80,0xbf353f35,0x3f80a60d,0xbf35bf35,0x3f80a60d,0xbf6dbec4,0x3f353f35,0xbec4bf6d
.long 0xa6d43f80,0xa70dbf80,0xa6f73f80,0x27c2bf80,0xbf80a777,0x3f6dbec4,0xbf353f35,0x3ec4bf6d
.long 0x27c2bf80,0x3f353f35,0xbf80a78d,0x3f35bf35,0x3f80258d,0xbec43f6d,0xbf35bf35,0x3f6dbec4
.long 0xa71f3f80,0xbf80a796,0xa68dbf80,0x3f80268d,0xbf80a796,0xbec4bf6d,0x3f35bf35,0x3f6d3ec4
.long 0xa68dbf80,0x3f35bf35,0x3f802816,0x3f353f35,0x3f80268d,0x3f6d3ec4,0x3f353f35,0x3ec43f6d
.long 0x3f808000,0x3f808000,0x3f808000,0x3f808000,0x3f808000,0x3f6dbec4,0x3f35bf35,0x3ec4bf6d
.long 0x3f808000,0x3f35bf35,0x248dbf80,0xbf35bf35,0x3f808000,0x3ec4bf6d,0xbf35bf35,0xbf6d3ec4
.long 0x3f808000,0x248dbf80,0xbf80a50d,0xa5543f80,0x3f808000,0xbec4bf6d,0xbf353f35,0x3f6d3ec4
.long 0x3f808000,0xbf35bf35,0xa5543f80,0x3f35bf35,0x3f808000,0xbf6dbec4,0x3f353f35,0xbec4bf6d
.long 0x3f808000,0xbf80a50d,0x3f80258d,0xbf80a5d4,0x3f808000,0xbf6d3ec4,0x3f35bf35,0xbec43f6d
.long 0x3f808000,0xbf353f35,0x25b0bf80,0x3f353f35,0x3f808000,0xbec43f6d,0xbf35bf35,0x3f6dbec4
.long 0x3f808000,0xa5543f80,0xbf80a5d4,0x261fbf80,0x3f808000,0x3ec43f6d,0xbf353f35,0xbf6dbec4
.long 0x3f808000,0x3f353f35,0xa5f73f80,0xbf353f35,0x3f808000,0x3f6d3ec4,0x3f353f35,0x3ec43f6d
.long 0x3f808000,0x3f808000,0x3f808000,0x3f808000,0x248dbf80,0xbec4bf6d,0xbf35bf35,0xbf6dbec4
.long 0xbf80a50d,0xbf353f35,0xa5543f80,0x3f353f35,0xa5543f80,0x3f6d3ec4,0x3f35bf35,0xbec4bf6d
.long 0x3f80258d,0x25b0bf80,0xbf80a5d4,0xa5f73f80,0x25b0bf80,0xbf6d3ec4,0x3f353f35,0x3ec4bf6d
.long 0xbf80a5d4,0x3f353f35,0x261fbf80,0xbf353f35,0xa5f73f80,0x3ec4bf6d,0xbf353f35,0x3f6dbec4
.long 0x3f80260d,0xbf80a630,0x3f802654,0xbf80a677,0x261fbf80,0x3ec43f6d,0xbf35bf35,0x3f6d3ec4
.long 0xbf80a630,0x3f35bf35,0xa7423f80,0xbf35bf35,0xa7313f80,0xbf6dbec4,0x3f35bf35,0x3ec43f6d
.long 0x3f802654,0xa7423f80,0xbf80a69f,0xa60dbf80,0xa68dbf80,0x3f6dbec4,0x3f353f35,0xbec43f6d
.long 0xbf80a677,0xbf35bf35,0xa60dbf80,0x3f35bf35,0xa7423f80,0xbec43f6d,0xbf353f35,0xbf6d3ec4
.long 0x3f808000,0x3f808000,0x3f808000,0x3f808000,0xbf80a50d,0xbf6d3ec4,0xbf353f35,0xbec43f6d
.long 0x3f80258d,0x3f35bf35,0x25b0bf80,0xbf35bf35,0xbf80a5d4,0xbec43f6d,0x3f353f35,0x3f6dbec4
.long 0x3f80260d,0x261fbf80,0xbf80a630,0xa7313f80,0xbf80a630,0x3ec43f6d,0x3f35bf35,0xbf6dbec4
.long 0x3f802654,0xbf35bf35,0xa7423f80,0x3f35bf35,0xbf80a677,0x3f6d3ec4,0xbf35bf35,0x3ec43f6d
.long 0x3f80268d,0xbf80a69f,0x3f8026b0,0xbf80a7b1,0xbf80a69f,0x3f6dbec4,0xbf353f35,0x3ec4bf6d
.long 0x3f8026b0,0xbf353f35,0xa58ebf80,0x3f353f35,0xbf80a7b1,0x3ec4bf6d,0x3f353f35,0xbf6d3ec4
.long 0x3f8026d4,0xa7773f80,0xbf80a7c2,0x258dbf80,0xbf80270d,0xbec4bf6d,0x3f35bf35,0x3f6d3ec4
.long 0x3f8026f7,0x3f353f35,0xa78d3f80,0xbf353f35,0xbf80a7c2,0xbf6dbec4,0xbf35bf35,0xbec4bf6d
.long 0x3f808000,0x3f808000,0x3f808000,0x3f808000,0xa5543f80,0x3ec43f6d,0x3f353f35,0x3f6d3ec4
.long 0xbf80a5d4,0xbf353f35,0xa5f73f80,0x3f353f35,0x261fbf80,0xbf6dbec4,0xbf353f35,0x3ec43f6d
.long 0x3f802654,0xa68dbf80,0xbf80a677,0xa7423f80,0xa7423f80,0x3f6dbec4,0xbf35bf35,0xbec43f6d
.long 0xbf80a69f,0x3f353f35,0xa60dbf80,0xbf353f35,0xa60dbf80,0xbec43f6d,0x3f35bf35,0xbf6d3ec4
.long 0x3f8026d4,0xbf80270d,0x3f8026f7,0xbf80a7c2,0xa7773f80,0xbec4bf6d,0x3f353f35,0xbf6dbec4
.long 0xbf80a7c2,0x3f35bf35,0xa78d3f80,0xbf35bf35,0x258dbf80,0x3f6d3ec4,0xbf353f35,0xbec4bf6d
.long 0x3f80271f,0xa7963f80,0xbf80268d,0x268dbf80,0xa7963f80,0xbf6d3ec4,0xbf35bf35,0x3ec4bf6d
.long 0xbf80268d,0xbf35bf35,0x2816bf80,0x3f35bf35,0x268dbf80,0x3ec4bf6d,0x3f35bf35,0x3f6dbec4
.long 0x80003f80,0x80003f80,0x80003f80,0x80003f80,0x80003f80,0xbec43f6d,0xbf353f35,0xbf6d3ec4
.long 0x80003f80,0xbf353f35,0xbf80248d,0xbf35bf35,0x80003f80,0xbf6d3ec4,0xbf35bf35,0x3ec4bf6d
.long 0x80003f80,0xbf80248d,0xa50dbf80,0x3f80a554,0x80003f80,0xbf6dbec4,0x3f35bf35,0x3ec43f6d
.long 0x80003f80,0xbf35bf35,0x3f80a554,0xbf353f35,0x80003f80,0xbec4bf6d,0x3f353f35,0xbf6dbec4
.long 0x80003f80,0xa50dbf80,0x258d3f80,0xa5d4bf80,0x80003f80,0x3ec4bf6d,0xbf353f35,0x3f6dbec4
.long 0x80003f80,0x3f35bf35,0xbf8025b0,0x3f353f35,0x80003f80,0x3f6dbec4,0xbf35bf35,0xbec43f6d
.long 0x80003f80,0x3f80a554,0xa5d4bf80,0xbf80261f,0x80003f80,0x3f6d3ec4,0x3f35bf35,0xbec4bf6d
.long 0x80003f80,0x3f353f35,0x3f80a5f7,0x3f35bf35,0x80003f80,0x3ec43f6d,0x3f353f35,0x3f6d3ec4
.long 0x80003f80,0x80003f80,0x80003f80,0x80003f80,0xbf80248d,0xbf6dbec4,0xbf35bf35,0xbec4bf6d
.long 0xa50dbf80,0x3f35bf35,0x3f80a554,0x3f353f35,0x3f80a554,0x3ec43f6d,0xbf353f35,0xbf6dbec4
.long 0x258d3f80,0xbf8025b0,0xa5d4bf80,0x3f80a5f7,0xbf8025b0,0x3ec4bf6d,0x3f353f35,0xbf6d3ec4
.long 0xa5d4bf80,0x3f353f35,0xbf80261f,0x3f35bf35,0x3f80a5f7,0xbf6d3ec4,0x3f35bf35,0xbec43f6d
.long 0x260d3f80,0xa630bf80,0x26543f80,0xa677bf80,0xbf80261f,0x3f6d3ec4,0xbf35bf35,0x3ec43f6d
.long 0xa630bf80,0xbf353f35,0x3f80a742,0xbf35bf35,0x3f80a731,0xbec4bf6d,0xbf353f35,0x3f6d3ec4
.long 0x26543f80,0x3f80a742,0xa69fbf80,0xbf80a60d,0xbf80a68d,0xbec43f6d,0x3f353f35,0x3f6dbec4
.long 0xa677bf80,0xbf35bf35,0xbf80a60d,0xbf353f35,0x3f80a742,0x3f6dbec4,0x3f35bf35,0x3ec4bf6d
.long 0x80003f80,0x80003f80,0x80003f80,0x80003f80,0xa50dbf80,0x3ec4bf6d,0x3f35bf35,0x3f6dbec4
.long 0x258d3f80,0xbf353f35,0xbf8025b0,0xbf35bf35,0xa5d4bf80,0x3f6dbec4,0x3f353f35,0xbec43f6d
.long 0x260d3f80,0xbf80261f,0xa630bf80,0x3f80a731,0xa630bf80,0x3f6d3ec4,0xbf353f35,0xbec4bf6d
.long 0x26543f80,0xbf35bf35,0x3f80a742,0xbf353f35,0xa677bf80,0x3ec43f6d,0xbf35bf35,0x3f6d3ec4
.long 0x268d3f80,0xa69fbf80,0x26b03f80,0xa7b1bf80,0xa69fbf80,0xbec43f6d,0x3f35bf35,0xbf6d3ec4
.long 0x26b03f80,0x3f35bf35,0xbf80a58e,0x3f353f35,0xa7b1bf80,0xbf6d3ec4,0x3f353f35,0x3ec4bf6d
.long 0x26d43f80,0x3f80a777,0xa7c2bf80,0xbf80258d,0x270dbf80,0xbf6dbec4,0xbf353f35,0x3ec43f6d
.long 0x26f73f80,0x3f353f35,0x3f80a78d,0x3f35bf35,0xa7c2bf80,0xbec4bf6d,0xbf35bf35,0xbf6dbec4
.long 0x80003f80,0x80003f80,0x80003f80,0x80003f80,0x3f80a554,0x3f6d3ec4,0x3f353f35,0x3ec43f6d
.long 0xa5d4bf80,0x3f35bf35,0x3f80a5f7,0x3f353f35,0xbf80261f,0xbec4bf6d,0x3f35bf35,0x3f6d3ec4
.long 0x26543f80,0xbf80a68d,0xa677bf80,0x3f80a742,0x3f80a742,0xbec43f6d,0xbf35bf35,0x3f6dbec4
.long 0xa69fbf80,0x3f353f35,0xbf80a60d,0x3f35bf35,0xbf80a60d,0x3f6dbec4,0xbf353f35,0x3ec4bf6d
.long 0x26d43f80,0x270dbf80,0x26f73f80,0xa7c2bf80,0x3f80a777,0xbf6dbec4,0x3f353f35,0xbec4bf6d
.long 0xa7c2bf80,0xbf353f35,0x3f80a78d,0xbf35bf35,0xbf80258d,0x3ec43f6d,0x3f35bf35,0xbf6dbec4
.long 0x271f3f80,0x3f80a796,0x268dbf80,0xbf80268d,0x3f80a796,0x3ec4bf6d,0xbf35bf35,0xbf6d3ec4
.long 0x268dbf80,0xbf35bf35,0xbf802816,0xbf353f35,0xbf80268d,0xbf6d3ec4,0xbf353f35,0xbec43f6d
.long 0x3f800000,0x3f800000,0x3f800000,0x3f800000,0x3f800000,0x3f6d3ec4,0x3f353f35,0x3ec43f6d
.long 0x3f800000,0x3f353f35,0x248d3f80,0xbf353f35,0x3f800000,0x3ec43f6d,0xbf353f35,0xbf6dbec4
.long 0x3f800000,0x248d3f80,0xbf80250d,0xa554bf80,0x3f800000,0xbec43f6d,0xbf35bf35,0x3f6dbec4
.long 0x3f800000,0xbf353f35,0xa554bf80,0x3f353f35,0x3f800000,0xbf6d3ec4,0x3f35bf35,0xbec43f6d
.long 0x3f800000,0xbf80250d,0x3f80a58d,0xbf8025d4,0x3f800000,0xbf6dbec4,0x3f353f35,0xbec4bf6d
.long 0x3f800000,0xbf35bf35,0x25b03f80,0x3f35bf35,0x3f800000,0xbec4bf6d,0xbf353f35,0x3f6d3ec4
.long 0x3f800000,0xa554bf80,0xbf8025d4,0x261f3f80,0x3f800000,0x3ec4bf6d,0xbf35bf35,0xbf6d3ec4
.long 0x3f800000,0x3f35bf35,0xa5f7bf80,0xbf35bf35,0x3f800000,0x3f6dbec4,0x3f35bf35,0x3ec4bf6d
.long 0x3f800000,0x3f800000,0x3f800000,0x3f800000,0x248d3f80,0xbec43f6d,0xbf353f35,0xbf6d3ec4
.long 0xbf80250d,0xbf35bf35,0xa554bf80,0x3f35bf35,0xa554bf80,0x3f6dbec4,0x3f353f35,0xbec43f6d
.long 0x3f80a58d,0x25b03f80,0xbf8025d4,0xa5f7bf80,0x25b03f80,0xbf6dbec4,0x3f35bf35,0x3ec43f6d
.long 0xbf8025d4,0x3f35bf35,0x261f3f80,0xbf35bf35,0xa5f7bf80,0x3ec43f6d,0xbf35bf35,0x3f6d3ec4
.long 0x3f80a60d,0xbf802630,0x3f80a654,0xbf802677,0x261f3f80,0x3ec4bf6d,0xbf353f35,0x3f6dbec4
.long 0xbf802630,0x3f353f35,0xa742bf80,0xbf353f35,0xa731bf80,0xbf6d3ec4,0x3f353f35,0x3ec4bf6d
.long 0x3f80a654,0xa742bf80,0xbf80269f,0xa60d3f80,0xa68d3f80,0x3f6d3ec4,0x3f35bf35,0xbec4bf6d
.long 0xbf802677,0xbf353f35,0xa60d3f80,0x3f353f35,0xa742bf80,0xbec4bf6d,0xbf35bf35,0xbf6dbec4
.long 0x3f800000,0x3f800000,0x3f800000,0x3f800000,0xbf80250d,0xbf6dbec4,0xbf35bf35,0xbec4bf6d
.long 0x3f80a58d,0x3f353f35,0x25b03f80,0xbf353f35,0xbf8025d4,0xbec4bf6d,0x3f35bf35,0x3f6d3ec4
.long 0x3f80a60d,0x261f3f80,0xbf802630,0xa731bf80,0xbf802630,0x3ec4bf6d,0x3f353f35,0xbf6d3ec4
.long 0x3f80a654,0xbf353f35,0xa742bf80,0x3f353f35,0xbf802677,0x3f6dbec4,0xbf353f35,0x3ec4bf6d
.long 0x3f80a68d,0xbf80269f,0x3f80a6b0,0xbf8027b1,0xbf80269f,0x3f6d3ec4,0xbf35bf35,0x3ec43f6d
.long 0x3f80a6b0,0xbf35bf35,0xa58e3f80,0x3f35bf35,0xbf8027b1,0x3ec43f6d,0x3f35bf35,0xbf6dbec4
.long 0x3f80a6d4,0xa777bf80,0xbf8027c2,0x258d3f80,0xbf80a70d,0xbec43f6d,0x3f353f35,0x3f6dbec4
.long 0x3f80a6f7,0x3f35bf35,0xa78dbf80,0xbf35bf35,0xbf8027c2,0xbf6d3ec4,0xbf353f35,0xbec43f6d
.long 0x3f800000,0x3f800000,0x3f800000,0x3f800000,0xa554bf80,0x3ec4bf6d,0x3f35bf35,0x3f6dbec4
.long 0xbf8025d4,0xbf35bf35,0xa5f7bf80,0x3f35bf35,0x261f3f80,0xbf6d3ec4,0xbf35bf35,0x3ec4bf6d
.long 0x3f80a654,0xa68d3f80,0xbf802677,0xa742bf80,0xa742bf80,0x3f6d3ec4,0xbf353f35,0xbec4bf6d
.long 0xbf80269f,0x3f35bf35,0xa60d3f80,0xbf35bf35,0xa60d3f80,0xbec4bf6d,0x3f353f35,0xbf6dbec4
.long 0x3f80a6d4,0xbf80a70d,0x3f80a6f7,0xbf8027c2,0xa777bf80,0xbec43f6d,0x3f35bf35,0xbf6d3ec4
.long 0xbf8027c2,0x3f353f35,0xa78dbf80,0xbf353f35,0x258d3f80,0x3f6dbec4,0xbf35bf35,0xbec43f6d
.long 0x3f80a71f,0xa796bf80,0xbf80a68d,0x268d3f80,0xa796bf80,0xbf6dbec4,0xbf353f35,0x3ec43f6d
.long 0xbf80a68d,0xbf353f35,0x28163f80,0x3f353f35,0x268d3f80,0x3ec43f6d,0x3f353f35,0x3f6d3ec4
.long 0x3f800000,0x3f800000,0x3f800000,0x3f800000,0x3f800000,0x3f7fec43,0x3f7fb10f,0x3f7f4e6d
.long 0x3f800000,0x3f7fb10f,0x3f7ec46d,0x3f7d3aac,0x3f800000,0x3f7f4e6d,0x3f7d3aac,0x3f79c79d
.long 0x3f800000,0x3f7ec46d,0x3f7b14be,0x3f74fa0b,0x3f800000,0x3f7e1324,0x3f7853f8,0x3f6ed89e
.long 0x3f800000,0x3f7d3aac,0x3f74fa0b,0x3f676bd8,0x3f800000,0x3f7c3b28,0x3f710908,0x3f5ebe05
.long 0x3f800000,0x3f7b14be,0x3f6c835e,0x3f54db31,0x3f800000,0x3f79c79d,0x3f676bd8,0x3f49d112
.long 0x3f800000,0x3f7853f8,0x3f61c598,0x3f3daef9,0x3f800000,0x3f76ba07,0x3f5b941a,0x3f3085bb
.long 0x3f800000,0x3f74fa0b,0x3f54db31,0x3f226799,0x3f800000,0x3f731447,0x3f4d9f02,0x3f13682a
.long 0x3f800000,0x3f710908,0x3f45e403,0x3f039c3d,0x3f800000,0x3f6ed89e,0x3f3daef9,0x3ee63375
.long 0x3f800000,0x3f800000,0x3f800000,0x3f800000,0x3f7ec46d,0x3f7e1324,0x3f7d3aac,0x3f7c3b28
.long 0x3f7b14be,0x3f7853f8,0x3f74fa0b,0x3f710908,0x3f74fa0b,0x3f6ed89e,0x3f676bd8,0x3f5ebe05
.long 0x3f6c835e,0x3f61c598,0x3f54db31,0x3f45e403,0x3f61c598,0x3f514d3d,0x3f3daef9,0x3f273656
.long 0x3f54db31,0x3f3daef9,0x3f226799,0x3f039c3d,0x3f45e403,0x3f273656,0x3f039c3d,0x3eb8442a
.long 0x3f3504f3,0x3f0e39da,0x3ec3ef15,0x3e47c5c2,0x3f226799,0x3ee63375,0x3e78cfcc,0x3cc90ab0
.long 0x3f0e39da,0x3eac7cd4,0x3dc8bd36,0xbe164083,0x3ef15aea,0x3e605c13,0xbd48fb30,0xbea09ae5
.long 0x3ec3ef15,0x3dc8bd36,0xbe47c5c2,0xbef15aea,0x3e94a031,0xbcc90ab0,0xbeac7cd4,0xbf1d7fd1
.long 0x3e47c5c2,0xbe164083,0xbef15aea,0xbf3daef9,0x3dc8bd36,0xbe888e93,0xbf187fc0,0xbf584853
.long 0x3f800000,0x3f800000,0x3f800000,0x3f800000,0x3f7b14be,0x3f79c79d,0x3f7853f8,0x3f76ba07
.long 0x3f6c835e,0x3f676bd8,0x3f61c598,0x3f5b941a,0x3f54db31,0x3f49d112,0x3f3daef9,0x3f3085bb
.long 0x3f3504f3,0x3f226799,0x3f0e39da,0x3ef15aea,0x3f0e39da,0x3ee63375,0x3eac7cd4,0x3e605c13
.long 0x3ec3ef15,0x3e78cfcc,0x3dc8bd36,0xbd48fb30,0x3e47c5c2,0x3cc90ab0,0xbe164083,0xbea09ae5
.long 0x248d3132,0xbe47c5c2,0xbec3ef15,0xbf0e39da,0xbe47c5c2,0xbecf7bca,0xbf187fc0,0xbf41d870
.long 0xbec3ef15,0xbf187fc0,0xbf45e403,0xbf676bd8,0xbf0e39da,0xbf41d870,0xbf676bd8,0xbf7c3b28
.long 0xbf3504f3,0xbf61c598,0xbf7b14be,0xbf7ec46d,0xbf54db31,0xbf76ba07,0xbf7fb10f,0xbf6ed89e
.long 0xbf6c835e,0xbf7fb10f,0xbf74fa0b,0xbf4d9f02,0xbf7b14be,0xbf7c3b28,0xbf5b941a,0xbf1d7fd1
.long 0x3f800000,0x3f800000,0x3f800000,0x3f800000,0x3f74fa0b,0x3f731447,0x3f710908,0x3f6ed89e
.long 0x3f54db31,0x3f4d9f02,0x3f45e403,0x3f3daef9,0x3f226799,0x3f13682a,0x3f039c3d,0x3ee63375
.long 0x3ec3ef15,0x3e94a031,0x3e47c5c2,0x3dc8bd36,0x3dc8bd36,0xbcc90ab0,0xbe164083,0xbe888e93
.long 0xbe47c5c2,0xbeac7cd4,0xbef15aea,0xbf187fc0,0xbef15aea,0xbf1d7fd1,0xbf3daef9,0xbf584853
.long 0xbf3504f3,0xbf54db31,0xbf6c835e,0xbf7b14be,0xbf61c598,0xbf76ba07,0xbf7fb10f,0xbf7c3b28
.long 0xbf7b14be,0xbf7fb10f,0xbf74fa0b,0xbf5b941a,0xbf7ec46d,0xbf6ed89e,0xbf4d9f02,0xbf1d7fd1
.long 0xbf6c835e,0xbf45e403,0xbf0e39da,0xbe94a031,0xbf45e403,0xbf08f59b,0xbe78cfcc,0x3d96a905
.long 0xbf0e39da,0xbe78cfcc,0x3dc8bd36,0x3edae880,0xbe94a031,0x3d96a905,0x3edae880,0x3f396842
.long 0,0,0,0,0,0x3cc90ab0,0x3d48fb30,0x3d96a905
.long 0,0x3d48fb30,0x3dc8bd36,0x3e164083,0,0x3d96a905,0x3e164083,0x3e605c13
.long 0,0x3dc8bd36,0x3e47c5c2,0x3e94a031,0,0x3dfab273,0x3e78cfcc,0x3eb8442a
.long 0,0x3e164083,0x3e94a031,0x3edae880,0,0x3e2f10a2,0x3eac7cd4,0x3efc5d27
.long 0,0x3e47c5c2,0x3ec3ef15,0x3f0e39da,0,0x3e605c13,0x3edae880,0x3f1d7fd1
.long 0,0x3e78cfcc,0x3ef15aea,0x3f2beb4a,0,0x3e888e93,0x3f039c3d,0x3f396842
.long 0,0x3e94a031,0x3f0e39da,0x3f45e403,0,0x3ea09ae5,0x3f187fc0,0x3f514d3d
.long 0,0x3eac7cd4,0x3f226799,0x3f5b941a,0,0x3eb8442a,0x3f2beb4a,0x3f64aa59
.long 0,0,0,0,0x3dc8bd36,0x3dfab273,0x3e164083,0x3e2f10a2
.long 0x3e47c5c2,0x3e78cfcc,0x3e94a031,0x3eac7cd4,0x3e94a031,0x3eb8442a,0x3edae880,0x3efc5d27
.long 0x3ec3ef15,0x3ef15aea,0x3f0e39da,0x3f226799,0x3ef15aea,0x3f13682a,0x3f2beb4a,0x3f41d870
.long 0x3f0e39da,0x3f2beb4a,0x3f45e403,0x3f5b941a,0x3f226799,0x3f41d870,0x3f5b941a,0x3f6ed89e
.long 0x3f3504f3,0x3f54db31,0x3f6c835e,0x3f7b14be,0x3f45e403,0x3f64aa59,0x3f7853f8,0x3f7fec43
.long 0x3f54db31,0x3f710908,0x3f7ec46d,0x3f7d3aac,0x3f61c598,0x3f79c79d,0x3f7fb10f,0x3f731447
.long 0x3f6c835e,0x3f7ec46d,0x3f7b14be,0x3f61c598,0x3f74fa0b,0x3f7fec43,0x3f710908,0x3f49d112
.long 0x3f7b14be,0x3f7d3aac,0x3f61c598,0x3f2beb4a,0x3f7ec46d,0x3f76ba07,0x3f4d9f02,0x3f08f59b
.long 0,0,0,0,0x3e47c5c2,0x3e605c13,0x3e78cfcc,0x3e888e93
.long 0x3ec3ef15,0x3edae880,0x3ef15aea,0x3f039c3d,0x3f0e39da,0x3f1d7fd1,0x3f2beb4a,0x3f396842
.long 0x3f3504f3,0x3f45e403,0x3f54db31,0x3f61c598,0x3f54db31,0x3f64aa59,0x3f710908,0x3f79c79d
.long 0x3f6c835e,0x3f7853f8,0x3f7ec46d,0x3f7fb10f,0x3f7b14be,0x3f7fec43,0x3f7d3aac,0x3f731447
.long 0x3f800000,0x3f7b14be,0x3f6c835e,0x3f54db31,0x3f7b14be,0x3f6a09a7,0x3f4d9f02,0x3f273656
.long 0x3f6c835e,0x3f4d9f02,0x3f226799,0x3edae880,0x3f54db31,0x3f273656,0x3edae880,0x3e2f10a2
.long 0x3f3504f3,0x3ef15aea,0x3e47c5c2,0xbdc8bd36,0x3f0e39da,0x3e888e93,0xbd48fb30,0xbeb8442a
.long 0x3ec3ef15,0x3d48fb30,0xbe94a031,0xbf187fc0,0x3e47c5c2,0xbe2f10a2,0xbf039c3d,0xbf49d112
.long 0,0,0,0,0x3e94a031,0x3ea09ae5,0x3eac7cd4,0x3eb8442a
.long 0x3f0e39da,0x3f187fc0,0x3f226799,0x3f2beb4a,0x3f45e403,0x3f514d3d,0x3f5b941a,0x3f64aa59
.long 0x3f6c835e,0x3f74fa0b,0x3f7b14be,0x3f7ec46d,0x3f7ec46d,0x3f7fec43,0x3f7d3aac,0x3f76ba07
.long 0x3f7b14be,0x3f710908,0x3f61c598,0x3f4d9f02,0x3f61c598,0x3f49d112,0x3f2beb4a,0x3f08f59b
.long 0x3f3504f3,0x3f0e39da,0x3ec3ef15,0x3e47c5c2,0x3ef15aea,0x3e888e93,0x3d48fb30,0xbe2f10a2
.long 0x3e47c5c2,0xbd48fb30,0xbe94a031,0xbf039c3d,0xbdc8bd36,0xbeb8442a,0xbf187fc0,0xbf49d112
.long 0xbec3ef15,0xbf226799,0xbf54db31,0xbf74fa0b,0xbf226799,0xbf584853,0xbf7853f8,0xbf7f4e6d
.long 0xbf54db31,0xbf7853f8,0xbf7ec46d,0xbf676bd8,0xbf74fa0b,0xbf7f4e6d,0xbf676bd8,0xbf3085bb
.long 0x3510d0c3,0x3510d0c3,0x3510d0c3,0x3510d0c3,0x3510d0c3,0x3510c598,0x3510a41b,0x35106c4f
.long 0x3510d0c3,0x3510a41b,0x35101e3f,0x350f3f81,0x3510d0c3,0x35106c4f,0x350f3f81,0x350d4bf9
.long 0x3510d0c3,0x35101e3f,0x350e086b,0x350a946b,0x3510d0c3,0x350fb9f5,0x350c79bc,0x35071c9e
.long 0x3510d0c3,0x350f3f81,0x350a946b,0x3502e961,0x3510d0c3,0x350eaef6,0x350859a3,0x34fc010d
.long 0x3510d0c3,0x350e086b,0x3505cac4,0x34f0d1bf,0x3510d0c3,0x350d4bf9,0x3502e961,0x34e4545b
.long 0x3510d0c3,0x350c79bc,0x34ff6e83,0x34d69a35,0x3510d0c3,0x350b91d7,0x34f86cbc,0x34c7b658
.long 0x3510d0c3,0x350a946b,0x34f0d1bf,0x34b7bd6c,0x3510d0c3,0x350981a1,0x34e8a23d,0x34a6c599
.long 0x3510d0c3,0x350859a3,0x34dfe343,0x3494e66a,0x3510d0c3,0x35071c9e,0x34d69a35,0x348238aa
.long 0x3510d0c3,0x3510d0c3,0x3510d0c3,0x3510d0c3,0x35101e3f,0x350fb9f5,0x350f3f81,0x350eaef6
.long 0x350e086b,0x350c79bc,0x350a946b,0x350859a3,0x350a946b,0x35071c9e,0x3502e961,0x34fc010d
.long 0x3505cac4,0x34ff6e83,0x34f0d1bf,0x34dfe343,0x34ff6e83,0x34eccc40,0x34d69a35,0x34bd2dd7
.long 0x34f0d1bf,0x34d69a35,0x34b7bd6c,0x3494e66a,0x34dfe343,0x34bd2dd7,0x3494e66a,0x34507936
.long 0x34cccccd,0x34a0e90b,0x345dac86,0x33e2044b,0x34b7bd6c,0x348238aa,0x340cbfc9,0x326373e9
.long 0x34a0e90b,0x344325bf,0x33631c41,0xb3a9fda1,0x348887f5,0x33fdd580,0xb2e3625f,0xb435b431
.long 0x345dac86,0x33631c41,0xb3e2044b,0xb48887f5,0x3428269e,0xb26373e9,0xb44325bf,0xb4b230ab
.long 0x33e2044b,0xb3a9fda1,0xb48887f5,0xb4d69a35,0x33631c41,0xb41a7f1d,0xb4ac886f,0xb4f4b21b
.long 0x3510d0c3,0x3510d0c3,0x3510d0c3,0x3510d0c3,0x350e086b,0x350d4bf9,0x350c79bc,0x350b91d7
.long 0x3505cac4,0x3502e961,0x34ff6e83,0x34f86cbc,0x34f0d1bf,0x34e4545b,0x34d69a35,0x34c7b658
.long 0x34cccccd,0x34b7bd6c,0x34a0e90b,0x348887f5,0x34a0e90b,0x348238aa,0x344325bf,0x33fdd580
.long 0x345dac86,0x340cbfc9,0x33631c41,0xb2e3625f,0x33e2044b,0x326373e9,0xb3a9fda1,0xb435b431
.long 0x1a1fbd9e,0xb3e2044b,0xb45dac86,0xb4a0e90b,0xb3e2044b,0xb46abda8,0xb4ac886f,0xb4db4fa5
.long 0xb45dac86,0xb4ac886f,0xb4dfe343,0xb502e961,0xb4a0e90b,0xb4db4fa5,0xb502e961,0xb50eaef6
.long 0xb4cccccd,0xb4ff6e83,0xb50e086b,0xb5101e3f,0xb4f0d1bf,0xb50b91d7,0xb510a41b,0xb5071c9e
.long 0xb505cac4,0xb510a41b,0xb50a946b,0xb4e8a23d,0xb50e086b,0xb50eaef6,0xb4f86cbc,0xb4b230ab
.long 0x3510d0c3,0x3510d0c3,0x3510d0c3,0x3510d0c3,0x350a946b,0x350981a1,0x350859a3,0x35071c9e
.long 0x34f0d1bf,0x34e8a23d,0x34dfe343,0x34d69a35,0x34b7bd6c,0x34a6c599,0x3494e66a,0x348238aa
.long 0x345dac86,0x3428269e,0x33e2044b,0x33631c41,0x33631c41,0xb26373e9,0xb3a9fda1,0xb41a7f1d
.long 0xb3e2044b,0xb44325bf,0xb48887f5,0xb4ac886f,0xb48887f5,0xb4b230ab,0xb4d69a35,0xb4f4b21b
.long 0xb4cccccd,0xb4f0d1bf,0xb505cac4,0xb50e086b,0xb4ff6e83,0xb50b91d7,0xb510a41b,0xb50eaef6
.long 0xb50e086b,0xb510a41b,0xb50a946b,0xb4f86cbc,0xb5101e3f,0xb5071c9e,0xb4e8a23d,0xb4b230ab
.long 0xb505cac4,0xb4dfe343,0xb4a0e90b,0xb428269e,0xb4dfe343,0xb49af3ad,0xb40cbfc9,0x332a73dd
.long 0xb4a0e90b,0xb40cbfc9,0x33631c41,0x3477aa97,0xb428269e,0x332a73dd,0x3477aa97,0x34d1c3ad
.long 0,0,0,0,0,0x326373e9,0x32e3625f,0x332a73dd
.long 0,0x32e3625f,0x33631c41,0x33a9fda1,0,0x332a73dd,0x33a9fda1,0x33fdd580
.long 0,0x33631c41,0x33e2044b,0x3428269e,0,0x338dd0d0,0x340cbfc9,0x34507936
.long 0,0x33a9fda1,0x3428269e,0x3477aa97,0,0x33c6103c,0x344325bf,0x348ec231
.long 0,0x33e2044b,0x345dac86,0x34a0e90b,0,0x33fdd580,0x3477aa97,0x34b230ab
.long 0,0x340cbfc9,0x348887f5,0x34c28117,0,0x341a7f1d,0x3494e66a,0x34d1c3ad
.long 0,0x3428269e,0x34a0e90b,0x34dfe343,0,0x3435b431,0x34ac886f,0x34eccc40
.long 0,0x344325bf,0x34b7bd6c,0x34f86cbc,0,0x34507936,0x34c28117,0x35015a4a
.long 0,0,0,0,0x33631c41,0x338dd0d0,0x33a9fda1,0x33c6103c
.long 0x33e2044b,0x340cbfc9,0x3428269e,0x344325bf,0x3428269e,0x34507936,0x3477aa97,0x348ec231
.long 0x345dac86,0x348887f5,0x34a0e90b,0x34b7bd6c,0x348887f5,0x34a6c599,0x34c28117,0x34db4fa5
.long 0x34a0e90b,0x34c28117,0x34dfe343,0x34f86cbc,0x34b7bd6c,0x34db4fa5,0x34f86cbc,0x35071c9e
.long 0x34cccccd,0x34f0d1bf,0x3505cac4,0x350e086b,0x34dfe343,0x35015a4a,0x350c79bc,0x3510c598
.long 0x34f0d1bf,0x350859a3,0x35101e3f,0x350f3f81,0x34ff6e83,0x350d4bf9,0x3510a41b,0x350981a1
.long 0x3505cac4,0x35101e3f,0x350e086b,0x34ff6e83,0x350a946b,0x3510c598,0x350859a3,0x34e4545b
.long 0x350e086b,0x350f3f81,0x34ff6e83,0x34c28117,0x35101e3f,0x350b91d7,0x34e8a23d,0x349af3ad
.long 0,0,0,0,0x33e2044b,0x33fdd580,0x340cbfc9,0x341a7f1d
.long 0x345dac86,0x3477aa97,0x348887f5,0x3494e66a,0x34a0e90b,0x34b230ab,0x34c28117,0x34d1c3ad
.long 0x34cccccd,0x34dfe343,0x34f0d1bf,0x34ff6e83,0x34f0d1bf,0x35015a4a,0x350859a3,0x350d4bf9
.long 0x3505cac4,0x350c79bc,0x35101e3f,0x3510a41b,0x350e086b,0x3510c598,0x350f3f81,0x350981a1
.long 0x3510d0c3,0x350e086b,0x3505cac4,0x34f0d1bf,0x350e086b,0x35046447,0x34e8a23d,0x34bd2dd7
.long 0x3505cac4,0x34e8a23d,0x34b7bd6c,0x3477aa97,0x34f0d1bf,0x34bd2dd7,0x3477aa97,0x33c6103c
.long 0x34cccccd,0x348887f5,0x33e2044b,0xb3631c41,0x34a0e90b,0x341a7f1d,0xb2e3625f,0xb4507936
.long 0x345dac86,0x32e3625f,0xb428269e,0xb4ac886f,0x33e2044b,0xb3c6103c,0xb494e66a,0xb4e4545b
.long 0,0,0,0,0x3428269e,0x3435b431,0x344325bf,0x34507936
.long 0x34a0e90b,0x34ac886f,0x34b7bd6c,0x34c28117,0x34dfe343,0x34eccc40,0x34f86cbc,0x35015a4a
.long 0x3505cac4,0x350a946b,0x350e086b,0x35101e3f,0x35101e3f,0x3510c598,0x350f3f81,0x350b91d7
.long 0x350e086b,0x350859a3,0x34ff6e83,0x34e8a23d,0x34ff6e83,0x34e4545b,0x34c28117,0x349af3ad
.long 0x34cccccd,0x34a0e90b,0x345dac86,0x33e2044b,0x348887f5,0x341a7f1d,0x32e3625f,0xb3c6103c
.long 0x33e2044b,0xb2e3625f,0xb428269e,0xb494e66a,0xb3631c41,0xb4507936,0xb4ac886f,0xb4e4545b
.long 0xb45dac86,0xb4b7bd6c,0xb4f0d1bf,0xb50a946b,0xb4b7bd6c,0xb4f4b21b,0xb50c79bc,0xb5106c4f
.long 0xb4f0d1bf,0xb50c79bc,0xb5101e3f,0xb502e961,0xb50a946b,0xb5106c4f,0xb502e961,0xb4c7b658
.long 0x3f80,0x3f80,0x3f80,0x3f80,0x3f80,0x3ec43f6d,0x3f353f35,0x3f6d3ec4
.long 0x3f80,0x3f353f35,0x3f80248d,0x3f35bf35,0x3f80,0x3f6d3ec4,0x3f35bf35,0xbec4bf6d
.long 0x3f80,0x3f80248d,0x250dbf80,0xbf80a554,0x3f80,0x3f6dbec4,0xbf35bf35,0xbec43f6d
.long 0x3f80,0x3f35bf35,0xbf80a554,0x3f353f35,0x3f80,0x3ec4bf6d,0xbf353f35,0x3f6dbec4
.long 0x3f80,0x250dbf80,0x3f80,0x250dbf80,0x3f80,0xbec4bf6d,0x3f353f35,0xbf6dbec4
.long 0x3f80,0xbf35bf35,0x3f80248d,0xbf353f35,0x3f80,0xbf6dbec4,0x3f35bf35,0x3ec43f6d
.long 0x3f80,0xbf80a554,0x250dbf80,0x3f80248d,0x3f80,0xbf6d3ec4,0xbf35bf35,0x3ec4bf6d
.long 0x3f80,0xbf353f35,0xbf80a554,0xbf35bf35,0x3f80,0xbec43f6d,0xbf353f35,0xbf6d3ec4
.long 0x3f80,0x3f80,0x3f80,0x3f80,0x3f80248d,0x3f6dbec4,0x3f35bf35,0x3ec4bf6d
.long 0x250dbf80,0xbf35bf35,0xbf80a554,0xbf353f35,0xbf80a554,0xbec43f6d,0x3f353f35,0x3f6dbec4
.long 0x3f80,0x3f80248d,0x250dbf80,0xbf80a554,0x3f80248d,0xbec4bf6d,0xbf353f35,0x3f6d3ec4
.long 0x250dbf80,0xbf353f35,0x3f80248d,0xbf35bf35,0xbf80a554,0x3f6d3ec4,0xbf35bf35,0x3ec43f6d
.long 0x3f80,0x250dbf80,0x3f80,0x250dbf80,0x3f80248d,0xbf6d3ec4,0x3f35bf35,0xbec43f6d
.long 0x250dbf80,0x3f353f35,0xbf80a554,0x3f35bf35,0xbf80a554,0x3ec4bf6d,0x3f353f35,0xbf6d3ec4
.long 0x3f80,0xbf80a554,0x250dbf80,0x3f80248d,0x3f80248d,0x3ec43f6d,0xbf353f35,0xbf6dbec4
.long 0x250dbf80,0x3f35bf35,0x3f80248d,0x3f353f35,0xbf80a554,0xbf6dbec4,0xbf35bf35,0xbec4bf6d
.long 0x3f80,0x3f80,0x3f80,0x3f80,0x250dbf80,0xbec4bf6d,0xbf35bf35,0xbf6dbec4
.long 0x3f80,0x3f353f35,0x3f80248d,0x3f35bf35,0x250dbf80,0xbf6dbec4,0xbf353f35,0x3ec43f6d
.long 0x3f80,0x3f80248d,0x250dbf80,0xbf80a554,0x250dbf80,0xbf6d3ec4,0x3f353f35,0x3ec4bf6d
.long 0x3f80,0x3f35bf35,0xbf80a554,0x3f353f35,0x250dbf80,0xbec43f6d,0x3f35bf35,0xbf6d3ec4
.long 0x3f80,0x250dbf80,0x3f80,0x250dbf80,0x250dbf80,0x3ec43f6d,0xbf35bf35,0x3f6d3ec4
.long 0x3f80,0xbf35bf35,0x3f80248d,0xbf353f35,0x250dbf80,0x3f6d3ec4,0xbf353f35,0xbec4bf6d
.long 0x3f80,0xbf80a554,0x250dbf80,0x3f80248d,0x250dbf80,0x3f6dbec4,0x3f353f35,0xbec43f6d
.long 0x3f80,0xbf353f35,0xbf80a554,0xbf35bf35,0x250dbf80,0x3ec4bf6d,0x3f35bf35,0x3f6dbec4
.long 0x3f80,0x3f80,0x3f80,0x3f80,0xbf80a554,0xbf6d3ec4,0xbf353f35,0xbec43f6d
.long 0x250dbf80,0xbf35bf35,0xbf80a554,0xbf353f35,0x3f80248d,0x3ec4bf6d,0xbf35bf35,0xbf6d3ec4
.long 0x3f80,0x3f80248d,0x250dbf80,0xbf80a554,0xbf80a554,0x3ec43f6d,0x3f35bf35,0xbf6dbec4
.long 0x250dbf80,0xbf353f35,0x3f80248d,0xbf35bf35,0x3f80248d,0xbf6dbec4,0x3f353f35,0xbec4bf6d
.long 0x3f80,0x250dbf80,0x3f80,0x250dbf80,0xbf80a554,0x3f6dbec4,0xbf353f35,0x3ec4bf6d
.long 0x250dbf80,0x3f353f35,0xbf80a554,0x3f35bf35,0x3f80248d,0xbec43f6d,0xbf35bf35,0x3f6dbec4
.long 0x3f80,0xbf80a554,0x250dbf80,0x3f80248d,0xbf80a554,0xbec4bf6d,0x3f35bf35,0x3f6d3ec4
.long 0x250dbf80,0x3f35bf35,0x3f80248d,0x3f353f35,0x3f80248d,0x3f6d3ec4,0x3f353f35,0x3ec43f6d
.long 0x3f808000,0x3f808000,0x3f808000,0x3f808000,0x3f808000,0x3f6dbec4,0x3f35bf35,0x3ec4bf6d
.long 0x3f808000,0x3f35bf35,0x248dbf80,0xbf35bf35,0x3f808000,0x3ec4bf6d,0xbf35bf35,0xbf6d3ec4
.long 0x3f808000,0x248dbf80,0xbf80a50d,0xa5543f80,0x3f808000,0xbec4bf6d,0xbf353f35,0x3f6d3ec4
.long 0x3f808000,0xbf35bf35,0xa5543f80,0x3f35bf35,0x3f808000,0xbf6dbec4,0x3f353f35,0xbec4bf6d
.long 0x3f808000,0xbf80a50d,0x3f808000,0xbf80a50d,0x3f808000,0xbf6d3ec4,0x3f35bf35,0xbec43f6d
.long 0x3f808000,0xbf353f35,0x248dbf80,0x3f353f35,0x3f808000,0xbec43f6d,0xbf35bf35,0x3f6dbec4
.long 0x3f808000,0xa5543f80,0xbf80a50d,0x248dbf80,0x3f808000,0x3ec43f6d,0xbf353f35,0xbf6dbec4
.long 0x3f808000,0x3f353f35,0xa5543f80,0xbf353f35,0x3f808000,0x3f6d3ec4,0x3f353f35,0x3ec43f6d
.long 0x3f808000,0x3f808000,0x3f808000,0x3f808000,0x248dbf80,0xbec4bf6d,0xbf35bf35,0xbf6dbec4
.long 0xbf80a50d,0xbf353f35,0xa5543f80,0x3f353f35,0xa5543f80,0x3f6d3ec4,0x3f35bf35,0xbec4bf6d
.long 0x3f808000,0x248dbf80,0xbf80a50d,0xa5543f80,0x248dbf80,0xbf6d3ec4,0x3f353f35,0x3ec4bf6d
.long 0xbf80a50d,0x3f353f35,0x248dbf80,0xbf353f35,0xa5543f80,0x3ec4bf6d,0xbf353f35,0x3f6dbec4
.long 0x3f808000,0xbf80a50d,0x3f808000,0xbf80a50d,0x248dbf80,0x3ec43f6d,0xbf35bf35,0x3f6d3ec4
.long 0xbf80a50d,0x3f35bf35,0xa5543f80,0xbf35bf35,0xa5543f80,0xbf6dbec4,0x3f35bf35,0x3ec43f6d
.long 0x3f808000,0xa5543f80,0xbf80a50d,0x248dbf80,0x248dbf80,0x3f6dbec4,0x3f353f35,0xbec43f6d
.long 0xbf80a50d,0xbf35bf35,0x248dbf80,0x3f35bf35,0xa5543f80,0xbec43f6d,0xbf353f35,0xbf6d3ec4
.long 0x3f808000,0x3f808000,0x3f808000,0x3f808000,0xbf80a50d,0xbf6d3ec4,0xbf353f35,0xbec43f6d
.long 0x3f808000,0x3f35bf35,0x248dbf80,0xbf35bf35,0xbf80a50d,0xbec43f6d,0x3f353f35,0x3f6dbec4
.long 0x3f808000,0x248dbf80,0xbf80a50d,0xa5543f80,0xbf80a50d,0x3ec43f6d,0x3f35bf35,0xbf6dbec4
.long 0x3f808000,0xbf35bf35,0xa5543f80,0x3f35bf35,0xbf80a50d,0x3f6d3ec4,0xbf35bf35,0x3ec43f6d
.long 0x3f808000,0xbf80a50d,0x3f808000,0xbf80a50d,0xbf80a50d,0x3f6dbec4,0xbf353f35,0x3ec4bf6d
.long 0x3f808000,0xbf353f35,0x248dbf80,0x3f353f35,0xbf80a50d,0x3ec4bf6d,0x3f353f35,0xbf6d3ec4
.long 0x3f808000,0xa5543f80,0xbf80a50d,0x248dbf80,0xbf80a50d,0xbec4bf6d,0x3f35bf35,0x3f6d3ec4
.long 0x3f808000,0x3f353f35,0xa5543f80,0xbf353f35,0xbf80a50d,0xbf6dbec4,0xbf35bf35,0xbec4bf6d
.long 0x3f808000,0x3f808000,0x3f808000,0x3f808000,0xa5543f80,0x3ec43f6d,0x3f353f35,0x3f6d3ec4
.long 0xbf80a50d,0xbf353f35,0xa5543f80,0x3f353f35,0x248dbf80,0xbf6dbec4,0xbf353f35,0x3ec43f6d
.long 0x3f808000,0x248dbf80,0xbf80a50d,0xa5543f80,0xa5543f80,0x3f6dbec4,0xbf35bf35,0xbec43f6d
.long 0xbf80a50d,0x3f353f35,0x248dbf80,0xbf353f35,0x248dbf80,0xbec43f6d,0x3f35bf35,0xbf6d3ec4
.long 0x3f808000,0xbf80a50d,0x3f808000,0xbf80a50d,0xa5543f80,0xbec4bf6d,0x3f353f35,0xbf6dbec4
.long 0xbf80a50d,0x3f35bf35,0xa5543f80,0xbf35bf35,0x248dbf80,0x3f6d3ec4,0xbf353f35,0xbec4bf6d
.long 0x3f808000,0xa5543f80,0xbf80a50d,0x248dbf80,0xa5543f80,0xbf6d3ec4,0xbf35bf35,0x3ec4bf6d
.long 0xbf80a50d,0xbf35bf35,0x248dbf80,0x3f35bf35,0x248dbf80,0x3ec4bf6d,0x3f35bf35,0x3f6dbec4
.long 0x80003f80,0x80003f80,0x80003f80,0x80003f80,0x80003f80,0xbec43f6d,0xbf353f35,0xbf6d3ec4
.long 0x80003f80,0xbf353f35,0xbf80248d,0xbf35bf35,0x80003f80,0xbf6d3ec4,0xbf35bf35,0x3ec4bf6d
.long 0x80003f80,0xbf80248d,0xa50dbf80,0x3f80a554,0x80003f80,0xbf6dbec4,0x3f35bf35,0x3ec43f6d
.long 0x80003f80,0xbf35bf35,0x3f80a554,0xbf353f35,0x80003f80,0xbec4bf6d,0x3f353f35,0xbf6dbec4
.long 0x80003f80,0xa50dbf80,0x80003f80,0xa50dbf80,0x80003f80,0x3ec4bf6d,0xbf353f35,0x3f6dbec4
.long 0x80003f80,0x3f35bf35,0xbf80248d,0x3f353f35,0x80003f80,0x3f6dbec4,0xbf35bf35,0xbec43f6d
.long 0x80003f80,0x3f80a554,0xa50dbf80,0xbf80248d,0x80003f80,0x3f6d3ec4,0x3f35bf35,0xbec4bf6d
.long 0x80003f80,0x3f353f35,0x3f80a554,0x3f35bf35,0x80003f80,0x3ec43f6d,0x3f353f35,0x3f6d3ec4
.long 0x80003f80,0x80003f80,0x80003f80,0x80003f80,0xbf80248d,0xbf6dbec4,0xbf35bf35,0xbec4bf6d
.long 0xa50dbf80,0x3f35bf35,0x3f80a554,0x3f353f35,0x3f80a554,0x3ec43f6d,0xbf353f35,0xbf6dbec4
.long 0x80003f80,0xbf80248d,0xa50dbf80,0x3f80a554,0xbf80248d,0x3ec4bf6d,0x3f353f35,0xbf6d3ec4
.long 0xa50dbf80,0x3f353f35,0xbf80248d,0x3f35bf35,0x3f80a554,0xbf6d3ec4,0x3f35bf35,0xbec43f6d
.long 0x80003f80,0xa50dbf80,0x80003f80,0xa50dbf80,0xbf80248d,0x3f6d3ec4,0xbf35bf35,0x3ec43f6d
.long 0xa50dbf80,0xbf353f35,0x3f80a554,0xbf35bf35,0x3f80a554,0xbec4bf6d,0xbf353f35,0x3f6d3ec4
.long 0x80003f80,0x3f80a554,0xa50dbf80,0xbf80248d,0xbf80248d,0xbec43f6d,0x3f353f35,0x3f6dbec4
.long 0xa50dbf80,0xbf35bf35,0xbf80248d,0xbf353f35,0x3f80a554,0x3f6dbec4,0x3f35bf35,0x3ec4bf6d
.long 0x80003f80,0x80003f80,0x80003f80,0x80003f80,0xa50dbf80,0x3ec4bf6d,0x3f35bf35,0x3f6dbec4
.long 0x80003f80,0xbf353f35,0xbf80248d,0xbf35bf35,0xa50dbf80,0x3f6dbec4,0x3f353f35,0xbec43f6d
.long 0x80003f80,0xbf80248d,0xa50dbf80,0x3f80a554,0xa50dbf80,0x3f6d3ec4,0xbf353f35,0xbec4bf6d
.long 0x80003f80,0xbf35bf35,0x3f80a554,0xbf353f35,0xa50dbf80,0x3ec43f6d,0xbf35bf35,0x3f6d3ec4
.long 0x80003f80,0xa50dbf80,0x80003f80,0xa50dbf80,0xa50dbf80,0xbec43f6d,0x3f35bf35,0xbf6d3ec4
.long 0x80003f80,0x3f35bf35,0xbf80248d,0x3f353f35,0xa50dbf80,0xbf6d3ec4,0x3f353f35,0x3ec4bf6d
.long 0x80003f80,0x3f80a554,0xa50dbf80,0xbf80248d,0xa50dbf80,0xbf6dbec4,0xbf353f35,0x3ec43f6d
.long 0x80003f80,0x3f353f35,0x3f80a554,0x3f35bf35,0xa50dbf80,0xbec4bf6d,0xbf35bf35,0xbf6dbec4
.long 0x80003f80,0x80003f80,0x80003f80,0x80003f80,0x3f80a554,0x3f6d3ec4,0x3f353f35,0x3ec43f6d
.long 0xa50dbf80,0x3f35bf35,0x3f80a554,0x3f353f35,0xbf80248d,0xbec4bf6d,0x3f35bf35,0x3f6d3ec4
.long 0x80003f80,0xbf80248d,0xa50dbf80,0x3f80a554,0x3f80a554,0xbec43f6d,0xbf35bf35,0x3f6dbec4
.long 0xa50dbf80,0x3f353f35,0xbf80248d,0x3f35bf35,0xbf80248d,0x3f6dbec4,0xbf353f35,0x3ec4bf6d
.long 0x80003f80,0xa50dbf80,0x80003f80,0xa50dbf80,0x3f80a554,0xbf6dbec4,0x3f353f35,0xbec4bf6d
.long 0xa50dbf80,0xbf353f35,0x3f80a554,0xbf35bf35,0xbf80248d,0x3ec43f6d,0x3f35bf35,0xbf6dbec4
.long 0x80003f80,0x3f80a554,0xa50dbf80,0xbf80248d,0x3f80a554,0x3ec4bf6d,0xbf35bf35,0xbf6d3ec4
.long 0xa50dbf80,0xbf35bf35,0xbf80248d,0xbf353f35,0xbf80248d,0xbf6d3ec4,0xbf353f35,0xbec43f6d
.long 0x3f800000,0x3f800000,0x3f800000,0x3f800000,0x3f800000,0x3f6d3ec4,0x3f353f35,0x3ec43f6d
.long 0x3f800000,0x3f353f35,0x248d3f80,0xbf353f35,0x3f800000,0x3ec43f6d,0xbf353f35,0xbf6dbec4
.long 0x3f800000,0x248d3f80,0xbf80250d,0xa554bf80,0x3f800000,0xbec43f6d,0xbf35bf35,0x3f6dbec4
.long 0x3f800000,0xbf353f35,0xa554bf80,0x3f353f35,0x3f800000,0xbf6d3ec4,0x3f35bf35,0xbec43f6d
.long 0x3f800000,0xbf80250d,0x3f800000,0xbf80250d,0x3f800000,0xbf6dbec4,0x3f353f35,0xbec4bf6d
.long 0x3f800000,0xbf35bf35,0x248d3f80,0x3f35bf35,0x3f800000,0xbec4bf6d,0xbf353f35,0x3f6d3ec4
.long 0x3f800000,0xa554bf80,0xbf80250d,0x248d3f80,0x3f800000,0x3ec4bf6d,0xbf35bf35,0xbf6d3ec4
.long 0x3f800000,0x3f35bf35,0xa554bf80,0xbf35bf35,0x3f800000,0x3f6dbec4,0x3f35bf35,0x3ec4bf6d
.long 0x3f800000,0x3f800000,0x3f800000,0x3f800000,0x248d3f80,0xbec43f6d,0xbf353f35,0xbf6d3ec4
.long 0xbf80250d,0xbf35bf35,0xa554bf80,0x3f35bf35,0xa554bf80,0x3f6dbec4,0x3f353f35,0xbec43f6d
.long 0x3f800000,0x248d3f80,0xbf80250d,0xa554bf80,0x248d3f80,0xbf6dbec4,0x3f35bf35,0x3ec43f6d
.long 0xbf80250d,0x3f35bf35,0x248d3f80,0xbf35bf35,0xa554bf80,0x3ec43f6d,0xbf35bf35,0x3f6d3ec4
.long 0x3f800000,0xbf80250d,0x3f800000,0xbf80250d,0x248d3f80,0x3ec4bf6d,0xbf353f35,0x3f6dbec4
.long 0xbf80250d,0x3f353f35,0xa554bf80,0xbf353f35,0xa554bf80,0xbf6d3ec4,0x3f353f35,0x3ec4bf6d
.long 0x3f800000,0xa554bf80,0xbf80250d,0x248d3f80,0x248d3f80,0x3f6d3ec4,0x3f35bf35,0xbec4bf6d
.long 0xbf80250d,0xbf353f35,0x248d3f80,0x3f353f35,0xa554bf80,0xbec4bf6d,0xbf35bf35,0xbf6dbec4
.long 0x3f800000,0x3f800000,0x3f800000,0x3f800000,0xbf80250d,0xbf6dbec4,0xbf35bf35,0xbec4bf6d
.long 0x3f800000,0x3f353f35,0x248d3f80,0xbf353f35,0xbf80250d,0xbec4bf6d,0x3f35bf35,0x3f6d3ec4
.long 0x3f800000,0x248d3f80,0xbf80250d,0xa554bf80,0xbf80250d,0x3ec4bf6d,0x3f353f35,0xbf6d3ec4
.long 0x3f800000,0xbf353f35,0xa554bf80,0x3f353f35,0xbf80250d,0x3f6dbec4,0xbf353f35,0x3ec4bf6d
.long 0x3f800000,0xbf80250d,0x3f800000,0xbf80250d,0xbf80250d,0x3f6d3ec4,0xbf35bf35,0x3ec43f6d
.long 0x3f800000,0xbf35bf35,0x248d3f80,0x3f35bf35,0xbf80250d,0x3ec43f6d,0x3f35bf35,0xbf6dbec4
.long 0x3f800000,0xa554bf80,0xbf80250d,0x248d3f80,0xbf80250d,0xbec43f6d,0x3f353f35,0x3f6dbec4
.long 0x3f800000,0x3f35bf35,0xa554bf80,0xbf35bf35,0xbf80250d,0xbf6d3ec4,0xbf353f35,0xbec43f6d
.long 0x3f800000,0x3f800000,0x3f800000,0x3f800000,0xa554bf80,0x3ec4bf6d,0x3f35bf35,0x3f6dbec4
.long 0xbf80250d,0xbf35bf35,0xa554bf80,0x3f35bf35,0x248d3f80,0xbf6d3ec4,0xbf35bf35,0x3ec4bf6d
.long 0x3f800000,0x248d3f80,0xbf80250d,0xa554bf80,0xa554bf80,0x3f6d3ec4,0xbf353f35,0xbec4bf6d
.long 0xbf80250d,0x3f35bf35,0x248d3f80,0xbf35bf35,0x248d3f80,0xbec4bf6d,0x3f353f35,0xbf6dbec4
.long 0x3f800000,0xbf80250d,0x3f800000,0xbf80250d,0xa554bf80,0xbec43f6d,0x3f35bf35,0xbf6d3ec4
.long 0xbf80250d,0x3f353f35,0xa554bf80,0xbf353f35,0x248d3f80,0x3f6dbec4,0xbf35bf35,0xbec43f6d
.long 0x3f800000,0xa554bf80,0xbf80250d,0x248d3f80,0xa554bf80,0xbf6dbec4,0xbf353f35,0x3ec43f6d
.long 0xbf80250d,0xbf353f35,0x248d3f80,0x3f353f35,0x248d3f80,0x3ec43f6d,0x3f353f35,0x3f6d3ec4
.long 0x3f800000,0x3f800000,0x40000000,0x80000000,0x3f800000,0xbf800000,0x3fb504f3,0xbfb504f3
.long 0x3f800000,0x3f800000,0,0xc0000000,0x3f800000,0xbf800000,0xbfb504f3,0xbfb504f3
.long 0,0,0,0,0,0,0,0
.long 0,0,0,0,0,0,0,0
.long 0,0,0,0,0,0,0,0
.long 0,0,0,0,0,0,0,0
.long 0,0,0,0,0,0,0,0
.long 0,0,0,0,0,0,0,0
.long 0,0,0,0,0,0,0,0
.long 0,0,0,0,0,0,0,0
.long 0x3f800000,0x3f800000,0x40000000,0x80000000,0x3f800000,0xbf800000,0x3fb504f3,0xbfb504f3
.long 0x3f800000,0x3f800000,0,0xc0000000,0x3f800000,0xbf800000,0xbfb504f3,0xbfb504f3
.long 0,0,0,0,0,0,0,0
.long 0,0,0,0,0,0,0,0
.long 0,0,0,0,0,0,0,0
.long 0,0,0,0,0,0,0,0
.long 0,0,0,0,0,0,0,0
.long 0,0,0,0,0,0,0,0
.long 0,0,0,0,0,0,0,0
.long 0,0,0,0,0,0,0,0
.long 0x3f800000,0x3f800000,0x40000000,0x80000000,0x3f800000,0xbf800000,0x3fb504f3,0xbfb504f3
.long 0x3f800000,0x3f800000,0,0xc0000000,0x3f800000,0xbf800000,0xbfb504f3,0xbfb504f3
.long 0,0,0,0,0,0,0,0
.long 0,0,0,0,0,0,0,0
.long 0,0,0,0,0,0,0,0
.long 0,0,0,0,0,0,0,0
.long 0,0,0,0,0,0,0,0
.long 0,0,0,0,0,0,0,0
.long 0,0,0,0,0,0,0,0
.long 0,0,0,0,0,0,0,0
.long 0x3f800000,0x3f800000,0x40000000,0x80000000,0x3f800000,0xbf800000,0x3fb504f3,0xbfb504f3
.long 0x3f800000,0x3f800000,0,0xc0000000,0x3f800000,0xbf800000,0xbfb504f3,0xbfb504f3
.long 0x40000000,0x80000000,0x40000000,0x80000000,0,0xc0000000,0xbfb504f3,0xbfb504f3
.long 0xc0000000,0x80000000,0x80000000,0x40000000,0x80000000,0x40000000,0x3fb504f3,0xbfb504f3
.long 0,0,0,0,0,0,0,0
.long 0,0,0,0,0,0,0,0
.long 0,0,0,0,0,0,0,0
.long 0,0,0,0,0,0,0,0
.long 0,0,0,0,0,0,0,0
.long 0,0,0,0,0,0,0,0
.long 0,0,0,0,0,0,0,0
.long 0,0,0,0,0,0,0,0
.long 0x40000000,0x80000000,0x40000000,0x80000000,0,0xc0000000,0xbfb504f3,0xbfb504f3
.long 0xc0000000,0x80000000,0x80000000,0x40000000,0x80000000,0x40000000,0x3fb504f3,0xbfb504f3
.long 0,0,0,0,0,0,0,0
.long 0,0,0,0,0,0,0,0
.long 0,0,0,0,0,0,0,0
.long 0,0,0,0,0,0,0,0
.long 0,0,0,0,0,0,0,0
.long 0,0,0,0,0,0,0,0
.long 0,0,0,0,0,0,0,0
.long 0,0,0,0,0,0,0,0
.long 0x40000000,0x80000000,0x40000000,0x80000000,0,0xc0000000,0xbfb504f3,0xbfb504f3
.long 0xc0000000,0x80000000,0x80000000,0x40000000,0x80000000,0x40000000,0x3fb504f3,0xbfb504f3
.long 0,0,0,0,0,0,0,0
.long 0,0,0,0,0,0,0,0
.long 0,0,0,0,0,0,0,0
.long 0,0,0,0,0,0,0,0
.long 0,0,0,0,0,0,0,0
.long 0,0,0,0,0,0,0,0
.long 0,0,0,0,0,0,0,0
.long 0,0,0,0,0,0,0,0
.long 0x40000000,0x80000000,0x40000000,0x80000000,0,0xc0000000,0xbfb504f3,0xbfb504f3
.long 0xc0000000,0x80000000,0x80000000,0x40000000,0x80000000,0x40000000,0x3fb504f3,0xbfb504f3
.long 0x3f80,0x3d493f80,0x3dc93f7f,0x3e163f7d,0x3f80,0x3edb3f67,0x3f463f22,0x3f783e79
.long 0x3f80,0x3f3e3f2c,0x3f7fbdc9,0x3f18bf4e,0x3f80,0x3f713eac,0x3f22bf46,0xbf04bf5c
.long 0x3f80,0x3f80bd49,0xbdc9bf7f,0xbf7d3e16,0x3f80,0x3f67bedb,0xbf46bf22,0xbe793f78
.long 0x3f80,0x3f2cbf3e,0xbf7f3dc9,0x3f4e3f18,0x3f80,0x3eacbf71,0xbf223f46,0x3f5cbf04
.long 0x3f80,0xbd49bf80,0x3dc93f7f,0xbe16bf7d,0x3f80,0xbedbbf67,0x3f463f22,0xbf78be79
.long 0x3f80,0xbf3ebf2c,0x3f7fbdc9,0xbf183f4e,0x3f80,0xbf71beac,0x3f22bf46,0x3f043f5c
.long 0x3f80,0xbf803d49,0xbdc9bf7f,0x3f7dbe16,0x3f80,0xbf673edb,0xbf46bf22,0x3e79bf78
.long 0x3f80,0xbf2c3f3e,0xbf7f3dc9,0xbf4ebf18,0x3f80,0xbeac3f71,0xbf223f46,0xbf5c3f04
.long 0x3e483f7b,0x3e793f78,0x3e953f75,0x3eac3f71,0x3f7bbe48,0x3f4ebf18,0x3ef1bf62,0x3d49bf80
.long 0xbe48bf7b,0xbf5cbf04,0xbf753e95,0xbedb3f67,0xbf7b3e48,0xbe163f7d,0x3f623ef1,0x3f3ebf2c
.long 0x3e483f7b,0x3f78be79,0xbe95bf75,0xbf713eac,0x3f7bbe48,0xbf18bf4e,0xbef13f62,0x3f803d49
.long 0xbe48bf7b,0xbf043f5c,0x3f75be95,0xbf67bedb,0xbf7b3e48,0x3f7d3e16,0xbf62bef1,0x3f2c3f3e
.long 0x3e483f7b,0xbe79bf78,0x3e953f75,0xbeacbf71,0x3f7bbe48,0xbf4e3f18,0x3ef1bf62,0xbd493f80
.long 0xbe48bf7b,0x3f5c3f04,0xbf753e95,0x3edbbf67,0xbf7b3e48,0x3e16bf7d,0x3f623ef1,0xbf3e3f2c
.long 0x3e483f7b,0xbf783e79,0xbe95bf75,0x3f71beac,0x3f7bbe48,0x3f183f4e,0xbef13f62,0xbf80bd49
.long 0xbe48bf7b,0x3f04bf5c,0x3f75be95,0x3f673edb,0xbf7b3e48,0xbf7dbe16,0xbf62bef1,0xbf2cbf3e
.long 0x3ec43f6d,0x3edb3f67,0x3ef13f62,0x3f043f5c,0xbec4bf6d,0xbf3ebf2c,0xbf75be95,0xbf7d3e16
.long 0x3ec43f6d,0x3f713eac,0x3f62bef1,0x3e79bf78,0xbec4bf6d,0xbf803d49,0xbe953f75,0x3f4e3f18
.long 0x3ec43f6d,0x3f67bedb,0xbef1bf62,0xbf5c3f04,0xbec4bf6d,0xbf2c3f3e,0x3f753e95,0xbe16bf7d
.long 0x3ec43f6d,0x3eacbf71,0xbf623ef1,0x3f783e79,0xbec4bf6d,0x3d493f80,0x3e95bf75,0xbf183f4e
.long 0x3ec43f6d,0xbedbbf67,0x3ef13f62,0xbf04bf5c,0xbec4bf6d,0x3f3e3f2c,0xbf75be95,0x3f7dbe16
.long 0x3ec43f6d,0xbf71beac,0x3f62bef1,0xbe793f78,0xbec4bf6d,0x3f80bd49,0xbe953f75,0xbf4ebf18
.long 0x3ec43f6d,0xbf673edb,0xbef1bf62,0x3f5cbf04,0xbec4bf6d,0x3f2cbf3e,0x3f753e95,0x3e163f7d
.long 0x3ec43f6d,0xbeac3f71,0xbf623ef1,0xbf78be79,0xbec4bf6d,0xbd49bf80,0x3e95bf75,0x3f18bf4e
.long 0x3f0e3f55,0x3f183f4e,0x3f223f46,0x3f2c3f3e,0xbf553f0e,0xbf043f5c,0xbdc93f7f,0x3eac3f71
.long 0xbf0ebf55,0xbf7dbe16,0xbf463f22,0xbd493f80,0x3f55bf0e,0xbe79bf78,0xbf7fbdc9,0xbedb3f67
.long 0x3f0e3f55,0x3f4ebf18,0xbf22bf46,0xbf3e3f2c,0xbf553f0e,0x3f5c3f04,0x3dc9bf7f,0xbf713eac
.long 0xbf0ebf55,0xbe163f7d,0x3f46bf22,0xbf80bd49,0x3f55bf0e,0xbf783e79,0x3f7f3dc9,0xbf67bedb
.long 0x3f0e3f55,0xbf18bf4e,0x3f223f46,0xbf2cbf3e,0xbf553f0e,0x3f04bf5c,0xbdc93f7f,0xbeacbf71
.long 0xbf0ebf55,0x3f7d3e16,0xbf463f22,0x3d49bf80,0x3f55bf0e,0x3e793f78,0xbf7fbdc9,0x3edbbf67
.long 0x3f0e3f55,0xbf4e3f18,0xbf22bf46,0x3f3ebf2c,0xbf553f0e,0xbf5cbf04,0x3dc9bf7f,0x3f71beac
.long 0xbf0ebf55,0x3e16bf7d,0x3f46bf22,0x3f803d49,0x3f55bf0e,0x3f78be79,0x3f7f3dc9,0x3f673edb
.long 0x3f808000,0x3f80bd49,0x3f7fbdc9,0x3f7dbe16,0x3f808000,0x3f67bedb,0x3f22bf46,0x3e79bf78
.long 0x3f808000,0x3f2cbf3e,0xbdc9bf7f,0xbf4ebf18,0x3f808000,0x3eacbf71,0xbf46bf22,0xbf5c3f04
.long 0x3f808000,0xbd49bf80,0xbf7f3dc9,0x3e163f7d,0x3f808000,0xbedbbf67,0xbf223f46,0x3f783e79
.long 0x3f808000,0xbf3ebf2c,0x3dc93f7f,0x3f18bf4e,0x3f808000,0xbf71beac,0x3f463f22,0xbf04bf5c
.long 0x3f808000,0xbf803d49,0x3f7fbdc9,0xbf7d3e16,0x3f808000,0xbf673edb,0x3f22bf46,0xbe793f78
.long 0x3f808000,0xbf2c3f3e,0xbdc9bf7f,0x3f4e3f18,0x3f808000,0xbeac3f71,0xbf46bf22,0x3f5cbf04
.long 0x3f808000,0x3d493f80,0xbf7f3dc9,0xbe16bf7d,0x3f808000,0x3edb3f67,0xbf223f46,0xbf78be79
.long 0x3f808000,0x3f3e3f2c,0x3dc93f7f,0xbf183f4e,0x3f808000,0x3f713eac,0x3f463f22,0x3f043f5c
.long 0x3f7bbe48,0x3f78be79,0x3f75be95,0x3f71beac,0xbe48bf7b,0xbf18bf4e,0xbf62bef1,0xbf80bd49
.long 0xbf7b3e48,0xbf043f5c,0x3e953f75,0x3f673edb,0x3e483f7b,0x3f7d3e16,0x3ef1bf62,0xbf2cbf3e
.long 0x3f7bbe48,0xbe79bf78,0xbf753e95,0x3eac3f71,0xbe48bf7b,0xbf4e3f18,0x3f623ef1,0x3d49bf80
.long 0xbf7b3e48,0x3f5c3f04,0xbe95bf75,0xbedb3f67,0x3e483f7b,0x3e16bf7d,0xbef13f62,0x3f3ebf2c
.long 0x3f7bbe48,0xbf783e79,0x3f75be95,0xbf713eac,0xbe48bf7b,0x3f183f4e,0xbf62bef1,0x3f803d49
.long 0xbf7b3e48,0x3f04bf5c,0x3e953f75,0xbf67bedb,0x3e483f7b,0xbf7dbe16,0x3ef1bf62,0x3f2c3f3e
.long 0x3f7bbe48,0x3e793f78,0xbf753e95,0xbeacbf71,0xbe48bf7b,0x3f4ebf18,0x3f623ef1,0xbd493f80
.long 0xbf7b3e48,0xbf5cbf04,0xbe95bf75,0x3edbbf67,0x3e483f7b,0xbe163f7d,0xbef13f62,0xbf3e3f2c
.long 0x3f6dbec4,0x3f67bedb,0x3f62bef1,0x3f5cbf04,0xbf6d3ec4,0xbf2c3f3e,0xbe953f75,0x3e163f7d
.long 0x3f6dbec4,0x3eacbf71,0xbef1bf62,0xbf78be79,0xbf6d3ec4,0x3d493f80,0x3f753e95,0x3f18bf4e
.long 0x3f6dbec4,0xbedbbf67,0xbf623ef1,0x3f043f5c,0xbf6d3ec4,0x3f3e3f2c,0x3e95bf75,0xbf7d3e16
.long 0x3f6dbec4,0xbf71beac,0x3ef13f62,0x3e79bf78,0xbf6d3ec4,0x3f80bd49,0xbf75be95,0x3f4e3f18
.long 0x3f6dbec4,0xbf673edb,0x3f62bef1,0xbf5c3f04,0xbf6d3ec4,0x3f2cbf3e,0xbe953f75,0xbe16bf7d
.long 0x3f6dbec4,0xbeac3f71,0xbef1bf62,0x3f783e79,0xbf6d3ec4,0xbd49bf80,0x3f753e95,0xbf183f4e
.long 0x3f6dbec4,0x3edb3f67,0xbf623ef1,0xbf04bf5c,0xbf6d3ec4,0xbf3ebf2c,0x3e95bf75,0x3f7dbe16
.long 0x3f6dbec4,0x3f713eac,0x3ef13f62,0xbe793f78,0xbf6d3ec4,0xbf803d49,0xbf75be95,0xbf4ebf18
.long 0x3f55bf0e,0x3f4ebf18,0x3f46bf22,0x3f3ebf2c,0x3f0e3f55,0x3f5c3f04,0x3f7f3dc9,0x3f71beac
.long 0xbf553f0e,0xbe163f7d,0x3f223f46,0x3f803d49,0xbf0ebf55,0xbf783e79,0xbdc93f7f,0x3f673edb
.long 0x3f55bf0e,0xbf18bf4e,0xbf463f22,0x3f2c3f3e,0x3f0e3f55,0x3f04bf5c,0xbf7fbdc9,0x3eac3f71
.long 0xbf553f0e,0x3f7d3e16,0xbf22bf46,0xbd493f80,0xbf0ebf55,0x3e793f78,0x3dc9bf7f,0xbedb3f67
.long 0x3f55bf0e,0xbf4e3f18,0x3f46bf22,0xbf3e3f2c,0x3f0e3f55,0xbf5cbf04,0x3f7f3dc9,0xbf713eac
.long 0xbf553f0e,0x3e16bf7d,0x3f223f46,0xbf80bd49,0xbf0ebf55,0x3f78be79,0xbdc93f7f,0xbf67bedb
.long 0x3f55bf0e,0x3f183f4e,0xbf463f22,0xbf2cbf3e,0x3f0e3f55,0xbf043f5c,0xbf7fbdc9,0xbeacbf71
.long 0xbf553f0e,0xbf7dbe16,0xbf22bf46,0x3d49bf80,0xbf0ebf55,0xbe79bf78,0x3dc9bf7f,0x3edbbf67
.long 0x80003f80,0x80003f80,0x80003f80,0x80003f80,0xbd493f80,0xbedb3f67,0xbf3e3f2c,0xbf713eac
.long 0xbdc93f7f,0xbf463f22,0xbf7fbdc9,0xbf22bf46,0xbe163f7d,0xbf783e79,0xbf18bf4e,0x3f04bf5c
.long 0xbe483f7b,0xbf7bbe48,0x3e48bf7b,0x3f7b3e48,0xbe793f78,0xbf4ebf18,0x3f5cbf04,0x3e163f7d
.long 0xbe953f75,0xbef1bf62,0x3f753e95,0xbf623ef1,0xbeac3f71,0xbd49bf80,0x3edb3f67,0xbf3ebf2c
.long 0xbec43f6d,0x3ec4bf6d,0xbec43f6d,0x3ec4bf6d,0xbedb3f67,0x3f3ebf2c,0xbf713eac,0x3f803d49
.long 0xbef13f62,0x3f75be95,0xbf62bef1,0x3e953f75,0xbf043f5c,0x3f7d3e16,0xbe79bf78,0xbf4e3f18
.long 0xbf0e3f55,0x3f553f0e,0x3f0ebf55,0xbf55bf0e,0xbf183f4e,0x3f043f5c,0x3f7dbe16,0x3e79bf78
.long 0xbf223f46,0x3dc93f7f,0x3f463f22,0x3f7fbdc9,0xbf2c3f3e,0xbeac3f71,0x3d493f80,0x3edb3f67
.long 0x80003f80,0x80003f80,0x80003f80,0x80003f80,0xbf80bd49,0xbf67bedb,0xbf2cbf3e,0xbeacbf71
.long 0x3dc9bf7f,0x3f46bf22,0x3f7f3dc9,0x3f223f46,0x3f7d3e16,0x3e793f78,0xbf4e3f18,0xbf5cbf04
.long 0xbe483f7b,0xbf7bbe48,0x3e48bf7b,0x3f7b3e48,0xbf78be79,0x3f18bf4e,0x3f043f5c,0xbf7d3e16
.long 0x3e95bf75,0x3ef13f62,0xbf75be95,0x3f62bef1,0x3f713eac,0xbf803d49,0x3f67bedb,0xbf2c3f3e
.long 0xbec43f6d,0x3ec4bf6d,0xbec43f6d,0x3ec4bf6d,0xbf67bedb,0x3f2c3f3e,0xbeacbf71,0xbd493f80
.long 0x3ef1bf62,0xbf753e95,0x3f623ef1,0xbe95bf75,0x3f5c3f04,0x3e16bf7d,0xbf783e79,0x3f183f4e
.long 0xbf0e3f55,0x3f553f0e,0x3f0ebf55,0xbf55bf0e,0xbf4ebf18,0xbf5c3f04,0x3e163f7d,0x3f783e79
.long 0x3f22bf46,0xbdc9bf7f,0xbf46bf22,0xbf7f3dc9,0x3f3e3f2c,0x3f713eac,0x3f80bd49,0x3f67bedb
.long 0x80003f80,0x80003f80,0x80003f80,0x80003f80,0x3d49bf80,0x3edbbf67,0x3f3ebf2c,0x3f71beac
.long 0xbdc93f7f,0xbf463f22,0xbf7fbdc9,0xbf22bf46,0x3e16bf7d,0x3f78be79,0x3f183f4e,0xbf043f5c
.long 0xbe483f7b,0xbf7bbe48,0x3e48bf7b,0x3f7b3e48,0x3e79bf78,0x3f4e3f18,0xbf5c3f04,0xbe16bf7d
.long 0xbe953f75,0xbef1bf62,0x3f753e95,0xbf623ef1,0x3eacbf71,0x3d493f80,0xbedbbf67,0x3f3e3f2c
.long 0xbec43f6d,0x3ec4bf6d,0xbec43f6d,0x3ec4bf6d,0x3edbbf67,0xbf3e3f2c,0x3f71beac,0xbf80bd49
.long 0xbef13f62,0x3f75be95,0xbf62bef1,0x3e953f75,0x3f04bf5c,0xbf7dbe16,0x3e793f78,0x3f4ebf18
.long 0xbf0e3f55,0x3f553f0e,0x3f0ebf55,0xbf55bf0e,0x3f18bf4e,0xbf04bf5c,0xbf7d3e16,0xbe793f78
.long 0xbf223f46,0x3dc93f7f,0x3f463f22,0x3f7fbdc9,0x3f2cbf3e,0x3eacbf71,0xbd49bf80,0xbedbbf67
.long 0x80003f80,0x80003f80,0x80003f80,0x80003f80,0x3f803d49,0x3f673edb,0x3f2c3f3e,0x3eac3f71
.long 0x3dc9bf7f,0x3f46bf22,0x3f7f3dc9,0x3f223f46,0xbf7dbe16,0xbe79bf78,0x3f4ebf18,0x3f5c3f04
.long 0xbe483f7b,0xbf7bbe48,0x3e48bf7b,0x3f7b3e48,0x3f783e79,0xbf183f4e,0xbf04bf5c,0x3f7dbe16
.long 0x3e95bf75,0x3ef13f62,0xbf75be95,0x3f62bef1,0xbf71beac,0x3f80bd49,0xbf673edb,0x3f2cbf3e
.long 0xbec43f6d,0x3ec4bf6d,0xbec43f6d,0x3ec4bf6d,0x3f673edb,0xbf2cbf3e,0x3eac3f71,0x3d49bf80
.long 0x3ef1bf62,0xbf753e95,0x3f623ef1,0xbe95bf75,0xbf5cbf04,0xbe163f7d,0x3f78be79,0xbf18bf4e
.long 0xbf0e3f55,0x3f553f0e,0x3f0ebf55,0xbf55bf0e,0x3f4e3f18,0x3f5cbf04,0xbe16bf7d,0xbf78be79
.long 0x3f22bf46,0xbdc9bf7f,0xbf46bf22,0xbf7f3dc9,0xbf3ebf2c,0xbf71beac,0xbf803d49,0xbf673edb
.long 0x3f800000,0x3f800000,0x3f800000,0x3f800000,0x3f803d49,0x3f673edb,0x3f2c3f3e,0x3eac3f71
.long 0x3f7f3dc9,0x3f223f46,0xbdc93f7f,0xbf463f22,0x3f7d3e16,0x3e793f78,0xbf4e3f18,0xbf5cbf04
.long 0x3f7b3e48,0xbe483f7b,0xbf7bbe48,0x3e48bf7b,0x3f783e79,0xbf183f4e,0xbf04bf5c,0x3f7dbe16
.long 0x3f753e95,0xbf623ef1,0x3e95bf75,0x3ef13f62,0x3f713eac,0xbf803d49,0x3f67bedb,0xbf2c3f3e
.long 0x3f6d3ec4,0xbf6dbec4,0x3f6d3ec4,0xbf6dbec4,0x3f673edb,0xbf2cbf3e,0x3eac3f71,0x3d49bf80
.long 0x3f623ef1,0xbe95bf75,0xbef13f62,0x3f75be95,0x3f5c3f04,0x3e16bf7d,0xbf783e79,0x3f183f4e
.long 0x3f553f0e,0x3f0ebf55,0xbf55bf0e,0xbf0e3f55,0x3f4e3f18,0x3f5cbf04,0xbe16bf7d,0xbf78be79
.long 0x3f463f22,0x3f7fbdc9,0x3f22bf46,0xbdc9bf7f,0x3f3e3f2c,0x3f713eac,0x3f80bd49,0x3f67bedb
.long 0x3f800000,0x3f800000,0x3f800000,0x3f800000,0xbd493f80,0xbedb3f67,0xbf3e3f2c,0xbf713eac
.long 0xbf7fbdc9,0xbf22bf46,0x3dc9bf7f,0x3f46bf22,0x3e16bf7d,0x3f78be79,0x3f183f4e,0xbf043f5c
.long 0x3f7b3e48,0xbe483f7b,0xbf7bbe48,0x3e48bf7b,0xbe793f78,0xbf4ebf18,0x3f5cbf04,0x3e163f7d
.long 0xbf75be95,0x3f62bef1,0xbe953f75,0xbef1bf62,0x3eacbf71,0x3d493f80,0xbedbbf67,0x3f3e3f2c
.long 0x3f6d3ec4,0xbf6dbec4,0x3f6d3ec4,0xbf6dbec4,0xbedb3f67,0x3f3ebf2c,0xbf713eac,0x3f803d49
.long 0xbf62bef1,0x3e953f75,0x3ef1bf62,0xbf753e95,0x3f04bf5c,0xbf7dbe16,0x3e793f78,0x3f4ebf18
.long 0x3f553f0e,0x3f0ebf55,0xbf55bf0e,0xbf0e3f55,0xbf183f4e,0x3f043f5c,0x3f7dbe16,0x3e79bf78
.long 0xbf46bf22,0xbf7f3dc9,0xbf223f46,0x3dc93f7f,0x3f2cbf3e,0x3eacbf71,0xbd49bf80,0xbedbbf67
.long 0x3f800000,0x3f800000,0x3f800000,0x3f800000,0xbf80bd49,0xbf67bedb,0xbf2cbf3e,0xbeacbf71
.long 0x3f7f3dc9,0x3f223f46,0xbdc93f7f,0xbf463f22,0xbf7dbe16,0xbe79bf78,0x3f4ebf18,0x3f5c3f04
.long 0x3f7b3e48,0xbe483f7b,0xbf7bbe48,0x3e48bf7b,0xbf78be79,0x3f18bf4e,0x3f043f5c,0xbf7d3e16
.long 0x3f753e95,0xbf623ef1,0x3e95bf75,0x3ef13f62,0xbf71beac,0x3f80bd49,0xbf673edb,0x3f2cbf3e
.long 0x3f6d3ec4,0xbf6dbec4,0x3f6d3ec4,0xbf6dbec4,0xbf67bedb,0x3f2c3f3e,0xbeacbf71,0xbd493f80
.long 0x3f623ef1,0xbe95bf75,0xbef13f62,0x3f75be95,0xbf5cbf04,0xbe163f7d,0x3f78be79,0xbf18bf4e
.long 0x3f553f0e,0x3f0ebf55,0xbf55bf0e,0xbf0e3f55,0xbf4ebf18,0xbf5c3f04,0x3e163f7d,0x3f783e79
.long 0x3f463f22,0x3f7fbdc9,0x3f22bf46,0xbdc9bf7f,0xbf3ebf2c,0xbf71beac,0xbf803d49,0xbf673edb
.long 0x3f800000,0x3f800000,0x3f800000,0x3f800000,0x3d49bf80,0x3edbbf67,0x3f3ebf2c,0x3f71beac
.long 0xbf7fbdc9,0xbf22bf46,0x3dc9bf7f,0x3f46bf22,0xbe163f7d,0xbf783e79,0xbf18bf4e,0x3f04bf5c
.long 0x3f7b3e48,0xbe483f7b,0xbf7bbe48,0x3e48bf7b,0x3e79bf78,0x3f4e3f18,0xbf5c3f04,0xbe16bf7d
.long 0xbf75be95,0x3f62bef1,0xbe953f75,0xbef1bf62,0xbeac3f71,0xbd49bf80,0x3edb3f67,0xbf3ebf2c
.long 0x3f6d3ec4,0xbf6dbec4,0x3f6d3ec4,0xbf6dbec4,0x3edbbf67,0xbf3e3f2c,0x3f71beac,0xbf80bd49
.long 0xbf62bef1,0x3e953f75,0x3ef1bf62,0xbf753e95,0xbf043f5c,0x3f7d3e16,0xbe79bf78,0xbf4e3f18
.long 0x3f553f0e,0x3f0ebf55,0xbf55bf0e,0xbf0e3f55,0x3f18bf4e,0xbf04bf5c,0xbf7d3e16,0xbe793f78
.long 0xbf46bf22,0xbf7f3dc9,0xbf223f46,0x3dc93f7f,0xbf2c3f3e,0xbeac3f71,0x3d493f80,0x3edb3f67
.long 0x3f800000,0x3f7fffb1,0x3f7ffec4,0x3f7ffd39,0x3f800000,0x3f7fe705,0x3f7f9c18,0x3f7f1f49
.long 0x3f800000,0x3f7fa6e3,0x3f7e9bc9,0x3f7cdf6c,0x3f800000,0x3f7f3f54,0x3f7cfe73,0x3f7940c0
.long 0x3f800000,0x3f7eb069,0x3f7ac516,0x3f74484b,0x3f800000,0x3f7dfa38,0x3f77f110,0x3f6dfcf2
.long 0x3f800000,0x3f7d1cdd,0x3f748422,0x3f666771,0x3f800000,0x3f7c187a,0x3f708066,0x3f5d924d
.long 0x3f800000,0x3f7aed37,0x3f6be858,0x3f5389c7,0x3f800000,0x3f799b43,0x3f66becc,0x3f485bca
.long 0x3f800000,0x3f7822d1,0x3f6106f2,0x3f3c17d9,0x3f800000,0x3f76841b,0x3f5ac450,0x3f2ecef7
.long 0x3f800000,0x3f74bf62,0x3f53fac3,0x3f209393,0x3f800000,0x3f72d4eb,0x3f4cae79,0x3f11796b
.long 0x3f800000,0x3f70c501,0x3f44e3f5,0x3f019573,0x3f800000,0x3f6e8ff8,0x3f3ca003,0x3ee1fb6a
.long 0x3f7ffb11,0x3f7ff84a,0x3f7ff4e6,0x3f7ff0e3,0x3f7e70b0,0x3f7d906e,0x3f7c7eb0,0x3f7b3bab
.long 0x3f7a7302,0x3f77583a,0x3f73913f,0x3f6f20b0,0x3f740bdd,0x3f6d67a1,0x3f655e0b,0x3f5bfb34
.long 0x3f6b4b0c,0x3f5fe4e9,0x3f5233c6,0x3f425b89,0x3f604621,0x3f4f0417,0x3f3a7ca4,0x3f2302d3
.long 0x3f531849,0x3f3b0629,0x3f1ebc12,0x3efdbabb,0x3f43e200,0x3f24381a,0x3eff17b2,0x3eadf73c
.long 0x3f32c8c9,0x3f0af1b7,0x3ebb31a0,0x3e3228d4,0x3f1ff6cb,0x3edf28a9,0x3e667c66,0x3b490fc6
.long 0x3f0b9a6b,0x3ea5129f,0x3da3308c,0xbe2bf804,0x3eebcbbb,0x3e5101f1,0xbd8a200a,0xbeab0201
.long 0x3ebe1d4a,0x3da973ba,0xbe5a3997,0xbefafef7,0x3e8e9a22,0xbd2351cb,0xbeb554ec,0xbf21cbfb
.long 0x3e3b6ecf,0xbe25c58c,0xbef9a02d,0xbf4154e1,0x3dafb680,0xbe901c2c,0xbf1c420c,0xbf5b2c79
.long 0x3f7fec43,0x3f7fe705,0x3f7fe129,0x3f7fdaaf,0x3f79c79d,0x3f7822d1,0x3f764d97,0x3f74484b
.long 0x3f6a09a7,0x3f644fac,0x3f5df6be,0x3f570348,0x3f514d3d,0x3f456439,0x3f385216,0x3f2a2a80
.long 0x3f3085bb,0x3f1ce11f,0x3f07a136,0x3ee1fb6a,0x3f08f59b,0x3ed97cb9,0x3e9d9e78,0x3e3e853e
.long 0x3eb8442a,0x3e5d4b1a,0x3d8a200a,0xbda973ba,0x3e2f10a2,0xbb490fc6,0xbe354098,0xbeb0eacb
.long 0xbcc90ab0,0xbe636c83,0xbed25a09,0xbf1553b7,0xbe605c13,0xbedc53c1,0xbf1ebc12,0xbf476085
.long 0xbecf7bca,0xbf1e1e22,0xbf4ac77f,0xbf6afb8c,0xbf13682a,0xbf466354,0xbf6aab7b,0xbf7d906e
.long 0xbf396842,0xbf650479,0xbf7c7eb0,0xbf7dc68c,0xbf584853,0xbf788486,0xbf7f2f9d,0xbf6b99fb
.long 0xbf6ed89e,0xbf7ff0e3,0xbf7294f8,0xbf485bca,0xbf7c3b28,0xbf7aed37,0xbf577026,0xbf16999f
.long 0x3f7fd397,0x3f7fcbe2,0x3f7fc38f,0x3f7fba9e,0x3f721352,0x3f6faf1b,0x3f6d1c1d,0x3f6a5ad9
.long 0x3f4f7a1f,0x3f476085,0x3f3ebc1b,0x3f3592e7,0x3f1b02c6,0x3f0af1b7,0x3ef41f07,0x3ed0eb2a
.long 0x3eb263ef,0x3e80f8c0,0x3e1c76de,0x3d55880e,0x3d7b2b74,0xbd83db0a,0xbe419b37,0xbe9f1cdf
.long 0xbe6c9a7f,0xbebf926f,0xbf0242b1,0xbf21cbfb,0xbf00e7e4,0xbf256bcb,0xbf44e3f5,0xbf5e5aa6
.long 0xbf3b8f3b,0xbf5a5ba0,0xbf708066,0xbf7d1cdd,0xbf660f88,0xbf7940c0,0xbf7ffec4,0xbf79f35e
.long 0xbf7cbfc9,0xbf7efcc9,0xbf718f57,0xbf554aa4,0xbf7dabcc,0xbf6afb8c,0xbf46e22a,0xbf140c5f
.long 0xbf68bf3c,0xbf3f41fc,0xbf04f484,0xbe7bdba4,0xbf3fc767,0xbf003a06,0xbe4dee60,0x3df475c0
.long 0xbf064b82,0xbe5101f1,0x3e1008b7,0x3eeff7fb,0xbe827dc0,0x3de7fa9a,0x3eee9479,0x3f4154e1
.long 0,0x3b490fc6,0x3bc90f88,0x3c16cb58,0,0x3ce22a7a,0x3d621469,0x3da973ba
.long 0,0x3d55880e,0x3dd53db9,0x3e1f917b,0,0x3d9cecf9,0x3e1c76de,0x3e698bba
.long 0,0x3dcefdb7,0x3e4dee60,0x3e9920fe,0,0x3e007745,0x3e7ee6e1,0x3ebca7af
.long 0,0x3e195be0,0x3e97a117,0x3edf28a9,0,0x3e3228d4,0x3eaf713a,0x3f003a06
.long 0,0x3e4ada4f,0x3ec6d529,0x3f102dd5,0,0x3e636c83,0x3eddbe79,0x3f1f599f
.long 0,0x3e7bdba4,0x3ef41f07,0x3f2da859,0,0x3e8a11f7,0x3f04f484,0x3f3b0629
.long 0,0x3e9620d2,0x3f0f8784,0x3f476085,0,0x3ea21887,0x3f19c200,0x3f52a649
.long 0,0x3eadf73c,0x3f239da9,0x3f5cc7d1,0,0x3eb9bb1e,0x3f2d1469,0x3f65b710
.long 0x3c490e90,0x3c7b514b,0x3c96c9b6,0x3cafea69,0x3de1bc2e,0x3e0cec4a,0x3e28defc,0x3e44b0b9
.long 0x3e541501,0x3e840270,0x3e9d9e78,0x3eb6ccc3,0x3e9aa086,0x3ebf926f,0x3ee363fa,0x3f02ef9f
.long 0x3ec9b953,0x3ef840c8,0x3f121eb0,0x3f269de3,0x3ef6e0cb,0x3f16999f,0x3f2f61a5,0x3f456439
.long 0x3f10d3cd,0x3f2ecef7,0x3f48d8b3,0x3f5e5aa6,0x3f24d225,0x3f446337,0x3f5df6be,0x3f70c501
.long 0x3f373a23,0x3f570348,0x3f6e46be,0x3f7c187a,0x3f47de65,0x3f666771,0x3f796e4e,0x3f7fffb1
.long 0x3f5695e5,0x3f725470,0x3f7f2f9d,0x3f7c5d3a,0x3f633c5a,0x3f7a9c59,0x3f7f6ac7,0x3f714c7a
.long 0x3f6db293,0x3f7f1f49,0x3f7a1e84,0x3f5f20db,0x3f75dec6,0x3f7fcbe2,0x3f6f6830,0x3f466354
.long 0x3f7baccd,0x3f7c9f8a,0x3f5f8327,0x3f27ce61,0x3f7f0e58,0x3f75a67b,0x3f4ac77f,0x3f044889
.long 0x3cc90ab0,0x3ce22a7a,0x3cfb49ba,0x3d0a342f,0x3e605c13,0x3e7bdba4,0x3e8b9507,0x3e9920fe
.long 0x3ecf7bca,0x3ee79a5d,0x3eff17b2,0x3f0af1b7,0x3f13682a,0x3f2302d3,0x3f31a81d,0x3f3f41fc
.long 0x3f396842,0x3f4a4c87,0x3f591e6a,0x3f65b710,0x3f584853,0x3f67c187,0x3f73913f,0x3f7b87b2
.long 0x3f6ed89e,0x3f79f35e,0x3f7f6ac7,0x3f7f1f49,0x3f7c3b28,0x3f7fffb1,0x3f7bf531,0x3f703b37
.long 0x3f7fec43,0x3f799b43,0x3f696591,0x3f4fefa8,0x3f79c79d,0x3f671599,0x3f48d8b3,0x3f209393
.long 0x3f6a09a7,0x3f495521,0x3f1c420c,0x3ecb2aae,0x3f514d3d,0x3f21cbfb,0x3ecc9b8b,0x3e0cec4a
.long 0x3f3085bb,0x3ee4cbfe,0x3e28defc,0xbe06b26e,0x3f08f59b,0x3e75c35a,0xbda3308c,0xbec8477c
.long 0x3eb8442a,0x3cafea69,0xbea395c5,0xbf1f599f,0x3e2f10a2,0xbe4ada4f,0xbf0a48ad,0xbf4f0417
.long 0x3d16c32c,0x3d2351cb,0x3d2fe007,0x3d3c6dd5,0x3ea68f12,0x3eb3dca5,0x3ec1071e,0x3ece0bea
.long 0x3f15f6d9,0x3f209393,0x3f2ac082,0x3f34768f,0x3f4bbbf8,0x3f570348,0x3f6106f2,0x3f69b7e4
.long 0x3f6ff573,0x3f77beb7,0x3f7cfe73,0x3f7fa6e3,0x3f7f84ab,0x3f7f7808,0x3f7b61fc,0x3f73530e
.long 0x3f791298,0x3f6d67a1,0x3f5c61c7,0x3f466354,0x3f5d2d53,0x3f436051,0x3f239da9,0x3efdbabb
.long 0x3f2e3bde,0x3f05a02c,0x3eaf713a,0x3e195be0,0x3ee0924f,0x3e698bba,0x3bc90f88,0xbe5d4b1a
.long 0x3e22abb6,0xbdb5f8da,0xbea986c4,0xbf0d9281,0xbe09cf86,0xbecb2aae,0xbf212ff9,0xbf50d937
.long 0xbed53641,0xbf2a2a80,0xbf5ac450,0xbf7822d1,0xbf299415,0xbf5d924d,0xbf7ac516,0xbf7e2b72
.long 0xbf59f26a,0xbf7a9c59,0xbf7d7474,0xbf62241a,0xbf778bc5,0xbf7e5a38,0xbf628210,0xbf27ce61
.long 0x354ccccd,0x354ccccd,0x354ccccd,0x354ccccd,0x354ccc8e,0x354cb8d1,0x354c8582,0x354c32aa
.long 0x354ccbd0,0x354c7ce0,0x354bafd4,0x354a6529,0x354cca94,0x354c1907,0x354a4c56,0x35476700
.long 0x354cc8da,0x354b8d5a,0x35485c01,0x35433cb1,0x354cc6a2,0x354ad9f2,0x3545e02f,0x353dec81
.long 0x354cc3eb,0x3549fef3,0x3542da99,0x35377e6f,0x354cc0b6,0x3548fc89,0x353f4d5a,0x352ffc2a
.long 0x354cbd02,0x3547d2e4,0x353b3aec,0x352770fe,0x354cb8d1,0x35468241,0x3536a623,0x351de9c7
.long 0x354cb421,0x35450adf,0x35319232,0x351374de,0x354caef3,0x35436d09,0x352c02a0,0x35082200
.long 0x354ca946,0x3541a90f,0x3525fb4c,0x34f8046f,0x354ca31b,0x353fbf49,0x351f806a,0x34de4f8b
.long 0x354c9c72,0x353db017,0x3518967c,0x34c34c06,0x354c954b,0x353b7be1,0x35114253,0x34a72288
.long 0x354ccccd,0x354ccccd,0x354ccccd,0x354ccccd,0x354bc054,0x354b2e94,0x354a7d7e,0x3549ad2f
.long 0x35489dab,0x35465a74,0x35439ce8,0x354066b8,0x35436d09,0x353e63f5,0x353852c1,0x353141d7
.long 0x353c3c09,0x35336b4e,0x3528e03a,0x351cb4cd,0x35331d87,0x35259ce0,0x35159e88,0x35036014
.long 0x3528296b,0x35153084,0x34fdf9b6,0x34cc12f5,0x351b7c6d,0x350268a9,0x34cafbc9,0x348b2c30
.long 0x350d37c9,0x34db2291,0x349369bb,0x340c0d4f,0x34fb01cb,0x34adfd61,0x343108e1,0xb120d96b
.long 0x34d901f0,0x347c30c0,0x335d000f,0xb411007a,0x34b4c922,0x34186a98,0xb3878fc8,0xb48d88a2
.long 0x348eb659,0x3348ef90,0xb43d4866,0xb4ce3fd4,0x344e5acd,0xb352f811,0xb49941f2,0xb504563c
.long 0x33fa57c9,0xb41ae293,0xb4d06ab5,0xb51d832a,0x332ad33e,0xb47e9498,0xb5016ffc,0xb531e21f
.long 0x354ccccd,0x354ccccd,0x354ccccd,0x354ccccd,0x3548bdc6,0x3547af69,0x35468241,0x3545367c
.long 0x353cb9e0,0x353898a3,0x3534058e,0x352f0373,0x35293b06,0x3520496e,0x3516797a,0x350bd8c6
.long 0x350f0707,0x34fff144,0x34df5d78,0x34bca2fc,0x34de4f8b,0x34b286ed,0x34840ee5,0x342734c1
.long 0x3495c14d,0x34386384,0x33828d3d,0xb35d000f,0x340e8710,0x3120d96b,0xb4099337,0xb488ce67
.long 0xb2a0d559,0xb4337cdc,0xb4a5fca2,0xb4ebd9dd,0xb435f068,0xb4b04301,0xb4fcfd04,0xb51eb5dd
.long 0xb4a84807,0xb4fdf9b6,0xb5223933,0xb53bbc62,0xb4eeec58,0xb51f806a,0xb53bfc70,0xb54ad9f2
.long 0xb5160c2f,0xb5380c6c,0xb54a3307,0xb54aefd6,0xb52eafb3,0xb5476700,0xb54bfd6e,0xb53bfc70
.long 0xb54066b8,0xb54ccbd0,0xb5413f79,0xb51f1b54,0xb54a7d7e,0xb547f5e5,0xb52aa21d,0xb4ece099
.long 0x354ccccd,0x354ccccd,0x354ccccd,0x354ccccd,0x3543cc4e,0x354243ef,0x35409d9b,0x353ed993
.long 0x35299568,0x3523bec8,0x351d832a,0x3516e669,0x3500760f,0x34e8c245,0x34cf5584,0x34b4c922
.long 0x3498176e,0x346429d0,0x3415f23f,0x338c9200,0x33878fc8,0xb302a7d6,0xb4049e0a,0xb466937a
.long 0xb42e9479,0xb49110bd,0xb4c7b357,0xb4fa0347,0xb4c8cbf9,0xb5016ffc,0xb51aaa4d,0xb52f56c7
.long 0xb5145368,0xb52d06a9,0xb53f13b1,0xb549c8ed,0xb53736c7,0xb546d06b,0xb54cc0b6,0xb548bdc6
.long 0xb549fef3,0xb54c2618,0xb54210c7,0xb52c59b8,0xb54b053d,0xb53c7b2f,0xb520496e,0xb4f0f5cb
.long 0xb53a3296,0xb5196c52,0xb4d6df37,0xb450c934,0xb5190197,0xb4cd29a4,0xb42734c1,0x33b99548
.long 0xb4d4ba6c,0xb424beb3,0x33e67457,0x34bedd2d,0xb4497c83,0x33c39166,0x34bff996,0x351aaa4d
.long 0,0,0,0,0x3120d96b,0x32b4eec8,0x332ad33e,0x337b14c1
.long 0x31a0d93a,0x3334dd20,0x33aa97c7,0x33fa57c9,0x31f1455a,0x33878fc8,0x33ff4f2b,0x343ad62f
.long 0x3220d873,0x33b4968b,0x3429aa67,0x3477673d,0x32490dd6,0x33e17a10,0x3453371a,0x349941f2
.long 0x327142bd,0x340718ca,0x347c30c0,0x34b5e995,0x328cbb87,0x341d5a2e,0x34923d69,0x34d17f65
.long 0x32a0d559,0x34337cdc,0x34a5fca2,0x34ebd9dd,0x32b4eec8,0x34497c83,0x34b9484b,0x350268a9
.long 0x32c907c8,0x345f54d8,0x34cc12f5,0x350e2017,0x32dd204b,0x34750196,0x34de4f8b,0x35190197
.long 0x32f13846,0x34853f42,0x34eff15b,0x3522fcc6,0x3302a7d6,0x348fe3b7,0x3500760f,0x352c02a0
.long 0x330cb338,0x349a6c18,0x35089a01,0x3534058e,0x3316be44,0x34a4d655,0x35105ed9,0x353af983
.long 0,0,0,0,0x33a597c6,0x33cd8ba2,0x33f55fcc,0x340e8710
.long 0x3424beb3,0x344bebe7,0x34729b58,0x348c5a95,0x34750196,0x3496ec8c,0x34b286ed,0x34cd29a4
.long 0x34a1610f,0x34c580a2,0x34e7b948,0x3503db51,0x34c69a3a,0x34f0f5cb,0x350bd8c6,0x351d1c2c
.long 0x34e9cab3,0x350c4e1d,0x3520ad5c,0x35319232,0x35054b1c,0x351de9c7,0x3531e21f,0x35409d9b
.long 0x35145368,0x352d06a9,0x353f13b1,0x3549c8ed,0x3521d6d2,0x3539679f,0x3547f5e5,0x354ccc8e
.long 0x352db1ef,0x3542da99,0x354c556c,0x354990f4,0x3537c5a7,0x3549395b,0x354c1907,0x35402f5f
.long 0x353ff78f,0x354c6a23,0x35474213,0x3530f10f,0x3546322c,0x354c6006,0x353dec81,0x351c4d0e
.long 0x354a6529,0x35491b30,0x35304e38,0x3502e487,0x354c8582,0x3542a8d8,0x351eb5dd,0x34cafbc9
.long 0,0,0,0,0x3422483f,0x3435f068,0x34497c83,0x345ce98c
.long 0x349f10ee,0x34b1652e,0x34c34c06,0x34d4ba6c,0x34e6afbb,0x34fef5cc,0x350aed14,0x35159e88
.long 0x351294e9,0x351fe51e,0x352bab1e,0x3535c9e1,0x352c02a0,0x353852c1,0x3541dd26,0x35487d14
.long 0x353e9eff,0x35478b72,0x354c2618,0x354c556c,0x3549ad2f,0x354ccc8e,0x3549e42e,0x354109fb
.long 0x354cbd02,0x3547d2e4,0x353b3aec,0x352770fe,0x3547af69,0x3538de14,0x352110e7,0x35016ffc
.long 0x353ab7a7,0x3520ad5c,0x34fa0347,0x34a3afa2,0x35265953,0x3500760f,0x34a2888b,0x33e17a10
.long 0x350b6318,0x34b3a83f,0x340222f8,0xb3dc7f3e,0x34d5cd14,0x343ad62f,0xb39193e2,0xb4a2888b
.long 0x348c5a95,0x31a0d93a,0xb4879f03,0xb500f32d,0x33f55fcc,0xb43108e1,0xb4e28401,0xb527142c
.long 0,0,0,0,0x34703484,0x3481ad39,0x348b2c30,0x349495b2
.long 0x34e5a5a1,0x34f60334,0x3502e487,0x350a76bb,0x351f806a,0x35288507,0x35309fda,0x3537c5a7
.long 0x353e2876,0x3544b238,0x3549570a,0x354c0b7a,0x354c1907,0x354ca31b,0x354a193c,0x3544852f
.long 0x3548186a,0x353f868d,0x3532cf52,0x35223933,0x353280af,0x351eb5dd,0x35063eb4,0x34d3a742
.long 0x350d37c9,0x34db2291,0x349369bb,0x340c0d4f,0x34b70998,0x34449c48,0x328cbb87,0xb422483f
.long 0x340718ca,0xb3828d3d,0xb482de37,0xb4dd4116,0xb3d783e3,0xb4a03930,0xb4fef5cc,0xb5259ce0
.long 0xb4aa91ce,0xb507a9aa,0xb52e5b88,0xb546096a,0xb5082200,0xb53141d7,0xb5487d14,0xb54b7b60
.long 0xb52f0373,0xb5489dab,0xb54ac390,0xb53534da,0xb5468241,0xb54b55f5,0xb534e9ae,0xb5063eb4
.long 0x3f80,0x3f80,0x3f80,0x3f80,0x3f80,0x3ec43f6d,0x3f353f35,0x3f6d3ec4
.long 0x3f80,0x3f353f35,0x3f80248d,0x3f35bf35,0x3f80,0x3f6d3ec4,0x3f35bf35,0xbec4bf6d
.long 0x3f80,0x3f80248d,0x250dbf80,0xbf80a554,0x3f80,0x3f6dbec4,0xbf35bf35,0xbec43f6d
.long 0x3f80,0x3f35bf35,0xbf80a554,0x3f353f35,0x3f80,0x3ec4bf6d,0xbf353f35,0x3f6dbec4
.long 0x3f80,0x250dbf80,0x3f80,0x250dbf80,0x3f80,0xbec4bf6d,0x3f353f35,0xbf6dbec4
.long 0x3f80,0xbf35bf35,0x3f80248d,0xbf353f35,0x3f80,0xbf6dbec4,0x3f35bf35,0x3ec43f6d
.long 0x3f80,0xbf80a554,0x250dbf80,0x3f80248d,0x3f80,0xbf6d3ec4,0xbf35bf35,0x3ec4bf6d
.long 0x3f80,0xbf353f35,0xbf80a554,0xbf35bf35,0x3f80,0xbec43f6d,0xbf353f35,0xbf6d3ec4
.long 0x3f80,0x3f80,0x3f80,0x3f80,0x3f80248d,0x3f6dbec4,0x3f35bf35,0x3ec4bf6d
.long 0x250dbf80,0xbf35bf35,0xbf80a554,0xbf353f35,0xbf80a554,0xbec43f6d,0x3f353f35,0x3f6dbec4
.long 0x3f80,0x3f80248d,0x250dbf80,0xbf80a554,0x3f80248d,0xbec4bf6d,0xbf353f35,0x3f6d3ec4
.long 0x250dbf80,0xbf353f35,0x3f80248d,0xbf35bf35,0xbf80a554,0x3f6d3ec4,0xbf35bf35,0x3ec43f6d
.long 0x3f80,0x250dbf80,0x3f80,0x250dbf80,0x3f80248d,0xbf6d3ec4,0x3f35bf35,0xbec43f6d
.long 0x250dbf80,0x3f353f35,0xbf80a554,0x3f35bf35,0xbf80a554,0x3ec4bf6d,0x3f353f35,0xbf6d3ec4
.long 0x3f80,0xbf80a554,0x250dbf80,0x3f80248d,0x3f80248d,0x3ec43f6d,0xbf353f35,0xbf6dbec4
.long 0x250dbf80,0x3f35bf35,0x3f80248d,0x3f353f35,0xbf80a554,0xbf6dbec4,0xbf35bf35,0xbec4bf6d
.long 0x3f80,0x3f80,0x3f80,0x3f80,0x250dbf80,0xbec4bf6d,0xbf35bf35,0xbf6dbec4
.long 0x3f80,0x3f353f35,0x3f80248d,0x3f35bf35,0x250dbf80,0xbf6dbec4,0xbf353f35,0x3ec43f6d
.long 0x3f80,0x3f80248d,0x250dbf80,0xbf80a554,0x250dbf80,0xbf6d3ec4,0x3f353f35,0x3ec4bf6d
.long 0x3f80,0x3f35bf35,0xbf80a554,0x3f353f35,0x250dbf80,0xbec43f6d,0x3f35bf35,0xbf6d3ec4
.long 0x3f80,0x250dbf80,0x3f80,0x250dbf80,0x250dbf80,0x3ec43f6d,0xbf35bf35,0x3f6d3ec4
.long 0x3f80,0xbf35bf35,0x3f80248d,0xbf353f35,0x250dbf80,0x3f6d3ec4,0xbf353f35,0xbec4bf6d
.long 0x3f80,0xbf80a554,0x250dbf80,0x3f80248d,0x250dbf80,0x3f6dbec4,0x3f353f35,0xbec43f6d
.long 0x3f80,0xbf353f35,0xbf80a554,0xbf35bf35,0x250dbf80,0x3ec4bf6d,0x3f35bf35,0x3f6dbec4
.long 0x3f80,0x3f80,0x3f80,0x3f80,0xbf80a554,0xbf6d3ec4,0xbf353f35,0xbec43f6d
.long 0x250dbf80,0xbf35bf35,0xbf80a554,0xbf353f35,0x3f80248d,0x3ec4bf6d,0xbf35bf35,0xbf6d3ec4
.long 0x3f80,0x3f80248d,0x250dbf80,0xbf80a554,0xbf80a554,0x3ec43f6d,0x3f35bf35,0xbf6dbec4
.long 0x250dbf80,0xbf353f35,0x3f80248d,0xbf35bf35,0x3f80248d,0xbf6dbec4,0x3f353f35,0xbec4bf6d
.long 0x3f80,0x250dbf80,0x3f80,0x250dbf80,0xbf80a554,0x3f6dbec4,0xbf353f35,0x3ec4bf6d
.long 0x250dbf80,0x3f353f35,0xbf80a554,0x3f35bf35,0x3f80248d,0xbec43f6d,0xbf35bf35,0x3f6dbec4
.long 0x3f80,0xbf80a554,0x250dbf80,0x3f80248d,0xbf80a554,0xbec4bf6d,0x3f35bf35,0x3f6d3ec4
.long 0x250dbf80,0x3f35bf35,0x3f80248d,0x3f353f35,0x3f80248d,0x3f6d3ec4,0x3f353f35,0x3ec43f6d
.long 0x3f808000,0x3f808000,0x3f808000,0x3f808000,0x3f808000,0x3f6dbec4,0x3f35bf35,0x3ec4bf6d
.long 0x3f808000,0x3f35bf35,0x248dbf80,0xbf35bf35,0x3f808000,0x3ec4bf6d,0xbf35bf35,0xbf6d3ec4
.long 0x3f808000,0x248dbf80,0xbf80a50d,0xa5543f80,0x3f808000,0xbec4bf6d,0xbf353f35,0x3f6d3ec4
.long 0x3f808000,0xbf35bf35,0xa5543f80,0x3f35bf35,0x3f808000,0xbf6dbec4,0x3f353f35,0xbec4bf6d
.long 0x3f808000,0xbf80a50d,0x3f808000,0xbf80a50d,0x3f808000,0xbf6d3ec4,0x3f35bf35,0xbec43f6d
.long 0x3f808000,0xbf353f35,0x248dbf80,0x3f353f35,0x3f808000,0xbec43f6d,0xbf35bf35,0x3f6dbec4
.long 0x3f808000,0xa5543f80,0xbf80a50d,0x248dbf80,0x3f808000,0x3ec43f6d,0xbf353f35,0xbf6dbec4
.long 0x3f808000,0x3f353f35,0xa5543f80,0xbf353f35,0x3f808000,0x3f6d3ec4,0x3f353f35,0x3ec43f6d
.long 0x3f808000,0x3f808000,0x3f808000,0x3f808000,0x248dbf80,0xbec4bf6d,0xbf35bf35,0xbf6dbec4
.long 0xbf80a50d,0xbf353f35,0xa5543f80,0x3f353f35,0xa5543f80,0x3f6d3ec4,0x3f35bf35,0xbec4bf6d
.long 0x3f808000,0x248dbf80,0xbf80a50d,0xa5543f80,0x248dbf80,0xbf6d3ec4,0x3f353f35,0x3ec4bf6d
.long 0xbf80a50d,0x3f353f35,0x248dbf80,0xbf353f35,0xa5543f80,0x3ec4bf6d,0xbf353f35,0x3f6dbec4
.long 0x3f808000,0xbf80a50d,0x3f808000,0xbf80a50d,0x248dbf80,0x3ec43f6d,0xbf35bf35,0x3f6d3ec4
.long 0xbf80a50d,0x3f35bf35,0xa5543f80,0xbf35bf35,0xa5543f80,0xbf6dbec4,0x3f35bf35,0x3ec43f6d
.long 0x3f808000,0xa5543f80,0xbf80a50d,0x248dbf80,0x248dbf80,0x3f6dbec4,0x3f353f35,0xbec43f6d
.long 0xbf80a50d,0xbf35bf35,0x248dbf80,0x3f35bf35,0xa5543f80,0xbec43f6d,0xbf353f35,0xbf6d3ec4
.long 0x3f808000,0x3f808000,0x3f808000,0x3f808000,0xbf80a50d,0xbf6d3ec4,0xbf353f35,0xbec43f6d
.long 0x3f808000,0x3f35bf35,0x248dbf80,0xbf35bf35,0xbf80a50d,0xbec43f6d,0x3f353f35,0x3f6dbec4
.long 0x3f808000,0x248dbf80,0xbf80a50d,0xa5543f80,0xbf80a50d,0x3ec43f6d,0x3f35bf35,0xbf6dbec4
.long 0x3f808000,0xbf35bf35,0xa5543f80,0x3f35bf35,0xbf80a50d,0x3f6d3ec4,0xbf35bf35,0x3ec43f6d
.long 0x3f808000,0xbf80a50d,0x3f808000,0xbf80a50d,0xbf80a50d,0x3f6dbec4,0xbf353f35,0x3ec4bf6d
.long 0x3f808000,0xbf353f35,0x248dbf80,0x3f353f35,0xbf80a50d,0x3ec4bf6d,0x3f353f35,0xbf6d3ec4
.long 0x3f808000,0xa5543f80,0xbf80a50d,0x248dbf80,0xbf80a50d,0xbec4bf6d,0x3f35bf35,0x3f6d3ec4
.long 0x3f808000,0x3f353f35,0xa5543f80,0xbf353f35,0xbf80a50d,0xbf6dbec4,0xbf35bf35,0xbec4bf6d
.long 0x3f808000,0x3f808000,0x3f808000,0x3f808000,0xa5543f80,0x3ec43f6d,0x3f353f35,0x3f6d3ec4
.long 0xbf80a50d,0xbf353f35,0xa5543f80,0x3f353f35,0x248dbf80,0xbf6dbec4,0xbf353f35,0x3ec43f6d
.long 0x3f808000,0x248dbf80,0xbf80a50d,0xa5543f80,0xa5543f80,0x3f6dbec4,0xbf35bf35,0xbec43f6d
.long 0xbf80a50d,0x3f353f35,0x248dbf80,0xbf353f35,0x248dbf80,0xbec43f6d,0x3f35bf35,0xbf6d3ec4
.long 0x3f808000,0xbf80a50d,0x3f808000,0xbf80a50d,0xa5543f80,0xbec4bf6d,0x3f353f35,0xbf6dbec4
.long 0xbf80a50d,0x3f35bf35,0xa5543f80,0xbf35bf35,0x248dbf80,0x3f6d3ec4,0xbf353f35,0xbec4bf6d
.long 0x3f808000,0xa5543f80,0xbf80a50d,0x248dbf80,0xa5543f80,0xbf6d3ec4,0xbf35bf35,0x3ec4bf6d
.long 0xbf80a50d,0xbf35bf35,0x248dbf80,0x3f35bf35,0x248dbf80,0x3ec4bf6d,0x3f35bf35,0x3f6dbec4
.long 0x80003f80,0x80003f80,0x80003f80,0x80003f80,0x80003f80,0xbec43f6d,0xbf353f35,0xbf6d3ec4
.long 0x80003f80,0xbf353f35,0xbf80248d,0xbf35bf35,0x80003f80,0xbf6d3ec4,0xbf35bf35,0x3ec4bf6d
.long 0x80003f80,0xbf80248d,0xa50dbf80,0x3f80a554,0x80003f80,0xbf6dbec4,0x3f35bf35,0x3ec43f6d
.long 0x80003f80,0xbf35bf35,0x3f80a554,0xbf353f35,0x80003f80,0xbec4bf6d,0x3f353f35,0xbf6dbec4
.long 0x80003f80,0xa50dbf80,0x80003f80,0xa50dbf80,0x80003f80,0x3ec4bf6d,0xbf353f35,0x3f6dbec4
.long 0x80003f80,0x3f35bf35,0xbf80248d,0x3f353f35,0x80003f80,0x3f6dbec4,0xbf35bf35,0xbec43f6d
.long 0x80003f80,0x3f80a554,0xa50dbf80,0xbf80248d,0x80003f80,0x3f6d3ec4,0x3f35bf35,0xbec4bf6d
.long 0x80003f80,0x3f353f35,0x3f80a554,0x3f35bf35,0x80003f80,0x3ec43f6d,0x3f353f35,0x3f6d3ec4
.long 0x80003f80,0x80003f80,0x80003f80,0x80003f80,0xbf80248d,0xbf6dbec4,0xbf35bf35,0xbec4bf6d
.long 0xa50dbf80,0x3f35bf35,0x3f80a554,0x3f353f35,0x3f80a554,0x3ec43f6d,0xbf353f35,0xbf6dbec4
.long 0x80003f80,0xbf80248d,0xa50dbf80,0x3f80a554,0xbf80248d,0x3ec4bf6d,0x3f353f35,0xbf6d3ec4
.long 0xa50dbf80,0x3f353f35,0xbf80248d,0x3f35bf35,0x3f80a554,0xbf6d3ec4,0x3f35bf35,0xbec43f6d
.long 0x80003f80,0xa50dbf80,0x80003f80,0xa50dbf80,0xbf80248d,0x3f6d3ec4,0xbf35bf35,0x3ec43f6d
.long 0xa50dbf80,0xbf353f35,0x3f80a554,0xbf35bf35,0x3f80a554,0xbec4bf6d,0xbf353f35,0x3f6d3ec4
.long 0x80003f80,0x3f80a554,0xa50dbf80,0xbf80248d,0xbf80248d,0xbec43f6d,0x3f353f35,0x3f6dbec4
.long 0xa50dbf80,0xbf35bf35,0xbf80248d,0xbf353f35,0x3f80a554,0x3f6dbec4,0x3f35bf35,0x3ec4bf6d
.long 0x80003f80,0x80003f80,0x80003f80,0x80003f80,0xa50dbf80,0x3ec4bf6d,0x3f35bf35,0x3f6dbec4
.long 0x80003f80,0xbf353f35,0xbf80248d,0xbf35bf35,0xa50dbf80,0x3f6dbec4,0x3f353f35,0xbec43f6d
.long 0x80003f80,0xbf80248d,0xa50dbf80,0x3f80a554,0xa50dbf80,0x3f6d3ec4,0xbf353f35,0xbec4bf6d
.long 0x80003f80,0xbf35bf35,0x3f80a554,0xbf353f35,0xa50dbf80,0x3ec43f6d,0xbf35bf35,0x3f6d3ec4
.long 0x80003f80,0xa50dbf80,0x80003f80,0xa50dbf80,0xa50dbf80,0xbec43f6d,0x3f35bf35,0xbf6d3ec4
.long 0x80003f80,0x3f35bf35,0xbf80248d,0x3f353f35,0xa50dbf80,0xbf6d3ec4,0x3f353f35,0x3ec4bf6d
.long 0x80003f80,0x3f80a554,0xa50dbf80,0xbf80248d,0xa50dbf80,0xbf6dbec4,0xbf353f35,0x3ec43f6d
.long 0x80003f80,0x3f353f35,0x3f80a554,0x3f35bf35,0xa50dbf80,0xbec4bf6d,0xbf35bf35,0xbf6dbec4
.long 0x80003f80,0x80003f80,0x80003f80,0x80003f80,0x3f80a554,0x3f6d3ec4,0x3f353f35,0x3ec43f6d
.long 0xa50dbf80,0x3f35bf35,0x3f80a554,0x3f353f35,0xbf80248d,0xbec4bf6d,0x3f35bf35,0x3f6d3ec4
.long 0x80003f80,0xbf80248d,0xa50dbf80,0x3f80a554,0x3f80a554,0xbec43f6d,0xbf35bf35,0x3f6dbec4
.long 0xa50dbf80,0x3f353f35,0xbf80248d,0x3f35bf35,0xbf80248d,0x3f6dbec4,0xbf353f35,0x3ec4bf6d
.long 0x80003f80,0xa50dbf80,0x80003f80,0xa50dbf80,0x3f80a554,0xbf6dbec4,0x3f353f35,0xbec4bf6d
.long 0xa50dbf80,0xbf353f35,0x3f80a554,0xbf35bf35,0xbf80248d,0x3ec43f6d,0x3f35bf35,0xbf6dbec4
.long 0x80003f80,0x3f80a554,0xa50dbf80,0xbf80248d,0x3f80a554,0x3ec4bf6d,0xbf35bf35,0xbf6d3ec4
.long 0xa50dbf80,0xbf35bf35,0xbf80248d,0xbf353f35,0xbf80248d,0xbf6d3ec4,0xbf353f35,0xbec43f6d
.long 0x3f800000,0x3f800000,0x3f800000,0x3f800000,0x3f800000,0x3f6d3ec4,0x3f353f35,0x3ec43f6d
.long 0x3f800000,0x3f353f35,0x248d3f80,0xbf353f35,0x3f800000,0x3ec43f6d,0xbf353f35,0xbf6dbec4
.long 0x3f800000,0x248d3f80,0xbf80250d,0xa554bf80,0x3f800000,0xbec43f6d,0xbf35bf35,0x3f6dbec4
.long 0x3f800000,0xbf353f35,0xa554bf80,0x3f353f35,0x3f800000,0xbf6d3ec4,0x3f35bf35,0xbec43f6d
.long 0x3f800000,0xbf80250d,0x3f800000,0xbf80250d,0x3f800000,0xbf6dbec4,0x3f353f35,0xbec4bf6d
.long 0x3f800000,0xbf35bf35,0x248d3f80,0x3f35bf35,0x3f800000,0xbec4bf6d,0xbf353f35,0x3f6d3ec4
.long 0x3f800000,0xa554bf80,0xbf80250d,0x248d3f80,0x3f800000,0x3ec4bf6d,0xbf35bf35,0xbf6d3ec4
.long 0x3f800000,0x3f35bf35,0xa554bf80,0xbf35bf35,0x3f800000,0x3f6dbec4,0x3f35bf35,0x3ec4bf6d
.long 0x3f800000,0x3f800000,0x3f800000,0x3f800000,0x248d3f80,0xbec43f6d,0xbf353f35,0xbf6d3ec4
.long 0xbf80250d,0xbf35bf35,0xa554bf80,0x3f35bf35,0xa554bf80,0x3f6dbec4,0x3f353f35,0xbec43f6d
.long 0x3f800000,0x248d3f80,0xbf80250d,0xa554bf80,0x248d3f80,0xbf6dbec4,0x3f35bf35,0x3ec43f6d
.long 0xbf80250d,0x3f35bf35,0x248d3f80,0xbf35bf35,0xa554bf80,0x3ec43f6d,0xbf35bf35,0x3f6d3ec4
.long 0x3f800000,0xbf80250d,0x3f800000,0xbf80250d,0x248d3f80,0x3ec4bf6d,0xbf353f35,0x3f6dbec4
.long 0xbf80250d,0x3f353f35,0xa554bf80,0xbf353f35,0xa554bf80,0xbf6d3ec4,0x3f353f35,0x3ec4bf6d
.long 0x3f800000,0xa554bf80,0xbf80250d,0x248d3f80,0x248d3f80,0x3f6d3ec4,0x3f35bf35,0xbec4bf6d
.long 0xbf80250d,0xbf353f35,0x248d3f80,0x3f353f35,0xa554bf80,0xbec4bf6d,0xbf35bf35,0xbf6dbec4
.long 0x3f800000,0x3f800000,0x3f800000,0x3f800000,0xbf80250d,0xbf6dbec4,0xbf35bf35,0xbec4bf6d
.long 0x3f800000,0x3f353f35,0x248d3f80,0xbf353f35,0xbf80250d,0xbec4bf6d,0x3f35bf35,0x3f6d3ec4
.long 0x3f800000,0x248d3f80,0xbf80250d,0xa554bf80,0xbf80250d,0x3ec4bf6d,0x3f353f35,0xbf6d3ec4
.long 0x3f800000,0xbf353f35,0xa554bf80,0x3f353f35,0xbf80250d,0x3f6dbec4,0xbf353f35,0x3ec4bf6d
.long 0x3f800000,0xbf80250d,0x3f800000,0xbf80250d,0xbf80250d,0x3f6d3ec4,0xbf35bf35,0x3ec43f6d
.long 0x3f800000,0xbf35bf35,0x248d3f80,0x3f35bf35,0xbf80250d,0x3ec43f6d,0x3f35bf35,0xbf6dbec4
.long 0x3f800000,0xa554bf80,0xbf80250d,0x248d3f80,0xbf80250d,0xbec43f6d,0x3f353f35,0x3f6dbec4
.long 0x3f800000,0x3f35bf35,0xa554bf80,0xbf35bf35,0xbf80250d,0xbf6d3ec4,0xbf353f35,0xbec43f6d
.long 0x3f800000,0x3f800000,0x3f800000,0x3f800000,0xa554bf80,0x3ec4bf6d,0x3f35bf35,0x3f6dbec4
.long 0xbf80250d,0xbf35bf35,0xa554bf80,0x3f35bf35,0x248d3f80,0xbf6d3ec4,0xbf35bf35,0x3ec4bf6d
.long 0x3f800000,0x248d3f80,0xbf80250d,0xa554bf80,0xa554bf80,0x3f6d3ec4,0xbf353f35,0xbec4bf6d
.long 0xbf80250d,0x3f35bf35,0x248d3f80,0xbf35bf35,0x248d3f80,0xbec4bf6d,0x3f353f35,0xbf6dbec4
.long 0x3f800000,0xbf80250d,0x3f800000,0xbf80250d,0xa554bf80,0xbec43f6d,0x3f35bf35,0xbf6d3ec4
.long 0xbf80250d,0x3f353f35,0xa554bf80,0xbf353f35,0x248d3f80,0x3f6dbec4,0xbf35bf35,0xbec43f6d
.long 0x3f800000,0xa554bf80,0xbf80250d,0x248d3f80,0xa554bf80,0xbf6dbec4,0xbf353f35,0x3ec43f6d
.long 0xbf80250d,0xbf353f35,0x248d3f80,0x3f353f35,0x248d3f80,0x3ec43f6d,0x3f353f35,0x3f6d3ec4
.long 0x3f800000,0x3f800000,0x40000000,0x80000000,0x3f800000,0xbf800000,0x3fb504f3,0xbfb504f3
.long 0x3f800000,0x3f800000,0,0xc0000000,0x3f800000,0xbf800000,0xbfb504f3,0xbfb504f3
.long 0,0,0,0,0,0,0,0
.long 0,0,0,0,0,0,0,0
.long 0,0,0,0,0,0,0,0
.long 0,0,0,0,0,0,0,0
.long 0,0,0,0,0,0,0,0
.long 0,0,0,0,0,0,0,0
.long 0,0,0,0,0,0,0,0
.long 0,0,0,0,0,0,0,0
.long 0x3f800000,0x3f800000,0x40000000,0x80000000,0x3f800000,0xbf800000,0x3fb504f3,0xbfb504f3
.long 0x3f800000,0x3f800000,0,0xc0000000,0x3f800000,0xbf800000,0xbfb504f3,0xbfb504f3
.long 0,0,0,0,0,0,0,0
.long 0,0,0,0,0,0,0,0
.long 0,0,0,0,0,0,0,0
.long 0,0,0,0,0,0,0,0
.long 0,0,0,0,0,0,0,0
.long 0,0,0,0,0,0,0,0
.long 0,0,0,0,0,0,0,0
.long 0,0,0,0,0,0,0,0
.long 0x3f800000,0x3f800000,0x40000000,0x80000000,0x3f800000,0xbf800000,0x3fb504f3,0xbfb504f3
.long 0x3f800000,0x3f800000,0,0xc0000000,0x3f800000,0xbf800000,0xbfb504f3,0xbfb504f3
.long 0,0,0,0,0,0,0,0
.long 0,0,0,0,0,0,0,0
.long 0,0,0,0,0,0,0,0
.long 0,0,0,0,0,0,0,0
.long 0,0,0,0,0,0,0,0
.long 0,0,0,0,0,0,0,0
.long 0,0,0,0,0,0,0,0
.long 0,0,0,0,0,0,0,0
.long 0x3f800000,0x3f800000,0x40000000,0x80000000,0x3f800000,0xbf800000,0x3fb504f3,0xbfb504f3
.long 0x3f800000,0x3f800000,0,0xc0000000,0x3f800000,0xbf800000,0xbfb504f3,0xbfb504f3
.long 0x40000000,0x80000000,0x40000000,0x80000000,0,0xc0000000,0xbfb504f3,0xbfb504f3
.long 0xc0000000,0x80000000,0x80000000,0x40000000,0x80000000,0x40000000,0x3fb504f3,0xbfb504f3
.long 0,0,0,0,0,0,0,0
.long 0,0,0,0,0,0,0,0
.long 0,0,0,0,0,0,0,0
.long 0,0,0,0,0,0,0,0
.long 0,0,0,0,0,0,0,0
.long 0,0,0,0,0,0,0,0
.long 0,0,0,0,0,0,0,0
.long 0,0,0,0,0,0,0,0
.long 0x40000000,0x80000000,0x40000000,0x80000000,0,0xc0000000,0xbfb504f3,0xbfb504f3
.long 0xc0000000,0x80000000,0x80000000,0x40000000,0x80000000,0x40000000,0x3fb504f3,0xbfb504f3
.long 0,0,0,0,0,0,0,0
.long 0,0,0,0,0,0,0,0
.long 0,0,0,0,0,0,0,0
.long 0,0,0,0,0,0,0,0
.long 0,0,0,0,0,0,0,0
.long 0,0,0,0,0,0,0,0
.long 0,0,0,0,0,0,0,0
.long 0,0,0,0,0,0,0,0
.long 0x40000000,0x80000000,0x40000000,0x80000000,0,0xc0000000,0xbfb504f3,0xbfb504f3
.long 0xc0000000,0x80000000,0x80000000,0x40000000,0x80000000,0x40000000,0x3fb504f3,0xbfb504f3
.long 0,0,0,0,0,0,0,0
.long 0,0,0,0,0,0,0,0
.long 0,0,0,0,0,0,0,0
.long 0,0,0,0,0,0,0,0
.long 0,0,0,0,0,0,0,0
.long 0,0,0,0,0,0,0,0
.long 0,0,0,0,0,0,0,0
.long 0,0,0,0,0,0,0,0
.long 0x40000000,0x80000000,0x40000000,0x80000000,0,0xc0000000,0xbfb504f3,0xbfb504f3
.long 0xc0000000,0x80000000,0x80000000,0x40000000,0x80000000,0x40000000,0x3fb504f3,0xbfb504f3
.long 0x3f80,0x3dc93f7f,0x3e483f7b,0x3e953f75,0x3f80,0x3ef13f62,0x3f553f0e,0x3f7f3dc9
.long 0x3f80,0x3f463f22,0x3f7bbe48,0x3ef1bf62,0x3f80,0x3f753e95,0x3f0ebf55,0xbf22bf46
.long 0x3f80,0x3f7fbdc9,0xbe48bf7b,0xbf753e95,0x3f80,0x3f62bef1,0xbf55bf0e,0xbdc93f7f
.long 0x3f80,0x3f22bf46,0xbf7b3e48,0x3f623ef1,0x3f80,0x3e95bf75,0xbf0e3f55,0x3f46bf22
.long 0x3f80,0xbdc9bf7f,0x3e483f7b,0xbe95bf75,0x3f80,0xbef1bf62,0x3f553f0e,0xbf7fbdc9
.long 0x3f80,0xbf46bf22,0x3f7bbe48,0xbef13f62,0x3f80,0xbf75be95,0x3f0ebf55,0x3f223f46
.long 0x3f80,0xbf7f3dc9,0xbe48bf7b,0x3f75be95,0x3f80,0xbf623ef1,0xbf55bf0e,0x3dc9bf7f
.long 0x3f80,0xbf223f46,0xbf7b3e48,0xbf62bef1,0x3f80,0xbe953f75,0xbf0e3f55,0xbf463f22
.long 0x3ec43f6d,0x3ef13f62,0x3f0e3f55,0x3f223f46,0x3f6dbec4,0x3f22bf46,0x3e48bf7b,0xbe95bf75
.long 0xbec4bf6d,0xbf75be95,0xbf553f0e,0xbdc93f7f,0xbf6d3ec4,0x3dc93f7f,0x3f7b3e48,0x3ef1bf62
.long 0x3ec43f6d,0x3f62bef1,0xbf0ebf55,0xbf463f22,0x3f6dbec4,0xbf46bf22,0xbe483f7b,0x3f75be95
.long 0xbec4bf6d,0xbe953f75,0x3f55bf0e,0xbf7fbdc9,0xbf6d3ec4,0x3f7fbdc9,0xbf7bbe48,0x3f623ef1
.long 0x3ec43f6d,0xbef1bf62,0x3f0e3f55,0xbf22bf46,0x3f6dbec4,0xbf223f46,0x3e48bf7b,0x3e953f75
.long 0xbec4bf6d,0x3f753e95,0xbf553f0e,0x3dc9bf7f,0xbf6d3ec4,0xbdc9bf7f,0x3f7b3e48,0xbef13f62
.long 0x3ec43f6d,0xbf623ef1,0xbf0ebf55,0x3f46bf22,0x3f6dbec4,0x3f463f22,0xbe483f7b,0xbf753e95
.long 0xbec4bf6d,0x3e95bf75,0x3f55bf0e,0x3f7f3dc9,0xbf6d3ec4,0xbf7f3dc9,0xbf7bbe48,0xbf62bef1
.long 0x3f353f35,0x3f463f22,0x3f553f0e,0x3f623ef1,0xbf35bf35,0xbf75be95,0xbf7b3e48,0xbf463f22
.long 0x3f353f35,0x3f7fbdc9,0x3f0ebf55,0xbe95bf75,0xbf35bf35,0xbf623ef1,0x3e483f7b,0x3f7f3dc9
.long 0x3f353f35,0x3f22bf46,0xbf55bf0e,0xbef13f62,0xbf35bf35,0xbe953f75,0x3f7bbe48,0xbf22bf46
.long 0x3f353f35,0xbdc9bf7f,0xbf0e3f55,0x3f75be95,0xbf35bf35,0x3ef13f62,0xbe48bf7b,0xbdc93f7f
.long 0x3f353f35,0xbf46bf22,0x3f553f0e,0xbf62bef1,0xbf35bf35,0x3f753e95,0xbf7b3e48,0x3f46bf22
.long 0x3f353f35,0xbf7f3dc9,0x3f0ebf55,0x3e953f75,0xbf35bf35,0x3f62bef1,0x3e483f7b,0xbf7fbdc9
.long 0x3f353f35,0xbf223f46,0xbf55bf0e,0x3ef1bf62,0xbf35bf35,0x3e95bf75,0x3f7bbe48,0x3f223f46
.long 0x3f353f35,0x3dc93f7f,0xbf0e3f55,0xbf753e95,0xbf35bf35,0xbef1bf62,0xbe48bf7b,0x3dc9bf7f
.long 0x3f6d3ec4,0x3f753e95,0x3f7b3e48,0x3f7f3dc9,0xbec43f6d,0x3dc93f7f,0x3f0e3f55,0x3f623ef1
.long 0xbf6dbec4,0xbf623ef1,0xbe483f7b,0x3f223f46,0x3ec4bf6d,0xbf46bf22,0xbf553f0e,0x3e953f75
.long 0x3f6d3ec4,0x3e95bf75,0xbf7bbe48,0xbdc93f7f,0xbec43f6d,0x3f7fbdc9,0xbf0ebf55,0xbef13f62
.long 0xbf6dbec4,0x3ef13f62,0x3e48bf7b,0xbf463f22,0x3ec4bf6d,0xbf223f46,0x3f55bf0e,0xbf753e95
.long 0x3f6d3ec4,0xbf75be95,0x3f7b3e48,0xbf7fbdc9,0xbec43f6d,0xbdc9bf7f,0x3f0e3f55,0xbf62bef1
.long 0xbf6dbec4,0x3f62bef1,0xbe483f7b,0xbf22bf46,0x3ec4bf6d,0x3f463f22,0xbf553f0e,0xbe95bf75
.long 0x3f6d3ec4,0xbe953f75,0xbf7bbe48,0x3dc9bf7f,0xbec43f6d,0xbf7f3dc9,0xbf0ebf55,0x3ef1bf62
.long 0xbf6dbec4,0xbef1bf62,0x3e48bf7b,0x3f46bf22,0x3ec4bf6d,0x3f22bf46,0x3f55bf0e,0x3f75be95
.long 0x3f808000,0x3f7fbdc9,0x3f7bbe48,0x3f75be95,0x3f808000,0x3f62bef1,0x3f0ebf55,0x3dc9bf7f
.long 0x3f808000,0x3f22bf46,0xbe48bf7b,0xbf62bef1,0x3f808000,0x3e95bf75,0xbf55bf0e,0xbf463f22
.long 0x3f808000,0xbdc9bf7f,0xbf7b3e48,0x3e953f75,0x3f808000,0xbef1bf62,0xbf0e3f55,0x3f7f3dc9
.long 0x3f808000,0xbf46bf22,0x3e483f7b,0x3ef1bf62,0x3f808000,0xbf75be95,0x3f553f0e,0xbf22bf46
.long 0x3f808000,0xbf7f3dc9,0x3f7bbe48,0xbf753e95,0x3f808000,0xbf623ef1,0x3f0ebf55,0xbdc93f7f
.long 0x3f808000,0xbf223f46,0xbe48bf7b,0x3f623ef1,0x3f808000,0xbe953f75,0xbf55bf0e,0x3f46bf22
.long 0x3f808000,0x3dc93f7f,0xbf7b3e48,0xbe95bf75,0x3f808000,0x3ef13f62,0xbf0e3f55,0xbf7fbdc9
.long 0x3f808000,0x3f463f22,0x3e483f7b,0xbef13f62,0x3f808000,0x3f753e95,0x3f553f0e,0x3f223f46
.long 0x3f6dbec4,0x3f62bef1,0x3f55bf0e,0x3f46bf22,0xbec4bf6d,0xbf46bf22,0xbf7bbe48,0xbf753e95
.long 0xbf6d3ec4,0xbe953f75,0x3f0e3f55,0x3f7f3dc9,0x3ec43f6d,0x3f7fbdc9,0x3e48bf7b,0xbf62bef1
.long 0x3f6dbec4,0xbef1bf62,0xbf553f0e,0x3f223f46,0xbec4bf6d,0xbf223f46,0x3f7b3e48,0xbe95bf75
.long 0xbf6d3ec4,0x3f753e95,0xbf0ebf55,0xbdc93f7f,0x3ec43f6d,0xbdc9bf7f,0xbe483f7b,0x3ef1bf62
.long 0x3f6dbec4,0xbf623ef1,0x3f55bf0e,0xbf463f22,0xbec4bf6d,0x3f463f22,0xbf7bbe48,0x3f75be95
.long 0xbf6d3ec4,0x3e95bf75,0x3f0e3f55,0xbf7fbdc9,0x3ec43f6d,0xbf7f3dc9,0x3e48bf7b,0x3f623ef1
.long 0x3f6dbec4,0x3ef13f62,0xbf553f0e,0xbf22bf46,0xbec4bf6d,0x3f22bf46,0x3f7b3e48,0x3e953f75
.long 0xbf6d3ec4,0xbf75be95,0xbf0ebf55,0x3dc9bf7f,0x3ec43f6d,0x3dc93f7f,0xbe483f7b,0xbef13f62
.long 0x3f35bf35,0x3f22bf46,0x3f0ebf55,0x3ef1bf62,0xbf353f35,0xbe953f75,0x3e483f7b,0x3f223f46
.long 0x3f35bf35,0xbdc9bf7f,0xbf55bf0e,0xbf753e95,0xbf353f35,0x3ef13f62,0x3f7bbe48,0x3dc9bf7f
.long 0x3f35bf35,0xbf46bf22,0xbf0e3f55,0x3f623ef1,0xbf353f35,0x3f753e95,0xbe48bf7b,0xbf463f22
.long 0x3f35bf35,0xbf7f3dc9,0x3f553f0e,0xbe95bf75,0xbf353f35,0x3f62bef1,0xbf7b3e48,0x3f7f3dc9
.long 0x3f35bf35,0xbf223f46,0x3f0ebf55,0xbef13f62,0xbf353f35,0x3e95bf75,0x3e483f7b,0xbf22bf46
.long 0x3f35bf35,0x3dc93f7f,0xbf55bf0e,0x3f75be95,0xbf353f35,0xbef1bf62,0x3f7bbe48,0xbdc93f7f
.long 0x3f35bf35,0x3f463f22,0xbf0e3f55,0xbf62bef1,0xbf353f35,0xbf75be95,0xbe48bf7b,0x3f46bf22
.long 0x3f35bf35,0x3f7fbdc9,0x3f553f0e,0x3e953f75,0xbf353f35,0xbf623ef1,0xbf7b3e48,0xbf7fbdc9
.long 0x3ec4bf6d,0x3e95bf75,0x3e48bf7b,0x3dc9bf7f,0x3f6d3ec4,0x3f7fbdc9,0x3f55bf0e,0x3ef1bf62
.long 0xbec43f6d,0x3ef13f62,0x3f7b3e48,0x3f46bf22,0xbf6dbec4,0xbf223f46,0x3f0e3f55,0x3f75be95
.long 0x3ec4bf6d,0xbf75be95,0xbe483f7b,0x3f7f3dc9,0x3f6d3ec4,0xbdc9bf7f,0xbf553f0e,0x3f623ef1
.long 0xbec43f6d,0x3f62bef1,0xbf7bbe48,0x3f223f46,0xbf6dbec4,0x3f463f22,0xbf0ebf55,0x3e953f75
.long 0x3ec4bf6d,0xbe953f75,0x3e48bf7b,0xbdc93f7f,0x3f6d3ec4,0xbf7f3dc9,0x3f55bf0e,0xbef13f62
.long 0xbec43f6d,0xbef1bf62,0x3f7b3e48,0xbf463f22,0xbf6dbec4,0x3f22bf46,0x3f0e3f55,0xbf753e95
.long 0x3ec4bf6d,0x3f753e95,0xbe483f7b,0xbf7fbdc9,0x3f6d3ec4,0x3dc93f7f,0xbf553f0e,0xbf62bef1
.long 0xbec43f6d,0xbf623ef1,0xbf7bbe48,0xbf22bf46,0xbf6dbec4,0xbf46bf22,0xbf0ebf55,0xbe95bf75
.long 0x80003f80,0x80003f80,0x80003f80,0x80003f80,0xbdc93f7f,0xbef13f62,0xbf463f22,0xbf753e95
.long 0xbe483f7b,0xbf553f0e,0xbf7bbe48,0xbf0ebf55,0xbe953f75,0xbf7f3dc9,0xbef1bf62,0x3f22bf46
.long 0xbec43f6d,0xbf6dbec4,0x3ec4bf6d,0x3f6d3ec4,0xbef13f62,0xbf22bf46,0x3f75be95,0xbdc93f7f
.long 0xbf0e3f55,0xbe48bf7b,0x3f553f0e,0xbf7b3e48,0xbf223f46,0x3e95bf75,0x3dc93f7f,0xbef1bf62
.long 0xbf353f35,0x3f35bf35,0xbf353f35,0x3f35bf35,0xbf463f22,0x3f75be95,0xbf7fbdc9,0x3f623ef1
.long 0xbf553f0e,0x3f7b3e48,0xbf0ebf55,0xbe483f7b,0xbf623ef1,0x3f463f22,0x3e95bf75,0xbf7f3dc9
.long 0xbf6d3ec4,0x3ec43f6d,0x3f6dbec4,0xbec4bf6d,0xbf753e95,0xbdc93f7f,0x3f623ef1,0x3f46bf22
.long 0xbf7b3e48,0xbf0e3f55,0x3e483f7b,0x3f553f0e,0xbf7f3dc9,0xbf623ef1,0xbf223f46,0xbe953f75
.long 0x80003f80,0x80003f80,0x80003f80,0x80003f80,0xbf7fbdc9,0xbf62bef1,0xbf22bf46,0xbe95bf75
.long 0x3e48bf7b,0x3f55bf0e,0x3f7b3e48,0x3f0e3f55,0x3f753e95,0x3dc93f7f,0xbf623ef1,0xbf46bf22
.long 0xbec43f6d,0xbf6dbec4,0x3ec4bf6d,0x3f6d3ec4,0xbf62bef1,0x3f46bf22,0x3e953f75,0xbf7fbdc9
.long 0x3f0ebf55,0x3e483f7b,0xbf55bf0e,0x3f7bbe48,0x3f463f22,0xbf75be95,0x3f7fbdc9,0xbf623ef1
.long 0xbf353f35,0x3f35bf35,0xbf353f35,0x3f35bf35,0xbf22bf46,0x3e953f75,0x3dc9bf7f,0xbef13f62
.long 0x3f55bf0e,0xbf7bbe48,0x3f0e3f55,0x3e48bf7b,0x3ef13f62,0x3f22bf46,0xbf75be95,0x3dc93f7f
.long 0xbf6d3ec4,0x3ec43f6d,0x3f6dbec4,0xbec4bf6d,0xbe95bf75,0xbf7fbdc9,0xbef13f62,0x3f223f46
.long 0x3f7bbe48,0x3f0ebf55,0xbe48bf7b,0xbf55bf0e,0x3dc93f7f,0x3ef13f62,0x3f463f22,0x3f753e95
.long 0x80003f80,0x80003f80,0x80003f80,0x80003f80,0x3dc9bf7f,0x3ef1bf62,0x3f46bf22,0x3f75be95
.long 0xbe483f7b,0xbf553f0e,0xbf7bbe48,0xbf0ebf55,0x3e95bf75,0x3f7fbdc9,0x3ef13f62,0xbf223f46
.long 0xbec43f6d,0xbf6dbec4,0x3ec4bf6d,0x3f6d3ec4,0x3ef1bf62,0x3f223f46,0xbf753e95,0x3dc9bf7f
.long 0xbf0e3f55,0xbe48bf7b,0x3f553f0e,0xbf7b3e48,0x3f22bf46,0xbe953f75,0xbdc9bf7f,0x3ef13f62
.long 0xbf353f35,0x3f35bf35,0xbf353f35,0x3f35bf35,0x3f46bf22,0xbf753e95,0x3f7f3dc9,0xbf62bef1
.long 0xbf553f0e,0x3f7b3e48,0xbf0ebf55,0xbe483f7b,0x3f62bef1,0xbf46bf22,0xbe953f75,0x3f7fbdc9
.long 0xbf6d3ec4,0x3ec43f6d,0x3f6dbec4,0xbec4bf6d,0x3f75be95,0x3dc9bf7f,0xbf62bef1,0xbf463f22
.long 0xbf7b3e48,0xbf0e3f55,0x3e483f7b,0x3f553f0e,0x3f7fbdc9,0x3f62bef1,0x3f22bf46,0x3e95bf75
.long 0x80003f80,0x80003f80,0x80003f80,0x80003f80,0x3f7f3dc9,0x3f623ef1,0x3f223f46,0x3e953f75
.long 0x3e48bf7b,0x3f55bf0e,0x3f7b3e48,0x3f0e3f55,0xbf75be95,0xbdc9bf7f,0x3f62bef1,0x3f463f22
.long 0xbec43f6d,0xbf6dbec4,0x3ec4bf6d,0x3f6d3ec4,0x3f623ef1,0xbf463f22,0xbe95bf75,0x3f7f3dc9
.long 0x3f0ebf55,0x3e483f7b,0xbf55bf0e,0x3f7bbe48,0xbf46bf22,0x3f753e95,0xbf7f3dc9,0x3f62bef1
.long 0xbf353f35,0x3f35bf35,0xbf353f35,0x3f35bf35,0x3f223f46,0xbe95bf75,0xbdc93f7f,0x3ef1bf62
.long 0x3f55bf0e,0xbf7bbe48,0x3f0e3f55,0x3e48bf7b,0xbef1bf62,0xbf223f46,0x3f753e95,0xbdc9bf7f
.long 0xbf6d3ec4,0x3ec43f6d,0x3f6dbec4,0xbec4bf6d,0x3e953f75,0x3f7f3dc9,0x3ef1bf62,0xbf22bf46
.long 0x3f7bbe48,0x3f0ebf55,0xbe48bf7b,0xbf55bf0e,0xbdc9bf7f,0xbef1bf62,0xbf46bf22,0xbf75be95
.long 0x3f800000,0x3f800000,0x3f800000,0x3f800000,0x3f7f3dc9,0x3f623ef1,0x3f223f46,0x3e953f75
.long 0x3f7b3e48,0x3f0e3f55,0xbe483f7b,0xbf553f0e,0x3f753e95,0x3dc93f7f,0xbf623ef1,0xbf46bf22
.long 0x3f6d3ec4,0xbec43f6d,0xbf6dbec4,0x3ec4bf6d,0x3f623ef1,0xbf463f22,0xbe95bf75,0x3f7f3dc9
.long 0x3f553f0e,0xbf7b3e48,0x3f0ebf55,0x3e483f7b,0x3f463f22,0xbf75be95,0x3f7fbdc9,0xbf623ef1
.long 0x3f353f35,0xbf35bf35,0x3f353f35,0xbf35bf35,0x3f223f46,0xbe95bf75,0xbdc93f7f,0x3ef1bf62
.long 0x3f0e3f55,0x3e48bf7b,0xbf553f0e,0x3f7b3e48,0x3ef13f62,0x3f22bf46,0xbf75be95,0x3dc93f7f
.long 0x3ec43f6d,0x3f6dbec4,0xbec4bf6d,0xbf6d3ec4,0x3e953f75,0x3f7f3dc9,0x3ef1bf62,0xbf22bf46
.long 0x3e483f7b,0x3f553f0e,0x3f7bbe48,0x3f0ebf55,0x3dc93f7f,0x3ef13f62,0x3f463f22,0x3f753e95
.long 0x3f800000,0x3f800000,0x3f800000,0x3f800000,0xbdc93f7f,0xbef13f62,0xbf463f22,0xbf753e95
.long 0xbf7bbe48,0xbf0ebf55,0x3e48bf7b,0x3f55bf0e,0x3e95bf75,0x3f7fbdc9,0x3ef13f62,0xbf223f46
.long 0x3f6d3ec4,0xbec43f6d,0xbf6dbec4,0x3ec4bf6d,0xbef13f62,0xbf22bf46,0x3f75be95,0xbdc93f7f
.long 0xbf55bf0e,0x3f7bbe48,0xbf0e3f55,0xbe48bf7b,0x3f22bf46,0xbe953f75,0xbdc9bf7f,0x3ef13f62
.long 0x3f353f35,0xbf35bf35,0x3f353f35,0xbf35bf35,0xbf463f22,0x3f75be95,0xbf7fbdc9,0x3f623ef1
.long 0xbf0ebf55,0xbe483f7b,0x3f55bf0e,0xbf7bbe48,0x3f62bef1,0xbf46bf22,0xbe953f75,0x3f7fbdc9
.long 0x3ec43f6d,0x3f6dbec4,0xbec4bf6d,0xbf6d3ec4,0xbf753e95,0xbdc93f7f,0x3f623ef1,0x3f46bf22
.long 0xbe48bf7b,0xbf55bf0e,0xbf7b3e48,0xbf0e3f55,0x3f7fbdc9,0x3f62bef1,0x3f22bf46,0x3e95bf75
.long 0x3f800000,0x3f800000,0x3f800000,0x3f800000,0xbf7fbdc9,0xbf62bef1,0xbf22bf46,0xbe95bf75
.long 0x3f7b3e48,0x3f0e3f55,0xbe483f7b,0xbf553f0e,0xbf75be95,0xbdc9bf7f,0x3f62bef1,0x3f463f22
.long 0x3f6d3ec4,0xbec43f6d,0xbf6dbec4,0x3ec4bf6d,0xbf62bef1,0x3f46bf22,0x3e953f75,0xbf7fbdc9
.long 0x3f553f0e,0xbf7b3e48,0x3f0ebf55,0x3e483f7b,0xbf46bf22,0x3f753e95,0xbf7f3dc9,0x3f62bef1
.long 0x3f353f35,0xbf35bf35,0x3f353f35,0xbf35bf35,0xbf22bf46,0x3e953f75,0x3dc9bf7f,0xbef13f62
.long 0x3f0e3f55,0x3e48bf7b,0xbf553f0e,0x3f7b3e48,0xbef1bf62,0xbf223f46,0x3f753e95,0xbdc9bf7f
.long 0x3ec43f6d,0x3f6dbec4,0xbec4bf6d,0xbf6d3ec4,0xbe95bf75,0xbf7fbdc9,0xbef13f62,0x3f223f46
.long 0x3e483f7b,0x3f553f0e,0x3f7bbe48,0x3f0ebf55,0xbdc9bf7f,0xbef1bf62,0xbf46bf22,0xbf75be95
.long 0x3f800000,0x3f800000,0x3f800000,0x3f800000,0x3dc9bf7f,0x3ef1bf62,0x3f46bf22,0x3f75be95
.long 0xbf7bbe48,0xbf0ebf55,0x3e48bf7b,0x3f55bf0e,0xbe953f75,0xbf7f3dc9,0xbef1bf62,0x3f22bf46
.long 0x3f6d3ec4,0xbec43f6d,0xbf6dbec4,0x3ec4bf6d,0x3ef1bf62,0x3f223f46,0xbf753e95,0x3dc9bf7f
.long 0xbf55bf0e,0x3f7bbe48,0xbf0e3f55,0xbe48bf7b,0xbf223f46,0x3e95bf75,0x3dc93f7f,0xbef1bf62
.long 0x3f353f35,0xbf35bf35,0x3f353f35,0xbf35bf35,0x3f46bf22,0xbf753e95,0x3f7f3dc9,0xbf62bef1
.long 0xbf0ebf55,0xbe483f7b,0x3f55bf0e,0xbf7bbe48,0xbf623ef1,0x3f463f22,0x3e95bf75,0xbf7f3dc9
.long 0x3ec43f6d,0x3f6dbec4,0xbec4bf6d,0xbf6d3ec4,0x3f75be95,0x3dc9bf7f,0xbf62bef1,0xbf463f22
.long 0xbe48bf7b,0xbf55bf0e,0xbf7b3e48,0xbf0e3f55,0xbf7f3dc9,0xbf623ef1,0xbf223f46,0xbe953f75
.long 0x3f800000,0x3f7ffec4,0x3f7ffb11,0x3f7ff4e6,0x3f800000,0x3f7fe129,0x3f7f84ab,0x3f7eea9d
.long 0x3f800000,0x3f7f9c18,0x3f7e70b0,0x3f7c7eb0,0x3f800000,0x3f7f2f9d,0x3f7cbfc9,0x3f78b47b
.long 0x3f800000,0x3f7e9bc9,0x3f7a7302,0x3f73913f,0x3f800000,0x3f7de0b1,0x3f778bc5,0x3f6d1c1d
.long 0x3f800000,0x3f7cfe73,0x3f740bdd,0x3f655e0b,0x3f800000,0x3f7bf531,0x3f6ff573,0x3f5c61c7
.long 0x3f800000,0x3f7ac516,0x3f6b4b0c,0x3f5233c6,0x3f800000,0x3f796e4e,0x3f660f88,0x3f46e22a
.long 0x3f800000,0x3f77f110,0x3f604621,0x3f3a7ca4,0x3f800000,0x3f764d97,0x3f59f26a,0x3f2d1469
.long 0x3f800000,0x3f748422,0x3f531849,0x3f1ebc12,0x3f800000,0x3f7294f8,0x3f4bbbf8,0x3f0f8784
.long 0x3f800000,0x3f708066,0x3f43e200,0x3eff17b2,0x3f800000,0x3f6e46be,0x3f3b8f3b,0x3eddbe79
.long 0x3f7fec43,0x3f7fe129,0x3f7fd397,0x3f7fc38f,0x3f7e1324,0x3f7cfe73,0x3f7baccd,0x3f7a1e84
.long 0x3f79c79d,0x3f764d97,0x3f721352,0x3f6d1c1d,0x3f731447,0x3f6be858,0x3f633c5a,0x3f591e6a
.long 0x3f6a09a7,0x3f5df6be,0x3f4f7a1f,0x3f3ebc1b,0x3f5ebe05,0x3f4cae79,0x3f373a23,0x3f1ebc12
.long 0x3f514d3d,0x3f385216,0x3f1b02c6,0x3ef41f07,0x3f41d870,0x3f212ff9,0x3ef6e0cb,0x3ea395c5
.long 0x3f3085bb,0x3f07a136,0x3eb263ef,0x3e1c76de,0x3f1d7fd1,0x3ed8106b,0x3e541501,0xbc96c9b6
.long 0x3f08f59b,0x3e9d9e78,0x3d7b2b74,0xbe419b37,0x3ee63375,0x3e419b37,0xbdafb680,0xbeb554ec
.long 0x3eb8442a,0x3d8a200a,0xbe6c9a7f,0xbf0242b1,0x3e888e93,0xbd621469,0xbebe1d4a,0xbf26050a
.long 0x3e2f10a2,0xbe354098,0xbf00e7e4,0xbf44e3f5,0x3d96a905,0xbe97a117,0xbf1ff6cb,0xbf5df6be
.long 0x3f7fb10f,0x3f7f9c18,0x3f7f84ab,0x3f7f6ac7,0x3f7853f8,0x3f764d97,0x3f740bdd,0x3f718f57
.long 0x3f676bd8,0x3f6106f2,0x3f59f26a,0x3f5233c6,0x3f4d9f02,0x3f40d0da,0x3f32c8c9,0x3f239da9
.long 0x3f2beb4a,0x3f173c07,0x3f00e7e4,0x3ed25a09,0x3f039c3d,0x3ecc9b8b,0x3e8e9a22,0x3e1c76de
.long 0x3eac7cd4,0x3e419b37,0x3d16c32c,0xbdee3876,0x3e164083,0xbcfb49ba,0xbe541501,0xbec1071e
.long 0xbd48fb30,0xbe7ee6e1,0xbee0924f,0xbf1c420c,0xbe78cfcc,0xbee900b7,0xbf24d225,0xbf4cae79
.long 0xbedae880,0xbf239da9,0xbf4f7a1f,0xbf6e46be,0xbf187fc0,0xbf4ac77f,0xbf6db293,0xbf7e9bc9
.long 0xbf3daef9,0xbf6816a8,0xbf7dabcc,0xbf7c7eb0,0xbf5b941a,0xbf7a1e84,0xbf7e70b0,0xbf6816a8
.long 0xbf710908,0xbf7ffec4,0xbf6ff573,0xbf42de29,0xbf7d3aac,0xbf796e4e,0xbf531849,0xbf0f8784
.long 0x3f7f4e6d,0x3f7f2f9d,0x3f7f0e58,0x3f7eea9d,0x3f6ed89e,0x3f6be858,0x3f68bf3c,0x3f655e0b
.long 0x3f49d112,0x3f40d0da,0x3f373a23,0x3f2d1469,0x3f13682a,0x3f0242b1,0x3ee0924f,0x3ebb31a0
.long 0x3ea09ae5,0x3e5a3997,0x3de1bc2e,0x3bc90f88,0x3cc90ab0,0xbdd53db9,0xbe6c9a7f,0xbeb554ec
.long 0xbe888e93,0xbed25a09,0xbf0b9a6b,0xbf2ac082,0xbf08f59b,0xbf2d1469,0xbf4bbbf8,0xbf63f473
.long 0xbf41d870,0xbf5f8327,0xbf740bdd,0xbf7e9bc9,0xbf6a09a7,0xbf7b61fc,0xbf7fd397,0xbf772417
.long 0xbf7e1324,0xbf7de0b1,0xbf6db293,0xbf4e8d90,0xbf7c3b28,0xbf66becc,0xbf3fc767,0xbf0a48ad
.long 0xbf64aa59,0xbf385216,0xbef6e0cb,0xbe4dee60,0xbf396842,0xbeee9479,0xbe22abb6,0x3e28defc
.long 0xbefc5d27,0xbe28defc,0x3e3b6ecf,0x3f0242b1,0xbe605c13,0x3e1c76de,0x3f00e7e4,0x3f48d8b3
.long 0,0x3bc90f88,0x3c490e90,0x3c96c9b6,0,0x3cfb49ba,0x3d7b2b74,0x3dbc3ac3
.long 0,0x3d621469,0x3de1bc2e,0x3e28defc,0,0x3da3308c,0x3e22abb6,0x3e72b651
.long 0,0x3dd53db9,0x3e541501,0x3e9d9e78,0,0x3e039502,0x3e827dc0,0x3ec1071e
.long 0,0x3e1c76de,0x3e9aa086,0x3ee363fa,0,0x3e354098,0x3eb263ef,0x3f0242b1
.long 0,0x3e4dee60,0x3ec9b953,0x3f121eb0,0,0x3e667c66,0x3ee0924f,0x3f212ff9
.long 0,0x3e7ee6e1,0x3ef6e0cb,0x3f2f61a5,0,0x3e8b9507,0x3f064b82,0x3f3ca003
.long 0,0x3e97a117,0x3f10d3cd,0x3f48d8b3,0,0x3ea395c5,0x3f1b02c6,0x3f53fac3
.long 0,0x3eaf713a,0x3f24d225,0x3f5df6be,0,0x3ebb31a0,0x3f2e3bde,0x3f66becc
.long 0x3cc90ab0,0x3cfb49ba,0x3d16c32c,0x3d2fe007,0x3dfab273,0x3e1c76de,0x3e3b6ecf,0x3e5a3997
.long 0x3e605c13,0x3e8b9507,0x3ea68f12,0x3ec1071e,0x3ea09ae5,0x3ec6d529,0x3eebcbbb,0x3f07a136
.long 0x3ecf7bca,0x3eff17b2,0x3f15f6d9,0x3f2ac082,0x3efc5d27,0x3f19c200,0x3f32c8c9,0x3f48d8b3
.long 0x3f13682a,0x3f31a81d,0x3f4bbbf8,0x3f6106f2,0x3f273656,0x3f46e22a,0x3f604621,0x3f7294f8
.long 0x3f396842,0x3f591e6a,0x3f6ff573,0x3f7cfe73,0x3f49d112,0x3f6816a8,0x3f7a7302,0x3f7ff4e6
.long 0x3f584853,0x3f73913f,0x3f7f84ab,0x3f7b61fc,0x3f64aa59,0x3f7b61fc,0x3f7f0e58,0x3f6f6830
.long 0x3f6ed89e,0x3f7f6ac7,0x3f791298,0x3f5c61c7,0x3f76ba07,0x3f7f9c18,0x3f6db293,0x3f42de29
.long 0x3f7c3b28,0x3f7bf531,0x3f5d2d53,0x3f239da9,0x3f7f4e6d,0x3f748422,0x3f47de65,0x3eff17b2
.long 0x3d48fb30,0x3d621469,0x3d7b2b74,0x3d8a200a,0x3e78cfcc,0x3e8b9507,0x3e9aa086,0x3ea986c4
.long 0x3edae880,0x3ef41f07,0x3f064b82,0x3f121eb0,0x3f187fc0,0x3f286605,0x3f373a23,0x3f44e3f5
.long 0x3f3daef9,0x3f4e8d90,0x3f5d2d53,0x3f696591,0x3f5b941a,0x3f6aab7b,0x3f75dec6,0x3f7cfe73
.long 0x3f710908,0x3f7b61fc,0x3f7fd397,0x3f7e4323,0x3f7d3aac,0x3f7fe129,0x3f7a7302,0x3f6d1c1d
.long 0x3f7fb10f,0x3f77f110,0x3f660f88,0x3f4ac77f,0x3f7853f8,0x3f63f473,0x3f43e200,0x3f19c200
.long 0x3f676bd8,0x3f44e3f5,0x3f15f6d9,0x3ebb31a0,0x3f4d9f02,0x3f1c420c,0x3ebe1d4a,0x3dd53db9
.long 0x3f2beb4a,0x3ed8106b,0x3e09cf86,0xbe28defc,0x3f039c3d,0x3e5a3997,0xbde1bc2e,0xbed8106b
.long 0x3eac7cd4,0xbbc90f88,0xbeb263ef,0xbf26050a,0x3e164083,0xbe667c66,0xbf10d3cd,0xbf53fac3
.long 0x3d96a905,0x3da3308c,0x3dafb680,0x3dbc3ac3,0x3eb8442a,0x3ec6d529,0x3ed53641,0x3ee363fa
.long 0x3f1d7fd1,0x3f286605,0x3f32c8c9,0x3f3ca003,0x3f514d3d,0x3f5c61c7,0x3f660f88,0x3f6e46be
.long 0x3f731447,0x3f7a1e84,0x3f7e70b0,0x3f7ffec4,0x3f7fec43,0x3f7e9bc9,0x3f791298,0x3f6f6830
.long 0x3f76ba07,0x3f696591,0x3f5695e5,0x3f3ebc1b,0x3f584853,0x3f3ca003,0x3f1b02c6,0x3ee900b7
.long 0x3f273656,0x3ef9a02d,0x3e9aa086,0x3dd53db9,0x3ecf7bca,0x3e419b37,0xbd16c32c,0xbe8586ce
.long 0x3dfab273,0xbe039502,0xbebe1d4a,0xbf173c07,0xbe2f10a2,0xbeddbe79,0xbf299415,0xbf577026
.long 0xbee63375,0xbf31a81d,0xbf604621,0xbf7ac516,0xbf3085bb,0xbf628210,0xbf7cbfc9,0xbf7c7eb0
.long 0xbf5ebe05,0xbf7c7eb0,0xbf7baccd,0xbf5c61c7,0xbf79c79d,0xbf7cfe73,0xbf5d2d53,0xbf1ebc12
.long 0x354ccccd,0x354ccccd,0x354ccccd,0x354ccccd,0x354ccbd0,0x354cb421,0x354c7ce0,0x354c2618
.long 0x354cc8da,0x354c6a23,0x354b8d5a,0x354a3307,0x354cc3eb,0x354beee4,0x3549fef3,0x3546f6c8
.long 0x354cbd02,0x354b4283,0x3547d2e4,0x354276a0,0x354cb421,0x354a6529,0x35450adf,0x353cb9e0
.long 0x354ca946,0x3549570a,0x3541a90f,0x3535c9e1,0x354c9c72,0x3548186a,0x353db017,0x352db1ef
.long 0x354c8da6,0x3546a993,0x35392313,0x35247f35,0x354c7ce0,0x35450adf,0x3534058e,0x351a40ae
.long 0x354c6a23,0x35433cb1,0x352e5b88,0x350f0707,0x354c556c,0x35413f79,0x3528296b,0x3502e487
.long 0x354c3ebe,0x353f13b1,0x3521740f,0x34ebd9dd,0x354c2618,0x353cb9e0,0x351a40ae,0x34d06ab5
.long 0x354c0b7a,0x353a3296,0x351294e9,0x34b3a83f,0x354beee4,0x35377e6f,0x350a76bb,0x3495c14d
.long 0x354ccccd,0x354ccccd,0x354ccccd,0x354ccccd,0x354bafd4,0x354b1a27,0x354a6529,0x354990f4
.long 0x35485c01,0x3546096a,0x35433cb1,0x353ff78f,0x3542da99,0x353db017,0x35377e6f,0x35304e38
.long 0x353b3aec,0x3532319e,0x352770fe,0x351b138d,0x35319232,0x3523bec8,0x351374de,0x3500f32d
.long 0x3525fb4c,0x351294e9,0x34f8046f,0x34c580a2,0x3518967c,0x34fdf9b6,0x34c34c06,0x3482de37
.long 0x35098908,0x34d29394,0x3489fd76,0x33f06739,0x34f1f9a5,0x34a3afa2,0x341ae293,0xb2c907c8
.long 0x34ce3fd4,0x346429d0,0x32f13846,0xb429aa67,0x34a84807,0x33fa57c9,0xb3be9392,0xb49a6c18
.long 0x34807bea,0x32a0d559,0xb45a7db8,0xb4db2291,0x342e9479,0xb3aa97c7,0xb4a84807,0xb50a76bb
.long 0x33b4968b,0xb43d4866,0xb4df5d78,0xb522fcc6,0x31a0d93a,0xb49110bd,0xb5089a01,0xb5365d28
.long 0x354ccccd,0x354ccccd,0x354ccccd,0x354ccccd,0x35489dab,0x35478b72,0x35465a74,0x35450adf
.long 0x353c3c09,0x35380c6c,0x35336b4e,0x352e5b88,0x3528296b,0x351f1b54,0x35153084,0x350a76bb
.long 0x350d37c9,0x34fbffb5,0x34db2291,0x34b8292a,0x34d901f0,0x34acd9f0,0x347c30c0,0x341ae293
.long 0x348eb659,0x3429aa67,0x3348ef90,0xb38c9200,0x33fa57c9,0xb27142bd,0xb41ae293,0xb49110bd
.long 0xb320c8f3,0xb4470ca3,0xb4af2067,0xb4f3ff99,0xb44bebe7,0xb4ba66f9,0xb502e487,0xb5223933
.long 0xb4b3a83f,0xb503db51,0xb525fb4c,0xb53e2876,0xb4fa0347,0xb523bec8,0xb53e9eff,0xb54bafd4
.long 0xb51b138d,0xb53b3aec,0xb54b4283,0xb549c8ed,0xb532cf52,0xb5491b30,0xb54b1a27,0xb53898a3
.long 0xb5433cb1,0xb54ca946,0xb53e2876,0xb5196c52,0xb54bafd4,0xb545b679,0xb5253e0d,0xb4dd4116
.long 0x354ccccd,0x354ccccd,0x354ccccd,0x354ccccd,0x35439ce8,0x354210c7,0x354066b8,0x353e9eff
.long 0x3528e03a,0x3522fcc6,0x351cb4cd,0x35160c2f,0x34fdf9b6,0x34e5a5a1,0x34cc12f5,0x34b1652e
.long 0x349369bb,0x345a7db8,0x340c0d4f,0x33710e6e,0x335d000f,0xb334dd20,0xb411007a,0xb4729b58
.long 0xb43d4866,0xb498176e,0xb4ce3fd4,0xb4fff144,0xb4d06ab5,0xb504d0d5,0xb51d832a,0xb5319232
.long 0xb517bf2e,0xb52fa9af,0xb540d407,0xb54a9556,0xb539abba,0xb548186a,0xb54ccbd0,0xb5478b72
.long 0xb54aefd6,0xb54b8d5a,0xb53ff78f,0xb528e03a,0xb549fef3,0xb539abba,0xb51be4ed,0xb4e5a5a1
.long 0xb536eeae,0xb5145368,0xb4c9e41f,0xb4337cdc,0xb51374de,0xb4bedd2d,0xb40718ca,0x33fa57c9
.long 0xb4c580a2,0xb40222f8,0x3415f23f,0x34ce3fd4,0xb424beb3,0x340718ca,0x34d06ab5,0x3520ad5c
.long 0,0,0,0,0x31a0d93a,0x32c907c8,0x3334dd20,0x33828d3d
.long 0x3220d873,0x3348ef90,0x33b4968b,0x340222f8,0x327142bd,0x33969569,0x340718ca,0x34422b74
.long 0x32a0d559,0x33c88ec2,0x34337cdc,0x34807bea,0x32c907c8,0x33fa57c9,0x345f54d8,0x349f10ee
.long 0x32f13846,0x3415f23f,0x34853f42,0x34bca2fc,0x330cb338,0x342e9479,0x349a6c18,0x34d901f0
.long 0x3320c8f3,0x34470ca3,0x34af2067,0x34f3ff99,0x3334dd20,0x345f54d8,0x34c34c06,0x3506b804
.long 0x3348ef90,0x3477673d,0x34d6df37,0x351294e9,0x335d000f,0x34879f03,0x34e9cab3,0x351d832a
.long 0x33710e6e,0x349369bb,0x34fbffb5,0x352770fe,0x33828d3d,0x349f10ee,0x3506b804,0x35304e38
.long 0x338c9200,0x34aa91ce,0x350f0707,0x35380c6c,0x33969569,0x34b5e995,0x3516e669,0x353e9eff
.long 0,0,0,0,0x33aa97c7,0x33d28804,0x33fa57c9,0x3411007a
.long 0x3429aa67,0x3450c934,0x3477673d,0x348eb659,0x347c30c0,0x349a6c18,0x34b5e995,0x34d06ab5
.long 0x34a5fca2,0x34c9e41f,0x34ebd9dd,0x3505c511,0x34cc12f5,0x34f60334,0x350e2017,0x351f1b54
.long 0x34eff15b,0x350f0707,0x3522fcc6,0x35336b4e,0x35089a01,0x3520ad5c,0x3534058e,0x354210c7
.long 0x3517bf2e,0x352fa9af,0x3540d407,0x354a9556,0x35253e0d,0x353bbc62,0x35491b30,0x354cb421
.long 0x3530f10f,0x3544b238,0x354ca946,0x35485c01,0x353ab7a7,0x354a6529,0x354b68e9,0x353db017
.long 0x354276a0,0x354cbd02,0x3545619f,0x352d06a9,0x3548186a,0x354bafd4,0x353ab7a7,0x3516e669
.long 0x354b8d5a,0x35474213,0x352bab1e,0x34f8046f,0x354ccbd0,0x353f868d,0x3518967c,0x34ba66f9
.long 0,0,0,0,0x3424beb3,0x34386384,0x344bebe7,0x345f54d8
.long 0x34a1610f,0x34b3a83f,0x34c580a2,0x34d6df37,0x34e9cab3,0x3500f32d,0x350c4e1d,0x3516e669
.long 0x35145368,0x3521740f,0x352d06a9,0x3536eeae,0x352db1ef,0x3539abba,0x3542da99,0x35491b30
.long 0x353ff78f,0x35485c01,0x354c6a23,0x354c0b7a,0x354a6529,0x354cc3eb,0x35491b30,0x353f868d
.long 0x354c8da6,0x3546a993,0x35392313,0x35247f35,0x35465a74,0x35365d28,0x351d832a,0x34fa0347
.long 0x35380c6c,0x351cb4cd,0x34eff15b,0x3498176e,0x35223933,0x34f60334,0x3495c14d,0x33aa97c7
.long 0x3505c511,0x34a5fca2,0x33c88ec2,0xb40c0d4f,0x34c7b357,0x341ae293,0xb3d28804,0xb4b1652e
.long 0x3477673d,0xb2f13846,0xb498176e,0xb507a9aa,0x33aa97c7,0xb455a47e,0xb4f1f9a5,0xb52c59b8
.long 0,0,0,0,0x34729b58,0x3482de37,0x348c5a95,0x3495c14d
.long 0x34e7b948,0x34f8046f,0x3503db51,0x350b6318,0x3520ad5c,0x35299568,0x35319232,0x353898a3
.long 0x353f13b1,0x3545619f,0x3549c8ed,0x354c3ebe,0x354c556c,0x354c7ce0,0x354990f4,0x35439ce8
.long 0x35474213,0x353e2876,0x3530f10f,0x351fe51e,0x35304e38,0x351be4ed,0x3502e487,0x34cc12f5
.long 0x35098908,0x34d29394,0x3489fd76,0x33f06739,0x34acd9f0,0x342e9479,0xb1a0d93a,0xb4386384
.long 0x33dc7f3e,0xb3b4968b,0xb48eb659,0xb4e7b948,0xb40718ca,0xb4acd9f0,0xb504d0d5,0xb5299568
.long 0xb4b8292a,0xb50d37c9,0xb532319e,0xb547d2e4,0xb50e2017,0xb53534da,0xb549fef3,0xb54a6529
.long 0xb5336b4e,0xb54a3307,0xb549570a,0xb530f10f,0xb5489dab,0xb549fef3,0xb5304e38,0xb4fdf9b6
.long 0x3f80,0x3f80,0x3f80,0x3f80,0x3f80,0x3ec43f6d,0x3f353f35,0x3f6d3ec4
.long 0x3f80,0x3f353f35,0x3f80248d,0x3f35bf35,0x3f80,0x3f6d3ec4,0x3f35bf35,0xbec4bf6d
.long 0x3f80,0x3f80248d,0x250dbf80,0xbf80a554,0x3f80,0x3f6dbec4,0xbf35bf35,0xbec43f6d
.long 0x3f80,0x3f35bf35,0xbf80a554,0x3f353f35,0x3f80,0x3ec4bf6d,0xbf353f35,0x3f6dbec4
.long 0x3f80,0x250dbf80,0x3f80,0x250dbf80,0x3f80,0xbec4bf6d,0x3f353f35,0xbf6dbec4
.long 0x3f80,0xbf35bf35,0x3f80248d,0xbf353f35,0x3f80,0xbf6dbec4,0x3f35bf35,0x3ec43f6d
.long 0x3f80,0xbf80a554,0x250dbf80,0x3f80248d,0x3f80,0xbf6d3ec4,0xbf35bf35,0x3ec4bf6d
.long 0x3f80,0xbf353f35,0xbf80a554,0xbf35bf35,0x3f80,0xbec43f6d,0xbf353f35,0xbf6d3ec4
.long 0x3f80,0x3f80,0x3f80,0x3f80,0x3f80248d,0x3f6dbec4,0x3f35bf35,0x3ec4bf6d
.long 0x250dbf80,0xbf35bf35,0xbf80a554,0xbf353f35,0xbf80a554,0xbec43f6d,0x3f353f35,0x3f6dbec4
.long 0x3f80,0x3f80248d,0x250dbf80,0xbf80a554,0x3f80248d,0xbec4bf6d,0xbf353f35,0x3f6d3ec4
.long 0x250dbf80,0xbf353f35,0x3f80248d,0xbf35bf35,0xbf80a554,0x3f6d3ec4,0xbf35bf35,0x3ec43f6d
.long 0x3f80,0x250dbf80,0x3f80,0x250dbf80,0x3f80248d,0xbf6d3ec4,0x3f35bf35,0xbec43f6d
.long 0x250dbf80,0x3f353f35,0xbf80a554,0x3f35bf35,0xbf80a554,0x3ec4bf6d,0x3f353f35,0xbf6d3ec4
.long 0x3f80,0xbf80a554,0x250dbf80,0x3f80248d,0x3f80248d,0x3ec43f6d,0xbf353f35,0xbf6dbec4
.long 0x250dbf80,0x3f35bf35,0x3f80248d,0x3f353f35,0xbf80a554,0xbf6dbec4,0xbf35bf35,0xbec4bf6d
.long 0x3f80,0x3f80,0x3f80,0x3f80,0x250dbf80,0xbec4bf6d,0xbf35bf35,0xbf6dbec4
.long 0x3f80,0x3f353f35,0x3f80248d,0x3f35bf35,0x250dbf80,0xbf6dbec4,0xbf353f35,0x3ec43f6d
.long 0x3f80,0x3f80248d,0x250dbf80,0xbf80a554,0x250dbf80,0xbf6d3ec4,0x3f353f35,0x3ec4bf6d
.long 0x3f80,0x3f35bf35,0xbf80a554,0x3f353f35,0x250dbf80,0xbec43f6d,0x3f35bf35,0xbf6d3ec4
.long 0x3f80,0x250dbf80,0x3f80,0x250dbf80,0x250dbf80,0x3ec43f6d,0xbf35bf35,0x3f6d3ec4
.long 0x3f80,0xbf35bf35,0x3f80248d,0xbf353f35,0x250dbf80,0x3f6d3ec4,0xbf353f35,0xbec4bf6d
.long 0x3f80,0xbf80a554,0x250dbf80,0x3f80248d,0x250dbf80,0x3f6dbec4,0x3f353f35,0xbec43f6d
.long 0x3f80,0xbf353f35,0xbf80a554,0xbf35bf35,0x250dbf80,0x3ec4bf6d,0x3f35bf35,0x3f6dbec4
.long 0x3f80,0x3f80,0x3f80,0x3f80,0xbf80a554,0xbf6d3ec4,0xbf353f35,0xbec43f6d
.long 0x250dbf80,0xbf35bf35,0xbf80a554,0xbf353f35,0x3f80248d,0x3ec4bf6d,0xbf35bf35,0xbf6d3ec4
.long 0x3f80,0x3f80248d,0x250dbf80,0xbf80a554,0xbf80a554,0x3ec43f6d,0x3f35bf35,0xbf6dbec4
.long 0x250dbf80,0xbf353f35,0x3f80248d,0xbf35bf35,0x3f80248d,0xbf6dbec4,0x3f353f35,0xbec4bf6d
.long 0x3f80,0x250dbf80,0x3f80,0x250dbf80,0xbf80a554,0x3f6dbec4,0xbf353f35,0x3ec4bf6d
.long 0x250dbf80,0x3f353f35,0xbf80a554,0x3f35bf35,0x3f80248d,0xbec43f6d,0xbf35bf35,0x3f6dbec4
.long 0x3f80,0xbf80a554,0x250dbf80,0x3f80248d,0xbf80a554,0xbec4bf6d,0x3f35bf35,0x3f6d3ec4
.long 0x250dbf80,0x3f35bf35,0x3f80248d,0x3f353f35,0x3f80248d,0x3f6d3ec4,0x3f353f35,0x3ec43f6d
.long 0x3f808000,0x3f808000,0x3f808000,0x3f808000,0x3f808000,0x3f6dbec4,0x3f35bf35,0x3ec4bf6d
.long 0x3f808000,0x3f35bf35,0x248dbf80,0xbf35bf35,0x3f808000,0x3ec4bf6d,0xbf35bf35,0xbf6d3ec4
.long 0x3f808000,0x248dbf80,0xbf80a50d,0xa5543f80,0x3f808000,0xbec4bf6d,0xbf353f35,0x3f6d3ec4
.long 0x3f808000,0xbf35bf35,0xa5543f80,0x3f35bf35,0x3f808000,0xbf6dbec4,0x3f353f35,0xbec4bf6d
.long 0x3f808000,0xbf80a50d,0x3f808000,0xbf80a50d,0x3f808000,0xbf6d3ec4,0x3f35bf35,0xbec43f6d
.long 0x3f808000,0xbf353f35,0x248dbf80,0x3f353f35,0x3f808000,0xbec43f6d,0xbf35bf35,0x3f6dbec4
.long 0x3f808000,0xa5543f80,0xbf80a50d,0x248dbf80,0x3f808000,0x3ec43f6d,0xbf353f35,0xbf6dbec4
.long 0x3f808000,0x3f353f35,0xa5543f80,0xbf353f35,0x3f808000,0x3f6d3ec4,0x3f353f35,0x3ec43f6d
.long 0x3f808000,0x3f808000,0x3f808000,0x3f808000,0x248dbf80,0xbec4bf6d,0xbf35bf35,0xbf6dbec4
.long 0xbf80a50d,0xbf353f35,0xa5543f80,0x3f353f35,0xa5543f80,0x3f6d3ec4,0x3f35bf35,0xbec4bf6d
.long 0x3f808000,0x248dbf80,0xbf80a50d,0xa5543f80,0x248dbf80,0xbf6d3ec4,0x3f353f35,0x3ec4bf6d
.long 0xbf80a50d,0x3f353f35,0x248dbf80,0xbf353f35,0xa5543f80,0x3ec4bf6d,0xbf353f35,0x3f6dbec4
.long 0x3f808000,0xbf80a50d,0x3f808000,0xbf80a50d,0x248dbf80,0x3ec43f6d,0xbf35bf35,0x3f6d3ec4
.long 0xbf80a50d,0x3f35bf35,0xa5543f80,0xbf35bf35,0xa5543f80,0xbf6dbec4,0x3f35bf35,0x3ec43f6d
.long 0x3f808000,0xa5543f80,0xbf80a50d,0x248dbf80,0x248dbf80,0x3f6dbec4,0x3f353f35,0xbec43f6d
.long 0xbf80a50d,0xbf35bf35,0x248dbf80,0x3f35bf35,0xa5543f80,0xbec43f6d,0xbf353f35,0xbf6d3ec4
.long 0x3f808000,0x3f808000,0x3f808000,0x3f808000,0xbf80a50d,0xbf6d3ec4,0xbf353f35,0xbec43f6d
.long 0x3f808000,0x3f35bf35,0x248dbf80,0xbf35bf35,0xbf80a50d,0xbec43f6d,0x3f353f35,0x3f6dbec4
.long 0x3f808000,0x248dbf80,0xbf80a50d,0xa5543f80,0xbf80a50d,0x3ec43f6d,0x3f35bf35,0xbf6dbec4
.long 0x3f808000,0xbf35bf35,0xa5543f80,0x3f35bf35,0xbf80a50d,0x3f6d3ec4,0xbf35bf35,0x3ec43f6d
.long 0x3f808000,0xbf80a50d,0x3f808000,0xbf80a50d,0xbf80a50d,0x3f6dbec4,0xbf353f35,0x3ec4bf6d
.long 0x3f808000,0xbf353f35,0x248dbf80,0x3f353f35,0xbf80a50d,0x3ec4bf6d,0x3f353f35,0xbf6d3ec4
.long 0x3f808000,0xa5543f80,0xbf80a50d,0x248dbf80,0xbf80a50d,0xbec4bf6d,0x3f35bf35,0x3f6d3ec4
.long 0x3f808000,0x3f353f35,0xa5543f80,0xbf353f35,0xbf80a50d,0xbf6dbec4,0xbf35bf35,0xbec4bf6d
.long 0x3f808000,0x3f808000,0x3f808000,0x3f808000,0xa5543f80,0x3ec43f6d,0x3f353f35,0x3f6d3ec4
.long 0xbf80a50d,0xbf353f35,0xa5543f80,0x3f353f35,0x248dbf80,0xbf6dbec4,0xbf353f35,0x3ec43f6d
.long 0x3f808000,0x248dbf80,0xbf80a50d,0xa5543f80,0xa5543f80,0x3f6dbec4,0xbf35bf35,0xbec43f6d
.long 0xbf80a50d,0x3f353f35,0x248dbf80,0xbf353f35,0x248dbf80,0xbec43f6d,0x3f35bf35,0xbf6d3ec4
.long 0x3f808000,0xbf80a50d,0x3f808000,0xbf80a50d,0xa5543f80,0xbec4bf6d,0x3f353f35,0xbf6dbec4
.long 0xbf80a50d,0x3f35bf35,0xa5543f80,0xbf35bf35,0x248dbf80,0x3f6d3ec4,0xbf353f35,0xbec4bf6d
.long 0x3f808000,0xa5543f80,0xbf80a50d,0x248dbf80,0xa5543f80,0xbf6d3ec4,0xbf35bf35,0x3ec4bf6d
.long 0xbf80a50d,0xbf35bf35,0x248dbf80,0x3f35bf35,0x248dbf80,0x3ec4bf6d,0x3f35bf35,0x3f6dbec4
.long 0x80003f80,0x80003f80,0x80003f80,0x80003f80,0x80003f80,0xbec43f6d,0xbf353f35,0xbf6d3ec4
.long 0x80003f80,0xbf353f35,0xbf80248d,0xbf35bf35,0x80003f80,0xbf6d3ec4,0xbf35bf35,0x3ec4bf6d
.long 0x80003f80,0xbf80248d,0xa50dbf80,0x3f80a554,0x80003f80,0xbf6dbec4,0x3f35bf35,0x3ec43f6d
.long 0x80003f80,0xbf35bf35,0x3f80a554,0xbf353f35,0x80003f80,0xbec4bf6d,0x3f353f35,0xbf6dbec4
.long 0x80003f80,0xa50dbf80,0x80003f80,0xa50dbf80,0x80003f80,0x3ec4bf6d,0xbf353f35,0x3f6dbec4
.long 0x80003f80,0x3f35bf35,0xbf80248d,0x3f353f35,0x80003f80,0x3f6dbec4,0xbf35bf35,0xbec43f6d
.long 0x80003f80,0x3f80a554,0xa50dbf80,0xbf80248d,0x80003f80,0x3f6d3ec4,0x3f35bf35,0xbec4bf6d
.long 0x80003f80,0x3f353f35,0x3f80a554,0x3f35bf35,0x80003f80,0x3ec43f6d,0x3f353f35,0x3f6d3ec4
.long 0x80003f80,0x80003f80,0x80003f80,0x80003f80,0xbf80248d,0xbf6dbec4,0xbf35bf35,0xbec4bf6d
.long 0xa50dbf80,0x3f35bf35,0x3f80a554,0x3f353f35,0x3f80a554,0x3ec43f6d,0xbf353f35,0xbf6dbec4
.long 0x80003f80,0xbf80248d,0xa50dbf80,0x3f80a554,0xbf80248d,0x3ec4bf6d,0x3f353f35,0xbf6d3ec4
.long 0xa50dbf80,0x3f353f35,0xbf80248d,0x3f35bf35,0x3f80a554,0xbf6d3ec4,0x3f35bf35,0xbec43f6d
.long 0x80003f80,0xa50dbf80,0x80003f80,0xa50dbf80,0xbf80248d,0x3f6d3ec4,0xbf35bf35,0x3ec43f6d
.long 0xa50dbf80,0xbf353f35,0x3f80a554,0xbf35bf35,0x3f80a554,0xbec4bf6d,0xbf353f35,0x3f6d3ec4
.long 0x80003f80,0x3f80a554,0xa50dbf80,0xbf80248d,0xbf80248d,0xbec43f6d,0x3f353f35,0x3f6dbec4
.long 0xa50dbf80,0xbf35bf35,0xbf80248d,0xbf353f35,0x3f80a554,0x3f6dbec4,0x3f35bf35,0x3ec4bf6d
.long 0x80003f80,0x80003f80,0x80003f80,0x80003f80,0xa50dbf80,0x3ec4bf6d,0x3f35bf35,0x3f6dbec4
.long 0x80003f80,0xbf353f35,0xbf80248d,0xbf35bf35,0xa50dbf80,0x3f6dbec4,0x3f353f35,0xbec43f6d
.long 0x80003f80,0xbf80248d,0xa50dbf80,0x3f80a554,0xa50dbf80,0x3f6d3ec4,0xbf353f35,0xbec4bf6d
.long 0x80003f80,0xbf35bf35,0x3f80a554,0xbf353f35,0xa50dbf80,0x3ec43f6d,0xbf35bf35,0x3f6d3ec4
.long 0x80003f80,0xa50dbf80,0x80003f80,0xa50dbf80,0xa50dbf80,0xbec43f6d,0x3f35bf35,0xbf6d3ec4
.long 0x80003f80,0x3f35bf35,0xbf80248d,0x3f353f35,0xa50dbf80,0xbf6d3ec4,0x3f353f35,0x3ec4bf6d
.long 0x80003f80,0x3f80a554,0xa50dbf80,0xbf80248d,0xa50dbf80,0xbf6dbec4,0xbf353f35,0x3ec43f6d
.long 0x80003f80,0x3f353f35,0x3f80a554,0x3f35bf35,0xa50dbf80,0xbec4bf6d,0xbf35bf35,0xbf6dbec4
.long 0x80003f80,0x80003f80,0x80003f80,0x80003f80,0x3f80a554,0x3f6d3ec4,0x3f353f35,0x3ec43f6d
.long 0xa50dbf80,0x3f35bf35,0x3f80a554,0x3f353f35,0xbf80248d,0xbec4bf6d,0x3f35bf35,0x3f6d3ec4
.long 0x80003f80,0xbf80248d,0xa50dbf80,0x3f80a554,0x3f80a554,0xbec43f6d,0xbf35bf35,0x3f6dbec4
.long 0xa50dbf80,0x3f353f35,0xbf80248d,0x3f35bf35,0xbf80248d,0x3f6dbec4,0xbf353f35,0x3ec4bf6d
.long 0x80003f80,0xa50dbf80,0x80003f80,0xa50dbf80,0x3f80a554,0xbf6dbec4,0x3f353f35,0xbec4bf6d
.long 0xa50dbf80,0xbf353f35,0x3f80a554,0xbf35bf35,0xbf80248d,0x3ec43f6d,0x3f35bf35,0xbf6dbec4
.long 0x80003f80,0x3f80a554,0xa50dbf80,0xbf80248d,0x3f80a554,0x3ec4bf6d,0xbf35bf35,0xbf6d3ec4
.long 0xa50dbf80,0xbf35bf35,0xbf80248d,0xbf353f35,0xbf80248d,0xbf6d3ec4,0xbf353f35,0xbec43f6d
.long 0x3f800000,0x3f800000,0x3f800000,0x3f800000,0x3f800000,0x3f6d3ec4,0x3f353f35,0x3ec43f6d
.long 0x3f800000,0x3f353f35,0x248d3f80,0xbf353f35,0x3f800000,0x3ec43f6d,0xbf353f35,0xbf6dbec4
.long 0x3f800000,0x248d3f80,0xbf80250d,0xa554bf80,0x3f800000,0xbec43f6d,0xbf35bf35,0x3f6dbec4
.long 0x3f800000,0xbf353f35,0xa554bf80,0x3f353f35,0x3f800000,0xbf6d3ec4,0x3f35bf35,0xbec43f6d
.long 0x3f800000,0xbf80250d,0x3f800000,0xbf80250d,0x3f800000,0xbf6dbec4,0x3f353f35,0xbec4bf6d
.long 0x3f800000,0xbf35bf35,0x248d3f80,0x3f35bf35,0x3f800000,0xbec4bf6d,0xbf353f35,0x3f6d3ec4
.long 0x3f800000,0xa554bf80,0xbf80250d,0x248d3f80,0x3f800000,0x3ec4bf6d,0xbf35bf35,0xbf6d3ec4
.long 0x3f800000,0x3f35bf35,0xa554bf80,0xbf35bf35,0x3f800000,0x3f6dbec4,0x3f35bf35,0x3ec4bf6d
.long 0x3f800000,0x3f800000,0x3f800000,0x3f800000,0x248d3f80,0xbec43f6d,0xbf353f35,0xbf6d3ec4
.long 0xbf80250d,0xbf35bf35,0xa554bf80,0x3f35bf35,0xa554bf80,0x3f6dbec4,0x3f353f35,0xbec43f6d
.long 0x3f800000,0x248d3f80,0xbf80250d,0xa554bf80,0x248d3f80,0xbf6dbec4,0x3f35bf35,0x3ec43f6d
.long 0xbf80250d,0x3f35bf35,0x248d3f80,0xbf35bf35,0xa554bf80,0x3ec43f6d,0xbf35bf35,0x3f6d3ec4
.long 0x3f800000,0xbf80250d,0x3f800000,0xbf80250d,0x248d3f80,0x3ec4bf6d,0xbf353f35,0x3f6dbec4
.long 0xbf80250d,0x3f353f35,0xa554bf80,0xbf353f35,0xa554bf80,0xbf6d3ec4,0x3f353f35,0x3ec4bf6d
.long 0x3f800000,0xa554bf80,0xbf80250d,0x248d3f80,0x248d3f80,0x3f6d3ec4,0x3f35bf35,0xbec4bf6d
.long 0xbf80250d,0xbf353f35,0x248d3f80,0x3f353f35,0xa554bf80,0xbec4bf6d,0xbf35bf35,0xbf6dbec4
.long 0x3f800000,0x3f800000,0x3f800000,0x3f800000,0xbf80250d,0xbf6dbec4,0xbf35bf35,0xbec4bf6d
.long 0x3f800000,0x3f353f35,0x248d3f80,0xbf353f35,0xbf80250d,0xbec4bf6d,0x3f35bf35,0x3f6d3ec4
.long 0x3f800000,0x248d3f80,0xbf80250d,0xa554bf80,0xbf80250d,0x3ec4bf6d,0x3f353f35,0xbf6d3ec4
.long 0x3f800000,0xbf353f35,0xa554bf80,0x3f353f35,0xbf80250d,0x3f6dbec4,0xbf353f35,0x3ec4bf6d
.long 0x3f800000,0xbf80250d,0x3f800000,0xbf80250d,0xbf80250d,0x3f6d3ec4,0xbf35bf35,0x3ec43f6d
.long 0x3f800000,0xbf35bf35,0x248d3f80,0x3f35bf35,0xbf80250d,0x3ec43f6d,0x3f35bf35,0xbf6dbec4
.long 0x3f800000,0xa554bf80,0xbf80250d,0x248d3f80,0xbf80250d,0xbec43f6d,0x3f353f35,0x3f6dbec4
.long 0x3f800000,0x3f35bf35,0xa554bf80,0xbf35bf35,0xbf80250d,0xbf6d3ec4,0xbf353f35,0xbec43f6d
.long 0x3f800000,0x3f800000,0x3f800000,0x3f800000,0xa554bf80,0x3ec4bf6d,0x3f35bf35,0x3f6dbec4
.long 0xbf80250d,0xbf35bf35,0xa554bf80,0x3f35bf35,0x248d3f80,0xbf6d3ec4,0xbf35bf35,0x3ec4bf6d
.long 0x3f800000,0x248d3f80,0xbf80250d,0xa554bf80,0xa554bf80,0x3f6d3ec4,0xbf353f35,0xbec4bf6d
.long 0xbf80250d,0x3f35bf35,0x248d3f80,0xbf35bf35,0x248d3f80,0xbec4bf6d,0x3f353f35,0xbf6dbec4
.long 0x3f800000,0xbf80250d,0x3f800000,0xbf80250d,0xa554bf80,0xbec43f6d,0x3f35bf35,0xbf6d3ec4
.long 0xbf80250d,0x3f353f35,0xa554bf80,0xbf353f35,0x248d3f80,0x3f6dbec4,0xbf35bf35,0xbec43f6d
.long 0x3f800000,0xa554bf80,0xbf80250d,0x248d3f80,0xa554bf80,0xbf6dbec4,0xbf353f35,0x3ec43f6d
.long 0xbf80250d,0xbf353f35,0x248d3f80,0x3f353f35,0x248d3f80,0x3ec43f6d,0x3f353f35,0x3f6d3ec4
.long 0x3f800000,0x3f800000,0x40000000,0x80000000,0x3f800000,0xbf800000,0x3fb504f3,0xbfb504f3
.long 0x3f800000,0x3f800000,0,0xc0000000,0x3f800000,0xbf800000,0xbfb504f3,0xbfb504f3
.long 0,0,0,0,0,0,0,0
.long 0,0,0,0,0,0,0,0
.long 0,0,0,0,0,0,0,0
.long 0,0,0,0,0,0,0,0
.long 0,0,0,0,0,0,0,0
.long 0,0,0,0,0,0,0,0
.long 0,0,0,0,0,0,0,0
.long 0,0,0,0,0,0,0,0
.long 0x3f800000,0x3f800000,0x40000000,0x80000000,0x3f800000,0xbf800000,0x3fb504f3,0xbfb504f3
.long 0x3f800000,0x3f800000,0,0xc0000000,0x3f800000,0xbf800000,0xbfb504f3,0xbfb504f3
.long 0,0,0,0,0,0,0,0
.long 0,0,0,0,0,0,0,0
.long 0,0,0,0,0,0,0,0
.long 0,0,0,0,0,0,0,0
.long 0,0,0,0,0,0,0,0
.long 0,0,0,0,0,0,0,0
.long 0,0,0,0,0,0,0,0
.long 0,0,0,0,0,0,0,0
.long 0x3f800000,0x3f800000,0x40000000,0x80000000,0x3f800000,0xbf800000,0x3fb504f3,0xbfb504f3
.long 0x3f800000,0x3f800000,0,0xc0000000,0x3f800000,0xbf800000,0xbfb504f3,0xbfb504f3
.long 0,0,0,0,0,0,0,0
.long 0,0,0,0,0,0,0,0
.long 0,0,0,0,0,0,0,0
.long 0,0,0,0,0,0,0,0
.long 0,0,0,0,0,0,0,0
.long 0,0,0,0,0,0,0,0
.long 0,0,0,0,0,0,0,0
.long 0,0,0,0,0,0,0,0
.long 0x3f800000,0x3f800000,0x40000000,0x80000000,0x3f800000,0xbf800000,0x3fb504f3,0xbfb504f3
.long 0x3f800000,0x3f800000,0,0xc0000000,0x3f800000,0xbf800000,0xbfb504f3,0xbfb504f3
.long 0x40000000,0x80000000,0x40000000,0x80000000,0,0xc0000000,0xbfb504f3,0xbfb504f3
.long 0xc0000000,0x80000000,0x80000000,0x40000000,0x80000000,0x40000000,0x3fb504f3,0xbfb504f3
.long 0,0,0,0,0,0,0,0
.long 0,0,0,0,0,0,0,0
.long 0,0,0,0,0,0,0,0
.long 0,0,0,0,0,0,0,0
.long 0,0,0,0,0,0,0,0
.long 0,0,0,0,0,0,0,0
.long 0,0,0,0,0,0,0,0
.long 0,0,0,0,0,0,0,0
.long 0x40000000,0x80000000,0x40000000,0x80000000,0,0xc0000000,0xbfb504f3,0xbfb504f3
.long 0xc0000000,0x80000000,0x80000000,0x40000000,0x80000000,0x40000000,0x3fb504f3,0xbfb504f3
.long 0,0,0,0,0,0,0,0
.long 0,0,0,0,0,0,0,0
.long 0,0,0,0,0,0,0,0
.long 0,0,0,0,0,0,0,0
.long 0,0,0,0,0,0,0,0
.long 0,0,0,0,0,0,0,0
.long 0,0,0,0,0,0,0,0
.long 0,0,0,0,0,0,0,0
.long 0x40000000,0x80000000,0x40000000,0x80000000,0,0xc0000000,0xbfb504f3,0xbfb504f3
.long 0xc0000000,0x80000000,0x80000000,0x40000000,0x80000000,0x40000000,0x3fb504f3,0xbfb504f3
.long 0,0,0,0,0,0,0,0
.long 0,0,0,0,0,0,0,0
.long 0,0,0,0,0,0,0,0
.long 0,0,0,0,0,0,0,0
.long 0,0,0,0,0,0,0,0
.long 0,0,0,0,0,0,0,0
.long 0,0,0,0,0,0,0,0
.long 0,0,0,0,0,0,0,0
.long 0x40000000,0x80000000,0x40000000,0x80000000,0,0xc0000000,0xbfb504f3,0xbfb504f3
.long 0xc0000000,0x80000000,0x80000000,0x40000000,0x80000000,0x40000000,0x3fb504f3,0xbfb504f3
.long 0x3f80,0x3e163f7d,0x3e953f75,0x3edb3f67,0x3f80,0x3f043f5c,0x3f623ef1,0x3f80bd49
.long 0x3f80,0x3f4e3f18,0x3f75be95,0x3eacbf71,0x3f80,0x3f783e79,0x3ef1bf62,0xbf3ebf2c
.long 0x3f80,0x3f7dbe16,0xbe95bf75,0xbf673edb,0x3f80,0x3f5cbf04,0xbf62bef1,0x3d493f80
.long 0x3f80,0x3f18bf4e,0xbf753e95,0x3f713eac,0x3f80,0x3e79bf78,0xbef13f62,0x3f2cbf3e
.long 0x3f80,0xbe16bf7d,0x3e953f75,0xbedbbf67,0x3f80,0xbf04bf5c,0x3f623ef1,0xbf803d49
.long 0x3f80,0xbf4ebf18,0x3f75be95,0xbeac3f71,0x3f80,0xbf78be79,0x3ef1bf62,0x3f3e3f2c
.long 0x3f80,0xbf7d3e16,0xbe95bf75,0x3f67bedb,0x3f80,0xbf5c3f04,0xbf62bef1,0xbd49bf80
.long 0x3f80,0xbf183f4e,0xbf753e95,0xbf71beac,0x3f80,0xbe793f78,0xbef13f62,0xbf2c3f3e
.long 0x3f0e3f55,0x3f2c3f3e,0x3f463f22,0x3f5c3f04,0x3f55bf0e,0x3edbbf67,0xbdc9bf7f,0xbf18bf4e
.long 0xbf0ebf55,0xbf80bd49,0xbf223f46,0x3e793f78,0xbf553f0e,0x3eac3f71,0x3f7fbdc9,0x3e16bf7d
.long 0x3f0e3f55,0x3f3ebf2c,0xbf46bf22,0xbf043f5c,0x3f55bf0e,0xbf67bedb,0x3dc93f7f,0x3f4ebf18
.long 0xbf0ebf55,0xbd493f80,0x3f22bf46,0xbf783e79,0xbf553f0e,0x3f71beac,0xbf7f3dc9,0x3f7d3e16
.long 0x3f0e3f55,0xbf2cbf3e,0x3f463f22,0xbf5cbf04,0x3f55bf0e,0xbedb3f67,0xbdc9bf7f,0x3f183f4e
.long 0xbf0ebf55,0x3f803d49,0xbf223f46,0xbe79bf78,0xbf553f0e,0xbeacbf71,0x3f7fbdc9,0xbe163f7d
.long 0x3f0e3f55,0xbf3e3f2c,0xbf46bf22,0x3f04bf5c,0x3f55bf0e,0x3f673edb,0x3dc93f7f,0xbf4e3f18
.long 0xbf0ebf55,0x3d49bf80,0x3f22bf46,0x3f78be79,0xbf553f0e,0xbf713eac,0xbf7f3dc9,0xbf7dbe16
.long 0x3f6d3ec4,0x3f783e79,0x3f7f3dc9,0x3f80bd49,0xbf6dbec4,0xbf7d3e16,0xbf463f22,0xbeac3f71
.long 0x3f6d3ec4,0x3f5cbf04,0x3dc9bf7f,0xbf3ebf2c,0xbf6dbec4,0xbf183f4e,0x3f223f46,0x3f67bedb
.long 0x3f6d3ec4,0x3e79bf78,0xbf7fbdc9,0x3d493f80,0xbf6dbec4,0x3e163f7d,0x3f46bf22,0xbf71beac
.long 0x3f6d3ec4,0xbf04bf5c,0xbdc93f7f,0x3f2cbf3e,0xbf6dbec4,0x3f4e3f18,0xbf22bf46,0x3edb3f67
.long 0x3f6d3ec4,0xbf78be79,0x3f7f3dc9,0xbf803d49,0xbf6dbec4,0x3f7dbe16,0xbf463f22,0x3eacbf71
.long 0x3f6d3ec4,0xbf5c3f04,0x3dc9bf7f,0x3f3e3f2c,0xbf6dbec4,0x3f18bf4e,0x3f223f46,0xbf673edb
.long 0x3f6d3ec4,0xbe793f78,0xbf7fbdc9,0xbd49bf80,0xbf6dbec4,0xbe16bf7d,0x3f46bf22,0x3f713eac
.long 0x3f6d3ec4,0x3f043f5c,0xbdc93f7f,0xbf2c3f3e,0xbf6dbec4,0xbf4ebf18,0xbf22bf46,0xbedbbf67
.long 0x3f7bbe48,0x3f71beac,0x3f62bef1,0x3f4ebf18,0x3e483f7b,0x3f2c3f3e,0x3f753e95,0x3f78be79
.long 0xbf7b3e48,0xbedb3f67,0x3ef13f62,0x3f7d3e16,0xbe48bf7b,0xbf80bd49,0xbe953f75,0x3f5c3f04
.long 0x3f7bbe48,0xbeacbf71,0xbf623ef1,0x3f183f4e,0x3e483f7b,0x3f3ebf2c,0xbf75be95,0x3e793f78
.long 0xbf7b3e48,0x3f673edb,0xbef1bf62,0xbe163f7d,0xbe48bf7b,0xbd493f80,0x3e95bf75,0xbf043f5c
.long 0x3f7bbe48,0xbf713eac,0x3f62bef1,0xbf4e3f18,0x3e483f7b,0xbf2cbf3e,0x3f753e95,0xbf783e79
.long 0xbf7b3e48,0x3edbbf67,0x3ef13f62,0xbf7dbe16,0xbe48bf7b,0x3f803d49,0xbe953f75,0xbf5cbf04
.long 0x3f7bbe48,0x3eac3f71,0xbf623ef1,0xbf18bf4e,0x3e483f7b,0xbf3e3f2c,0xbf75be95,0xbe79bf78
.long 0xbf7b3e48,0xbf67bedb,0xbef1bf62,0x3e16bf7d,0xbe48bf7b,0x3d49bf80,0x3e95bf75,0x3f04bf5c
.long 0x3f808000,0x3f7dbe16,0x3f75be95,0x3f67bedb,0x3f808000,0x3f5cbf04,0x3ef1bf62,0xbd49bf80
.long 0x3f808000,0x3f18bf4e,0xbe95bf75,0xbf71beac,0x3f808000,0x3e79bf78,0xbf62bef1,0xbf2c3f3e
.long 0x3f808000,0xbe16bf7d,0xbf753e95,0x3edb3f67,0x3f808000,0xbf04bf5c,0xbef13f62,0x3f80bd49
.long 0x3f808000,0xbf4ebf18,0x3e953f75,0x3eacbf71,0x3f808000,0xbf78be79,0x3f623ef1,0xbf3ebf2c
.long 0x3f808000,0xbf7d3e16,0x3f75be95,0xbf673edb,0x3f808000,0xbf5c3f04,0x3ef1bf62,0x3d493f80
.long 0x3f808000,0xbf183f4e,0xbe95bf75,0x3f713eac,0x3f808000,0xbe793f78,0xbf62bef1,0x3f2cbf3e
.long 0x3f808000,0x3e163f7d,0xbf753e95,0xbedbbf67,0x3f808000,0x3f043f5c,0xbef13f62,0xbf803d49
.long 0x3f808000,0x3f4e3f18,0x3e953f75,0xbeac3f71,0x3f808000,0x3f783e79,0x3f623ef1,0x3f3e3f2c
.long 0x3f55bf0e,0x3f3ebf2c,0x3f22bf46,0x3f04bf5c,0xbf0ebf55,0xbf67bedb,0xbf7f3dc9,0xbf4e3f18
.long 0xbf553f0e,0xbd493f80,0x3f463f22,0x3f78be79,0x3f0e3f55,0x3f71beac,0xbdc9bf7f,0xbf7dbe16
.long 0x3f55bf0e,0xbf2cbf3e,0xbf223f46,0x3f5c3f04,0xbf0ebf55,0xbedb3f67,0x3f7fbdc9,0xbf18bf4e
.long 0xbf553f0e,0x3f803d49,0xbf46bf22,0x3e793f78,0x3f0e3f55,0xbeacbf71,0x3dc93f7f,0x3e16bf7d
.long 0x3f55bf0e,0xbf3e3f2c,0x3f22bf46,0xbf043f5c,0xbf0ebf55,0x3f673edb,0xbf7f3dc9,0x3f4ebf18
.long 0xbf553f0e,0x3d49bf80,0x3f463f22,0xbf783e79,0x3f0e3f55,0xbf713eac,0xbdc9bf7f,0x3f7d3e16
.long 0x3f55bf0e,0x3f2c3f3e,0xbf223f46,0xbf5cbf04,0xbf0ebf55,0x3edbbf67,0x3f7fbdc9,0x3f183f4e
.long 0xbf553f0e,0xbf80bd49,0xbf46bf22,0xbe79bf78,0x3f0e3f55,0x3eac3f71,0x3dc93f7f,0xbe163f7d
.long 0x3ec4bf6d,0x3e79bf78,0x3dc9bf7f,0xbd49bf80,0xbec43f6d,0x3e163f7d,0x3f223f46,0x3f713eac
.long 0x3ec4bf6d,0xbf04bf5c,0xbf7fbdc9,0xbf2c3f3e,0xbec43f6d,0x3f4e3f18,0x3f46bf22,0xbedbbf67
.long 0x3ec4bf6d,0xbf78be79,0xbdc93f7f,0x3f80bd49,0xbec43f6d,0x3f7dbe16,0xbf22bf46,0xbeac3f71
.long 0x3ec4bf6d,0xbf5c3f04,0x3f7f3dc9,0xbf3ebf2c,0xbec43f6d,0x3f18bf4e,0xbf463f22,0x3f67bedb
.long 0x3ec4bf6d,0xbe793f78,0x3dc9bf7f,0x3d493f80,0xbec43f6d,0xbe16bf7d,0x3f223f46,0xbf71beac
.long 0x3ec4bf6d,0x3f043f5c,0xbf7fbdc9,0x3f2cbf3e,0xbec43f6d,0xbf4ebf18,0x3f46bf22,0x3edb3f67
.long 0x3ec4bf6d,0x3f783e79,0xbdc93f7f,0xbf803d49,0xbec43f6d,0xbf7d3e16,0xbf22bf46,0x3eacbf71
.long 0x3ec4bf6d,0x3f5cbf04,0x3f7f3dc9,0x3f3e3f2c,0xbec43f6d,0xbf183f4e,0xbf463f22,0xbf673edb
.long 0xbe48bf7b,0xbeacbf71,0xbef1bf62,0xbf18bf4e,0x3f7bbe48,0x3f3ebf2c,0x3e95bf75,0xbe79bf78
.long 0x3e483f7b,0x3f673edb,0x3f62bef1,0x3e16bf7d,0xbf7b3e48,0xbd493f80,0x3f753e95,0x3f04bf5c
.long 0xbe48bf7b,0xbf713eac,0x3ef13f62,0x3f4ebf18,0x3f7bbe48,0xbf2cbf3e,0xbe953f75,0x3f78be79
.long 0x3e483f7b,0x3edbbf67,0xbf623ef1,0x3f7d3e16,0xbf7b3e48,0x3f803d49,0xbf75be95,0x3f5c3f04
.long 0xbe48bf7b,0x3eac3f71,0xbef1bf62,0x3f183f4e,0x3f7bbe48,0xbf3e3f2c,0x3e95bf75,0x3e793f78
.long 0x3e483f7b,0xbf67bedb,0x3f62bef1,0xbe163f7d,0xbf7b3e48,0x3d49bf80,0x3f753e95,0xbf043f5c
.long 0xbe48bf7b,0x3f71beac,0x3ef13f62,0xbf4e3f18,0x3f7bbe48,0x3f2c3f3e,0xbe953f75,0xbf783e79
.long 0x3e483f7b,0xbedb3f67,0xbf623ef1,0xbf7dbe16,0xbf7b3e48,0xbf80bd49,0xbf75be95,0xbf5cbf04
.long 0x80003f80,0x80003f80,0x80003f80,0x80003f80,0xbe163f7d,0xbf043f5c,0xbf4e3f18,0xbf783e79
.long 0xbe953f75,0xbf623ef1,0xbf75be95,0xbef1bf62,0xbedb3f67,0xbf80bd49,0xbeacbf71,0x3f3ebf2c
.long 0xbf0e3f55,0xbf55bf0e,0x3f0ebf55,0x3f553f0e,0xbf2c3f3e,0xbedbbf67,0x3f80bd49,0xbeac3f71
.long 0xbf463f22,0x3dc9bf7f,0x3f223f46,0xbf7fbdc9,0xbf5c3f04,0x3f18bf4e,0xbe793f78,0xbe16bf7d
.long 0xbf6d3ec4,0x3f6dbec4,0xbf6d3ec4,0x3f6dbec4,0xbf783e79,0x3f7d3e16,0xbf5cbf04,0x3f183f4e
.long 0xbf7f3dc9,0x3f463f22,0xbdc9bf7f,0xbf223f46,0xbf80bd49,0x3eac3f71,0x3f3ebf2c,0xbf67bedb
.long 0xbf7bbe48,0xbe483f7b,0x3f7b3e48,0x3e48bf7b,0xbf71beac,0xbf2c3f3e,0x3edb3f67,0x3f80bd49
.long 0xbf62bef1,0xbf753e95,0xbef13f62,0x3e953f75,0xbf4ebf18,0xbf78be79,0xbf7d3e16,0xbf5c3f04
.long 0x80003f80,0x80003f80,0x80003f80,0x80003f80,0xbf7dbe16,0xbf5cbf04,0xbf18bf4e,0xbe79bf78
.long 0x3e95bf75,0x3f62bef1,0x3f753e95,0x3ef13f62,0x3f673edb,0xbd493f80,0xbf713eac,0xbf2cbf3e
.long 0xbf0e3f55,0xbf55bf0e,0x3f0ebf55,0x3f553f0e,0xbf3ebf2c,0x3f67bedb,0x3d493f80,0xbf71beac
.long 0x3f46bf22,0xbdc93f7f,0xbf22bf46,0x3f7f3dc9,0x3f043f5c,0xbf4ebf18,0x3f783e79,0xbf7d3e16
.long 0xbf6d3ec4,0x3f6dbec4,0xbf6d3ec4,0x3f6dbec4,0xbe79bf78,0xbe163f7d,0x3f04bf5c,0xbf4e3f18
.long 0x3f7fbdc9,0xbf46bf22,0x3dc93f7f,0x3f22bf46,0xbd493f80,0x3f71beac,0xbf2cbf3e,0xbedb3f67
.long 0xbf7bbe48,0xbe483f7b,0x3f7b3e48,0x3e48bf7b,0x3eacbf71,0xbf3ebf2c,0xbf673edb,0x3d493f80
.long 0x3f623ef1,0x3f75be95,0x3ef1bf62,0xbe95bf75,0xbf183f4e,0xbe793f78,0x3e163f7d,0x3f043f5c
.long 0x80003f80,0x80003f80,0x80003f80,0x80003f80,0x3e16bf7d,0x3f04bf5c,0x3f4ebf18,0x3f78be79
.long 0xbe953f75,0xbf623ef1,0xbf75be95,0xbef1bf62,0x3edbbf67,0x3f803d49,0x3eac3f71,0xbf3e3f2c
.long 0xbf0e3f55,0xbf55bf0e,0x3f0ebf55,0x3f553f0e,0x3f2cbf3e,0x3edb3f67,0xbf803d49,0x3eacbf71
.long 0xbf463f22,0x3dc9bf7f,0x3f223f46,0xbf7fbdc9,0x3f5cbf04,0xbf183f4e,0x3e79bf78,0x3e163f7d
.long 0xbf6d3ec4,0x3f6dbec4,0xbf6d3ec4,0x3f6dbec4,0x3f78be79,0xbf7dbe16,0x3f5c3f04,0xbf18bf4e
.long 0xbf7f3dc9,0x3f463f22,0xbdc9bf7f,0xbf223f46,0x3f803d49,0xbeacbf71,0xbf3e3f2c,0x3f673edb
.long 0xbf7bbe48,0xbe483f7b,0x3f7b3e48,0x3e48bf7b,0x3f713eac,0x3f2cbf3e,0xbedbbf67,0xbf803d49
.long 0xbf62bef1,0xbf753e95,0xbef13f62,0x3e953f75,0x3f4e3f18,0x3f783e79,0x3f7dbe16,0x3f5cbf04
.long 0x80003f80,0x80003f80,0x80003f80,0x80003f80,0x3f7d3e16,0x3f5c3f04,0x3f183f4e,0x3e793f78
.long 0x3e95bf75,0x3f62bef1,0x3f753e95,0x3ef13f62,0xbf67bedb,0x3d49bf80,0x3f71beac,0x3f2c3f3e
.long 0xbf0e3f55,0xbf55bf0e,0x3f0ebf55,0x3f553f0e,0x3f3e3f2c,0xbf673edb,0xbd49bf80,0x3f713eac
.long 0x3f46bf22,0xbdc93f7f,0xbf22bf46,0x3f7f3dc9,0xbf04bf5c,0x3f4e3f18,0xbf78be79,0x3f7dbe16
.long 0xbf6d3ec4,0x3f6dbec4,0xbf6d3ec4,0x3f6dbec4,0x3e793f78,0x3e16bf7d,0xbf043f5c,0x3f4ebf18
.long 0x3f7fbdc9,0xbf46bf22,0x3dc93f7f,0x3f22bf46,0x3d49bf80,0xbf713eac,0x3f2c3f3e,0x3edbbf67
.long 0xbf7bbe48,0xbe483f7b,0x3f7b3e48,0x3e48bf7b,0xbeac3f71,0x3f3e3f2c,0x3f67bedb,0xbd49bf80
.long 0x3f623ef1,0x3f75be95,0x3ef1bf62,0xbe95bf75,0x3f18bf4e,0x3e79bf78,0xbe16bf7d,0xbf04bf5c
.long 0x3f800000,0x3f800000,0x3f800000,0x3f800000,0x3f7d3e16,0x3f5c3f04,0x3f183f4e,0x3e793f78
.long 0x3f753e95,0x3ef13f62,0xbe953f75,0xbf623ef1,0x3f673edb,0xbd493f80,0xbf713eac,0xbf2cbf3e
.long 0x3f553f0e,0xbf0e3f55,0xbf55bf0e,0x3f0ebf55,0x3f3e3f2c,0xbf673edb,0xbd49bf80,0x3f713eac
.long 0x3f223f46,0xbf7fbdc9,0x3f46bf22,0xbdc93f7f,0x3f043f5c,0xbf4ebf18,0x3f783e79,0xbf7d3e16
.long 0x3ec43f6d,0xbec4bf6d,0x3ec43f6d,0xbec4bf6d,0x3e793f78,0x3e16bf7d,0xbf043f5c,0x3f4ebf18
.long 0x3dc93f7f,0x3f22bf46,0xbf7f3dc9,0x3f463f22,0xbd493f80,0x3f71beac,0xbf2cbf3e,0xbedb3f67
.long 0xbe483f7b,0x3f7b3e48,0x3e48bf7b,0xbf7bbe48,0xbeac3f71,0x3f3e3f2c,0x3f67bedb,0xbd49bf80
.long 0xbef13f62,0x3e953f75,0x3f623ef1,0x3f75be95,0xbf183f4e,0xbe793f78,0x3e163f7d,0x3f043f5c
.long 0x3f800000,0x3f800000,0x3f800000,0x3f800000,0xbe163f7d,0xbf043f5c,0xbf4e3f18,0xbf783e79
.long 0xbf75be95,0xbef1bf62,0x3e95bf75,0x3f62bef1,0x3edbbf67,0x3f803d49,0x3eac3f71,0xbf3e3f2c
.long 0x3f553f0e,0xbf0e3f55,0xbf55bf0e,0x3f0ebf55,0xbf2c3f3e,0xbedbbf67,0x3f80bd49,0xbeac3f71
.long 0xbf22bf46,0x3f7f3dc9,0xbf463f22,0x3dc9bf7f,0x3f5cbf04,0xbf183f4e,0x3e79bf78,0x3e163f7d
.long 0x3ec43f6d,0xbec4bf6d,0x3ec43f6d,0xbec4bf6d,0xbf783e79,0x3f7d3e16,0xbf5cbf04,0x3f183f4e
.long 0xbdc9bf7f,0xbf223f46,0x3f7fbdc9,0xbf46bf22,0x3f803d49,0xbeacbf71,0xbf3e3f2c,0x3f673edb
.long 0xbe483f7b,0x3f7b3e48,0x3e48bf7b,0xbf7bbe48,0xbf71beac,0xbf2c3f3e,0x3edb3f67,0x3f80bd49
.long 0x3ef1bf62,0xbe95bf75,0xbf62bef1,0xbf753e95,0x3f4e3f18,0x3f783e79,0x3f7dbe16,0x3f5cbf04
.long 0x3f800000,0x3f800000,0x3f800000,0x3f800000,0xbf7dbe16,0xbf5cbf04,0xbf18bf4e,0xbe79bf78
.long 0x3f753e95,0x3ef13f62,0xbe953f75,0xbf623ef1,0xbf67bedb,0x3d49bf80,0x3f71beac,0x3f2c3f3e
.long 0x3f553f0e,0xbf0e3f55,0xbf55bf0e,0x3f0ebf55,0xbf3ebf2c,0x3f67bedb,0x3d493f80,0xbf71beac
.long 0x3f223f46,0xbf7fbdc9,0x3f46bf22,0xbdc93f7f,0xbf04bf5c,0x3f4e3f18,0xbf78be79,0x3f7dbe16
.long 0x3ec43f6d,0xbec4bf6d,0x3ec43f6d,0xbec4bf6d,0xbe79bf78,0xbe163f7d,0x3f04bf5c,0xbf4e3f18
.long 0x3dc93f7f,0x3f22bf46,0xbf7f3dc9,0x3f463f22,0x3d49bf80,0xbf713eac,0x3f2c3f3e,0x3edbbf67
.long 0xbe483f7b,0x3f7b3e48,0x3e48bf7b,0xbf7bbe48,0x3eacbf71,0xbf3ebf2c,0xbf673edb,0x3d493f80
.long 0xbef13f62,0x3e953f75,0x3f623ef1,0x3f75be95,0x3f18bf4e,0x3e79bf78,0xbe16bf7d,0xbf04bf5c
.long 0x3f800000,0x3f800000,0x3f800000,0x3f800000,0x3e16bf7d,0x3f04bf5c,0x3f4ebf18,0x3f78be79
.long 0xbf75be95,0xbef1bf62,0x3e95bf75,0x3f62bef1,0xbedb3f67,0xbf80bd49,0xbeacbf71,0x3f3ebf2c
.long 0x3f553f0e,0xbf0e3f55,0xbf55bf0e,0x3f0ebf55,0x3f2cbf3e,0x3edb3f67,0xbf803d49,0x3eacbf71
.long 0xbf22bf46,0x3f7f3dc9,0xbf463f22,0x3dc9bf7f,0xbf5c3f04,0x3f18bf4e,0xbe793f78,0xbe16bf7d
.long 0x3ec43f6d,0xbec4bf6d,0x3ec43f6d,0xbec4bf6d,0x3f78be79,0xbf7dbe16,0x3f5c3f04,0xbf18bf4e
.long 0xbdc9bf7f,0xbf223f46,0x3f7fbdc9,0xbf46bf22,0xbf80bd49,0x3eac3f71,0x3f3ebf2c,0xbf67bedb
.long 0xbe483f7b,0x3f7b3e48,0x3e48bf7b,0xbf7bbe48,0x3f713eac,0x3f2cbf3e,0xbedbbf67,0xbf803d49
.long 0x3ef1bf62,0xbe95bf75,0xbf62bef1,0xbf753e95,0xbf4ebf18,0xbf78be79,0xbf7d3e16,0xbf5c3f04
.long 0x3f800000,0x3f7ffd39,0x3f7ff4e6,0x3f7fe705,0x3f800000,0x3f7fdaaf,0x3f7f6ac7,0x3f7eb069
.long 0x3f800000,0x3f7f90b1,0x3f7e4323,0x3f7c187a,0x3f800000,0x3f7f1f49,0x3f7c7eb0,0x3f7822d1
.long 0x3f800000,0x3f7e868b,0x3f7a1e84,0x3f72d4eb,0x3f800000,0x3f7dc68c,0x3f772417,0x3f6c3624
.long 0x3f800000,0x3f7cdf6c,0x3f73913f,0x3f644fac,0x3f800000,0x3f7bd14d,0x3f6f6830,0x3f5b2c79
.long 0x3f800000,0x3f7a9c59,0x3f6aab7b,0x3f50d937,0x3f800000,0x3f7940c0,0x3f655e0b,0x3f456439
.long 0x3f800000,0x3f77beb7,0x3f5f8327,0x3f38dd65,0x3f800000,0x3f76167a,0x3f591e6a,0x3f2b561b
.long 0x3f800000,0x3f74484b,0x3f5233c6,0x3f1ce11f,0x3f800000,0x3f725470,0x3f4ac77f,0x3f0d9281
.long 0x3f800000,0x3f703b37,0x3f42de29,0x3efafef7,0x3f800000,0x3f6dfcf2,0x3f3a7ca4,0x3ed97cb9
.long 0x3f7fd397,0x3f7fba9e,0x3f7f9c18,0x3f7f7808,0x3f7dabcc,0x3f7c5d3a,0x3f7ac516,0x3f78e3d6
.long 0x3f791298,0x3f75341d,0x3f708066,0x3f6afb8c,0x3f721352,0x3f6a5ad9,0x3f6106f2,0x3f5627fe
.long 0x3f68bf3c,0x3f5bfb34,0x3f4cae79,0x3f3b0629,0x3f5d2d53,0x3f4a4c87,0x3f33e7bc,0x3f1a6293
.long 0x3f4f7a1f,0x3f3592e7,0x3f173c07,0x3eea6681,0x3f3fc767,0x3f1e1e22,0x3eee9479,0x3e9920fe
.long 0x3f2e3bde,0x3f044889,0x3ea986c4,0x3e06b26e,0x3f1b02c6,0x3ed0eb2a,0x3e419b37,0xbd2351cb
.long 0x3f064b82,0x3e9620d2,0x3d2fe007,0xbe57278f,0x3ee0924f,0x3e3228d4,0xbdd53db9,0xbebf926f
.long 0x3eb263ef,0x3d55880e,0xbe7ee6e1,0xbf06f686,0x3e827dc0,0xbd9064b4,0xbec6d529,0xbf2a2a80
.long 0x3e22abb6,0xbe44b0b9,0xbf04f484,0xbf485bca,0x3d7b2b74,0xbe9f1cdf,0xbf239da9,0xbf60a6cf
.long 0x3f7f4e6d,0x3f7f1f49,0x3f7eea9d,0x3f7eb069,0x3f76ba07,0x3f74484b,0x3f718f57,0x3f6e8ff8
.long 0x3f64aa59,0x3f5d924d,0x3f55b993,0x3f4d26fd,0x3f49d112,0x3f3c17d9,0x3f2d1469,0x3f1ce11f
.long 0x3f273656,0x3f11796b,0x3ef41f07,0x3ec27b55,0x3efc5d27,0x3ebf926f,0x3e7ee6e1,0x3df475c0
.long 0x3ea09ae5,0x3e25c58c,0x3bc90f88,0xbe195be0,0x3dfab273,0xbd6ea038,0xbe72b651,0xbed0eb2a
.long 0xbd96a905,0xbe8d17c0,0xbeee9479,0xbf2302d3,0xbe888e93,0xbef58035,0xbf2ac082,0xbf51c0c2
.long 0xbee63375,0xbf28fd41,0xbf53fac3,0xbf714c7a,0xbf1d7fd1,0xbf4f0417,0xbf708066,0xbf7f5ce9
.long 0xbf41d870,0xbf6afb8c,0xbf7e9bc9,0xbf7aed37,0xbf5ebe05,0xbf7b87b2,0xbf7d7474,0xbf644fac
.long 0xbf731447,0xbf7fdaaf,0xbf6d1c1d,0xbf3d27b8,0xbf7e1324,0xbf77beb7,0xbf4e8d90,0xbf084b92
.long 0x3f7e70b0,0x3f7e2b72,0x3f7de0b1,0x3f7d906e,0x3f6b4b0c,0x3f67c187,0x3f63f473,0x3f5fe4e9
.long 0x3f43e200,0x3f39f2ac,0x3f2f61a5,0x3f24381a,0x3f0b9a6b,0x3ef2bd43,0x3ecc9b8b,0x3ea5129f
.long 0x3e8e9a22,0x3e3228d4,0x3d8a200a,0xbd2351cb,0xbc490e90,0xbe1324ca,0xbe8b9507,0xbecb2aae
.long 0xbe9aa086,0xbee4cbfe,0xbf14b039,0xbf33587a,0xbf10d3cd,0xbf34768f,0xbf5233c6,0xbf6912ae
.long 0xbf47de65,0xbf644fac,0xbf772417,0xbf7f90b1,0xbf6db293,0xbf7d1cdd,0xbf7f2f9d,0xbf73ced9
.long 0xbf7f0e58,0xbf7c5d3a,0xbf696591,0xbf476085,0xbf7a7302,0xbf62241a,0xbf385216,0xbf003a06
.long 0xbf604621,0xbf311722,0xbee363fa,0xbe1f917b,0xbf32c8c9,0xbedc53c1,0xbdee3876,0x3e57278f
.long 0xbeebcbbb,0xbe007745,0x3e667c66,0x3f0c42c9,0xbe3b6ecf,0x3e44b0b9,0x3f0a48ad,0x3f4fefa8
.long 0,0x3c16cb58,0x3c96c9b6,0x3ce22a7a,0,0x3d0a342f,0x3d8a200a,0x3dcefdb7
.long 0,0x3d6ea038,0x3dee3876,0x3e3228d4,0,0x3da973ba,0x3e28defc,0x3e7bdba4
.long 0,0x3ddb7d37,0x3e5a3997,0x3ea21887,0,0x3e06b26e,0x3e8586ce,0x3ec5625c
.long 0,0x3e1f917b,0x3e9d9e78,0x3ee79a5d,0,0x3e3857ec,0x3eb554ec,0x3f044889
.long 0,0x3e5101f1,0x3ecc9b8b,0x3f140c5f,0,0x3e698bba,0x3ee363fa,0x3f2302d3
.long 0,0x3e80f8c0,0x3ef9a02d,0x3f311722,0,0x3e8d17c0,0x3f07a136,0x3f3e35c5
.long 0,0x3e9920fe,0x3f121eb0,0x3f4a4c87,0,0x3ea5129f,0x3f1c420c,0x3f554aa4
.long 0,0x3eb0eacb,0x3f26050a,0x3f5f20db,0,0x3ebca7af,0x3f2f61a5,0x3f67c187
.long 0x3d16c32c,0x3d3c6dd5,0x3d621469,0x3d83db0a,0x3e09cf86,0x3e2bf804,0x3e4dee60,0x3e6fa8b2
.long 0x3e6c9a7f,0x3e931f35,0x3eaf713a,0x3ecb2aae,0x3ea68f12,0x3ece0bea,0x3ef41f07,0x3f0c42c9
.long 0x3ed53641,0x3f02ef9f,0x3f19c200,0x3f2ecef7,0x3f00e7e4,0x3f1ce11f,0x3f36206c,0x3f4c3578
.long 0x3f15f6d9,0x3f34768f,0x3f4e8d90,0x3f6398ac,0x3f299415,0x3f495521,0x3f628210,0x3f74484b
.long 0x3f3b8f3b,0x3f5b2c79,0x3f718f57,0x3f7dc68c,0x3f4bbbf8,0x3f69b7e4,0x3f7b61fc,0x3f7fcbe2
.long 0x3f59f26a,0x3f74bf62,0x3f7fc38f,0x3f7a4910,0x3f660f88,0x3f7c187a,0x3f7e9bc9,0x3f6d67a1
.long 0x3f6ff573,0x3f7fa6e3,0x3f77f110,0x3f5988ad,0x3f778bc5,0x3f7f5ce9,0x3f6be858,0x3f3f41fc
.long 0x3f7cbfc9,0x3f7b3bab,0x3f5ac450,0x3f1f599f,0x3f7f84ab,0x3f73530e,0x3f44e3f5,0x3ef58035
.long 0x3d96a905,0x3da973ba,0x3dbc3ac3,0x3dcefdb7,0x3e888e93,0x3e9920fe,0x3ea986c4,0x3eb9bb1e
.long 0x3ee63375,0x3f003a06,0x3f0cead0,0x3f19210f,0x3f1d7fd1,0x3f2da859,0x3f3ca003,0x3f4a4c87
.long 0x3f41d870,0x3f52a649,0x3f6106f2,0x3f6cd007,0x3f5ebe05,0x3f6d67a1,0x3f77f110,0x3f7e2b72
.long 0x3f731447,0x3f7c9f8a,0x3f7ffec4,0x3f7d1cdd,0x3f7e1324,0x3f7f90b1,0x3f78b47b,0x3f69b7e4
.long 0x3f7f4e6d,0x3f76167a,0x3f628210,0x3f456439,0x3f76ba07,0x3f60a6cf,0x3f3ebc1b,0x3f12c39a
.long 0x3f64aa59,0x3f404c5c,0x3f0f8784,0x3eab0201,0x3f49d112,0x3f16999f,0x3eaf713a,0x3d9064b4
.long 0x3f273656,0x3ecb2aae,0x3dd53db9,0xbe4ada4f,0x3efc5d27,0x3e3e853e,0xbe1008b7,0xbee79a5d
.long 0x3ea09ae5,0xbd0a342f,0xbec1071e,0xbf2c800f,0x3dfab273,0xbe80f8c0,0xbf173c07,0xbf58b3a1
.long 0x3de1bc2e,0x3df475c0,0x3e039502,0x3e0cec4a,0x3ec9b953,0x3ed97cb9,0x3ee900b7,0x3ef840c8
.long 0x3f24d225,0x3f2ff3e6,0x3f3a7ca4,0x3f446337,0x3f5695e5,0x3f61668a,0x3f6aab7b,0x3f725470
.long 0x3f75dec6,0x3f7c187a,0x3f7f6ac7,0x3f7fcbe2,0x3f7ffb11,0x3f7d57de,0x3f764d97,0x3f6afb8c
.long 0x3f740bdd,0x3f650479,0x3f5064af,0x3f36ad7f,0x3f531849,0x3f3592e7,0x3f121eb0,0x3ed3c867
.long 0x3f1ff6cb,0x3ee79a5d,0x3e8586ce,0x3d6ea038,0x3ebe1d4a,0x3e195be0,0xbda3308c,0xbe9c1faf
.long 0x3dafb680,0xbe2bf804,0xbed25a09,0xbf209393,0xbe541501,0xbeeff7fb,0xbf31a81d,0xbf5d924d
.long 0xbef6e0cb,0xbf38dd65,0xbf655e0b,0xbf7cdf6c,0xbf373a23,0xbf671599,0xbf7e4323,0xbf7a4910
.long 0xbf633c5a,0xbf7dfa38,0xbf796e4e,0xbf5627fe,0xbf7baccd,0xbf7b3bab,0xbf577026,0xbf1553b7
.long 0x354ccccd,0x354ccccd,0x354ccccd,0x354ccccd,0x354cca94,0x354caef3,0x354c73c1,0x354c1907
.long 0x354cc3eb,0x354c556c,0x354b68e9,0x3549fef3,0x354cb8d1,0x354bc054,0x3549ad2f,0x35468241
.long 0x354ca946,0x354aefd6,0x35474213,0x3541a90f,0x354c954b,0x3549e42e,0x354429b0,0x353b7be1
.long 0x354c7ce0,0x35489dab,0x354066b8,0x3534058e,0x354c6006,0x35471cab,0x353bfc70,0x352b5332
.long 0x354c3ebe,0x3545619f,0x3536eeae,0x3521740f,0x354c1907,0x35436d09,0x353141d7,0x3516797a
.long 0x354beee4,0x35413f79,0x352afadc,0x350a76bb,0x354bc054,0x353ed993,0x35241f31,0x34fb01cb
.long 0x354b8d5a,0x353c3c09,0x351cb4cd,0x34df5d78,0x354b55f5,0x3539679f,0x3514c224,0x34c23103
.long 0x354b1a27,0x35365d28,0x350c4e1d,0x34a3afa2,0x354ad9f2,0x35331d87,0x35036014,0x34840ee5
.long 0x354ccccd,0x354ccccd,0x354ccccd,0x354ccccd,0x354b9ed5,0x354b053d,0x354a4c56,0x3549743e
.long 0x3548186a,0x3545b679,0x3542da99,0x353f868d,0x354243ef,0x353cf81d,0x3536a623,0x352f56c7
.long 0x353a3296,0x3530f10f,0x3525fb4c,0x35196c52,0x352ffc2a,0x3521d6d2,0x35114253,0x34fcfd04
.long 0x3523bec8,0x350fec97,0x34f1f9a5,0x34bedd2d,0x35159e88,0x34f7041e,0x34bb8534,0x34750196
.long 0x3505c511,0x34c9e41f,0x34807bea,0x33c88ec2,0x34e8c245,0x349941f2,0x34049e0a,0xb33ee693
.long 0x34c34c06,0x344bebe7,0x31a0d93a,0xb4422b74,0x349b95de,0x33c39166,0xb3f55fcc,0xb4a72288
.long 0x346429d0,0xb220d873,0xb477673d,0xb4e7b948,0x340e8710,0xb3eb6e11,0xb4b70998,0xb5105ed9
.long 0x335d000f,0xb45f54d8,0xb4ede6c2,0xb528296b,0xb302a7d6,0xb4a2888b,0xb50f79fb,0xb53a7558
.long 0x354ccccd,0x354ccccd,0x354ccccd,0x354ccccd,0x35487d14,0x35476700,0x3546322c,0x3544dec8
.long 0x353bbc62,0x35377e6f,0x3532cf52,0x352db1ef,0x3527142c,0x351de9c7,0x3513e451,0x350911af
.long 0x350b6318,0x34f8046f,0x34d6df37,0x34b3a83f,0x34d3a742,0x34a72288,0x34703484,0x340e8710
.long 0x34879f03,0x341ae293,0x330cb338,0xb3aa97c7,0x33d783e3,0xb302a7d6,0xb42c1fa5,0xb49941f2
.long 0xb3710e6e,0xb45a7db8,0xb4b8292a,0xb4fbffb5,0xb461bf99,0xb4c46691,0xb5073101,0xb5259ce0
.long 0xb4bedd2d,0xb5089a01,0xb5299568,0xb54066b8,0xb50268a9,0xb527cd68,0xb54109fb,0xb54c4a54
.long 0xb51fe51e,0xb53e2876,0xb54c0b7a,0xb5485c01,0xb536a623,0xb54a7d7e,0xb549e42e,0xb534e9ae
.long 0xb545b679,0xb54c2618,0xb53ab7a7,0xb51374de,0xb54c73c1,0xb5430be1,0xb51f806a,0xb4cd29a4
.long 0x354ccccd,0x354ccccd,0x354ccccd,0x354ccccd,0x35436d09,0x3541dd26,0x35402f5f,0x353e63f5
.long 0x3528296b,0x35223933,0x351be4ed,0x35153084,0x34fb01cb,0x34e28401,0x34c8cbf9,0x34adfd61
.long 0x348eb659,0x3450c934,0x340222f8,0x3348ef90,0x332ad33e,0xb3670786,0xb41d5a2e,0xb47e9498
.long 0xb44bebe7,0xb49f10ee,0xb4d4ba6c,0xb502e487,0xb4d7f0d6,0xb5082200,0xb520496e,0xb533b8a6
.long 0xb51b138d,0xb532319e,0xb54276a0,0xb54b4283,0xb53bfc70,0xb549395b,0xb54caef3,0xb546322c
.long 0xb54bafd4,0xb54ac390,0xb53db017,0xb5253e0d,0xb548bdc6,0xb536a623,0xb51752fa,0xb4da1284
.long 0xb5336b4e,0xb50f0707,0xb4bca2fc,0xb415f23f,0xb50dac1c,0xb4b04301,0xb3cd8ba2,0x341d5a2e
.long 0xb4b5e995,0xb3be9392,0x34386384,0x34dd4116,0xb3ff4f2b,0x342c1fa5,0x34e06adb,0x35265953
.long 0,0,0,0,0x31f1455a,0x32dd204b,0x333ee693,0x33878fc8
.long 0x327142bd,0x335d000f,0x33be9392,0x340718ca,0x32b4eec8,0x33a597c6,0x340e8710,0x34497c83
.long 0x32f13846,0x33dc7f3e,0x343d4866,0x34853f42,0x3316be44,0x34099337,0x346b6521,0x34a4d655
.long 0x3334dd20,0x3424beb3,0x348c5a95,0x34c34c06,0x3352f811,0x343fba28,0x34a2888b,0x34e06adb
.long 0x33710e6e,0x345a7db8,0x34b8292a,0x34fbffb5,0x33878fc8,0x34750196,0x34cd29a4,0x350aed14
.long 0x33969569,0x34879f03,0x34e177b4,0x3516e669,0x33a597c6,0x349495b2,0x34f501b2,0x3521d6d2
.long 0x33b4968b,0x34a1610f,0x3503db51,0x352bab1e,0x33c39166,0x34adfd61,0x350cc31e,0x35345208
.long 0x33d28804,0x34ba66f9,0x35153084,0x353bbc62,0x33e17a10,0x34c69a3a,0x351d1c2c,0x3541dd26
.long 0,0,0,0,0x33af9760,0x33d783e3,0x33ff4f2b,0x3413798a
.long 0x342e9479,0x3455a47e,0x347c30c0,0x349110bd,0x3481ad39,0x349de84a,0x34b9484b,0x34d3a742
.long 0x34aa91ce,0x34ce3fd4,0x34eff15b,0x3507a9aa,0x34d17f65,0x34fb01cb,0x35105ed9,0x352110e7
.long 0x34f60334,0x3511b389,0x35253e0d,0x353534da,0x350bd8c6,0x35235df9,0x353613bd,0x35436d09
.long 0x351b138d,0x3532319e,0x354276a0,0x354b4283,0x35288507,0x353dec81,0x354a193c,0x354c73c1
.long 0x3534058e,0x35465a74,0x354ccbd0,0x3546f6c8,0x353d7339,0x354b55f5,0x354a7d7e,0x353af983
.long 0x3544b238,0x354cc8da,0x35433cb1,0x3528e03a,0x3549ad2f,0x354aacb2,0x353736c7,0x35114253
.long 0x354c556c,0x35450adf,0x3526b6f3,0x34e9cab3,0x354ca31b,0x353bfc70,0x35122466,0x34a96d1f
.long 0,0,0,0,0x342734c1,0x343ad62f,0x344e5acd,0x3461bf99
.long 0x34a3afa2,0x34b5e995,0x34c7b357,0x34d901f0,0x34ece099,0x350268a9,0x350dac1c,0x35182b04
.long 0x35160c2f,0x3522fcc6,0x352e5b88,0x35380c6c,0x352f56c7,0x353af983,0x3543cc4e,0x3549ad2f
.long 0x35413f79,0x35491b30,0x354c9c72,0x354bafd4,0x354b053d,0x354ca31b,0x35483a73,0x353dec81
.long 0x354c3ebe,0x3545619f,0x3536eeae,0x3521740f,0x3544dec8,0x3533b8a6,0x3519d6b0,0x34f0f5cb
.long 0x353534da,0x3518967c,0x34e5a5a1,0x348c5a95,0x351de9c7,0x34ead291,0x3488ce67,0x33670786
.long 0x34fff144,0x3498176e,0x338c9200,0xb429aa67,0x34b9484b,0x33f55fcc,0xb4099337,0xb4bff996
.long 0x3455a47e,0xb3828d3d,0xb4a84807,0xb50e2017,0x333ee693,0xb479cc4b,0xb500760f,0xb53141d7
.long 0,0,0,0,0x34750196,0x34840ee5,0x348d88a2,0x3496ec8c
.long 0x34e9cab3,0x34fa0347,0x3504d0d5,0x350c4e1d,0x3521d6d2,0x352aa21d,0x353280af,0x3539679f
.long 0x353ff78f,0x3546096a,0x354a3307,0x354c6a23,0x354c8582,0x354c4a54,0x3548fc89,0x3542a8d8
.long 0x35465a74,0x353cb9e0,0x352f0373,0x351d832a,0x352e06f1,0x35190197,0x34fef5cc,0x34c46691
.long 0x3505c511,0x34c9e41f,0x34807bea,0x33c88ec2,0x34a2888b,0x34186a98,0xb2dd204b,0xb44e5acd
.long 0x33aa97c7,0xb3e67457,0xb49a6c18,0xb4f1f9a5,0xb422483f,0xb4b9484b,0xb50a000c,0xb52d5c81
.long 0xb4c580a2,0xb51294e9,0xb535c9e1,0xb549570a,0xb513e451,0xb538de14,0xb54b2e94,0xb548fc89
.long 0xb5377e6f,0xb54b68e9,0xb5478b72,0xb52c59b8,0xb54a4c56,0xb5483a73,0xb52b5332,0xb4eeec58
.long 0x3f80,0x3f80,0x3f80,0x3f80,0x3f80,0x3ec43f6d,0x3f353f35,0x3f6d3ec4
.long 0x3f80,0x3f353f35,0x3f80248d,0x3f35bf35,0x3f80,0x3f6d3ec4,0x3f35bf35,0xbec4bf6d
.long 0x3f80,0x3f80248d,0x250dbf80,0xbf80a554,0x3f80,0x3f6dbec4,0xbf35bf35,0xbec43f6d
.long 0x3f80,0x3f35bf35,0xbf80a554,0x3f353f35,0x3f80,0x3ec4bf6d,0xbf353f35,0x3f6dbec4
.long 0x3f80,0x250dbf80,0x3f80,0x250dbf80,0x3f80,0xbec4bf6d,0x3f353f35,0xbf6dbec4
.long 0x3f80,0xbf35bf35,0x3f80248d,0xbf353f35,0x3f80,0xbf6dbec4,0x3f35bf35,0x3ec43f6d
.long 0x3f80,0xbf80a554,0x250dbf80,0x3f80248d,0x3f80,0xbf6d3ec4,0xbf35bf35,0x3ec4bf6d
.long 0x3f80,0xbf353f35,0xbf80a554,0xbf35bf35,0x3f80,0xbec43f6d,0xbf353f35,0xbf6d3ec4
.long 0x3f80,0x3f80,0x3f80,0x3f80,0x3f80248d,0x3f6dbec4,0x3f35bf35,0x3ec4bf6d
.long 0x250dbf80,0xbf35bf35,0xbf80a554,0xbf353f35,0xbf80a554,0xbec43f6d,0x3f353f35,0x3f6dbec4
.long 0x3f80,0x3f80248d,0x250dbf80,0xbf80a554,0x3f80248d,0xbec4bf6d,0xbf353f35,0x3f6d3ec4
.long 0x250dbf80,0xbf353f35,0x3f80248d,0xbf35bf35,0xbf80a554,0x3f6d3ec4,0xbf35bf35,0x3ec43f6d
.long 0x3f80,0x250dbf80,0x3f80,0x250dbf80,0x3f80248d,0xbf6d3ec4,0x3f35bf35,0xbec43f6d
.long 0x250dbf80,0x3f353f35,0xbf80a554,0x3f35bf35,0xbf80a554,0x3ec4bf6d,0x3f353f35,0xbf6d3ec4
.long 0x3f80,0xbf80a554,0x250dbf80,0x3f80248d,0x3f80248d,0x3ec43f6d,0xbf353f35,0xbf6dbec4
.long 0x250dbf80,0x3f35bf35,0x3f80248d,0x3f353f35,0xbf80a554,0xbf6dbec4,0xbf35bf35,0xbec4bf6d
.long 0x3f80,0x3f80,0x3f80,0x3f80,0x250dbf80,0xbec4bf6d,0xbf35bf35,0xbf6dbec4
.long 0x3f80,0x3f353f35,0x3f80248d,0x3f35bf35,0x250dbf80,0xbf6dbec4,0xbf353f35,0x3ec43f6d
.long 0x3f80,0x3f80248d,0x250dbf80,0xbf80a554,0x250dbf80,0xbf6d3ec4,0x3f353f35,0x3ec4bf6d
.long 0x3f80,0x3f35bf35,0xbf80a554,0x3f353f35,0x250dbf80,0xbec43f6d,0x3f35bf35,0xbf6d3ec4
.long 0x3f80,0x250dbf80,0x3f80,0x250dbf80,0x250dbf80,0x3ec43f6d,0xbf35bf35,0x3f6d3ec4
.long 0x3f80,0xbf35bf35,0x3f80248d,0xbf353f35,0x250dbf80,0x3f6d3ec4,0xbf353f35,0xbec4bf6d
.long 0x3f80,0xbf80a554,0x250dbf80,0x3f80248d,0x250dbf80,0x3f6dbec4,0x3f353f35,0xbec43f6d
.long 0x3f80,0xbf353f35,0xbf80a554,0xbf35bf35,0x250dbf80,0x3ec4bf6d,0x3f35bf35,0x3f6dbec4
.long 0x3f80,0x3f80,0x3f80,0x3f80,0xbf80a554,0xbf6d3ec4,0xbf353f35,0xbec43f6d
.long 0x250dbf80,0xbf35bf35,0xbf80a554,0xbf353f35,0x3f80248d,0x3ec4bf6d,0xbf35bf35,0xbf6d3ec4
.long 0x3f80,0x3f80248d,0x250dbf80,0xbf80a554,0xbf80a554,0x3ec43f6d,0x3f35bf35,0xbf6dbec4
.long 0x250dbf80,0xbf353f35,0x3f80248d,0xbf35bf35,0x3f80248d,0xbf6dbec4,0x3f353f35,0xbec4bf6d
.long 0x3f80,0x250dbf80,0x3f80,0x250dbf80,0xbf80a554,0x3f6dbec4,0xbf353f35,0x3ec4bf6d
.long 0x250dbf80,0x3f353f35,0xbf80a554,0x3f35bf35,0x3f80248d,0xbec43f6d,0xbf35bf35,0x3f6dbec4
.long 0x3f80,0xbf80a554,0x250dbf80,0x3f80248d,0xbf80a554,0xbec4bf6d,0x3f35bf35,0x3f6d3ec4
.long 0x250dbf80,0x3f35bf35,0x3f80248d,0x3f353f35,0x3f80248d,0x3f6d3ec4,0x3f353f35,0x3ec43f6d
.long 0x3f808000,0x3f808000,0x3f808000,0x3f808000,0x3f808000,0x3f6dbec4,0x3f35bf35,0x3ec4bf6d
.long 0x3f808000,0x3f35bf35,0x248dbf80,0xbf35bf35,0x3f808000,0x3ec4bf6d,0xbf35bf35,0xbf6d3ec4
.long 0x3f808000,0x248dbf80,0xbf80a50d,0xa5543f80,0x3f808000,0xbec4bf6d,0xbf353f35,0x3f6d3ec4
.long 0x3f808000,0xbf35bf35,0xa5543f80,0x3f35bf35,0x3f808000,0xbf6dbec4,0x3f353f35,0xbec4bf6d
.long 0x3f808000,0xbf80a50d,0x3f808000,0xbf80a50d,0x3f808000,0xbf6d3ec4,0x3f35bf35,0xbec43f6d
.long 0x3f808000,0xbf353f35,0x248dbf80,0x3f353f35,0x3f808000,0xbec43f6d,0xbf35bf35,0x3f6dbec4
.long 0x3f808000,0xa5543f80,0xbf80a50d,0x248dbf80,0x3f808000,0x3ec43f6d,0xbf353f35,0xbf6dbec4
.long 0x3f808000,0x3f353f35,0xa5543f80,0xbf353f35,0x3f808000,0x3f6d3ec4,0x3f353f35,0x3ec43f6d
.long 0x3f808000,0x3f808000,0x3f808000,0x3f808000,0x248dbf80,0xbec4bf6d,0xbf35bf35,0xbf6dbec4
.long 0xbf80a50d,0xbf353f35,0xa5543f80,0x3f353f35,0xa5543f80,0x3f6d3ec4,0x3f35bf35,0xbec4bf6d
.long 0x3f808000,0x248dbf80,0xbf80a50d,0xa5543f80,0x248dbf80,0xbf6d3ec4,0x3f353f35,0x3ec4bf6d
.long 0xbf80a50d,0x3f353f35,0x248dbf80,0xbf353f35,0xa5543f80,0x3ec4bf6d,0xbf353f35,0x3f6dbec4
.long 0x3f808000,0xbf80a50d,0x3f808000,0xbf80a50d,0x248dbf80,0x3ec43f6d,0xbf35bf35,0x3f6d3ec4
.long 0xbf80a50d,0x3f35bf35,0xa5543f80,0xbf35bf35,0xa5543f80,0xbf6dbec4,0x3f35bf35,0x3ec43f6d
.long 0x3f808000,0xa5543f80,0xbf80a50d,0x248dbf80,0x248dbf80,0x3f6dbec4,0x3f353f35,0xbec43f6d
.long 0xbf80a50d,0xbf35bf35,0x248dbf80,0x3f35bf35,0xa5543f80,0xbec43f6d,0xbf353f35,0xbf6d3ec4
.long 0x3f808000,0x3f808000,0x3f808000,0x3f808000,0xbf80a50d,0xbf6d3ec4,0xbf353f35,0xbec43f6d
.long 0x3f808000,0x3f35bf35,0x248dbf80,0xbf35bf35,0xbf80a50d,0xbec43f6d,0x3f353f35,0x3f6dbec4
.long 0x3f808000,0x248dbf80,0xbf80a50d,0xa5543f80,0xbf80a50d,0x3ec43f6d,0x3f35bf35,0xbf6dbec4
.long 0x3f808000,0xbf35bf35,0xa5543f80,0x3f35bf35,0xbf80a50d,0x3f6d3ec4,0xbf35bf35,0x3ec43f6d
.long 0x3f808000,0xbf80a50d,0x3f808000,0xbf80a50d,0xbf80a50d,0x3f6dbec4,0xbf353f35,0x3ec4bf6d
.long 0x3f808000,0xbf353f35,0x248dbf80,0x3f353f35,0xbf80a50d,0x3ec4bf6d,0x3f353f35,0xbf6d3ec4
.long 0x3f808000,0xa5543f80,0xbf80a50d,0x248dbf80,0xbf80a50d,0xbec4bf6d,0x3f35bf35,0x3f6d3ec4
.long 0x3f808000,0x3f353f35,0xa5543f80,0xbf353f35,0xbf80a50d,0xbf6dbec4,0xbf35bf35,0xbec4bf6d
.long 0x3f808000,0x3f808000,0x3f808000,0x3f808000,0xa5543f80,0x3ec43f6d,0x3f353f35,0x3f6d3ec4
.long 0xbf80a50d,0xbf353f35,0xa5543f80,0x3f353f35,0x248dbf80,0xbf6dbec4,0xbf353f35,0x3ec43f6d
.long 0x3f808000,0x248dbf80,0xbf80a50d,0xa5543f80,0xa5543f80,0x3f6dbec4,0xbf35bf35,0xbec43f6d
.long 0xbf80a50d,0x3f353f35,0x248dbf80,0xbf353f35,0x248dbf80,0xbec43f6d,0x3f35bf35,0xbf6d3ec4
.long 0x3f808000,0xbf80a50d,0x3f808000,0xbf80a50d,0xa5543f80,0xbec4bf6d,0x3f353f35,0xbf6dbec4
.long 0xbf80a50d,0x3f35bf35,0xa5543f80,0xbf35bf35,0x248dbf80,0x3f6d3ec4,0xbf353f35,0xbec4bf6d
.long 0x3f808000,0xa5543f80,0xbf80a50d,0x248dbf80,0xa5543f80,0xbf6d3ec4,0xbf35bf35,0x3ec4bf6d
.long 0xbf80a50d,0xbf35bf35,0x248dbf80,0x3f35bf35,0x248dbf80,0x3ec4bf6d,0x3f35bf35,0x3f6dbec4
.long 0x80003f80,0x80003f80,0x80003f80,0x80003f80,0x80003f80,0xbec43f6d,0xbf353f35,0xbf6d3ec4
.long 0x80003f80,0xbf353f35,0xbf80248d,0xbf35bf35,0x80003f80,0xbf6d3ec4,0xbf35bf35,0x3ec4bf6d
.long 0x80003f80,0xbf80248d,0xa50dbf80,0x3f80a554,0x80003f80,0xbf6dbec4,0x3f35bf35,0x3ec43f6d
.long 0x80003f80,0xbf35bf35,0x3f80a554,0xbf353f35,0x80003f80,0xbec4bf6d,0x3f353f35,0xbf6dbec4
.long 0x80003f80,0xa50dbf80,0x80003f80,0xa50dbf80,0x80003f80,0x3ec4bf6d,0xbf353f35,0x3f6dbec4
.long 0x80003f80,0x3f35bf35,0xbf80248d,0x3f353f35,0x80003f80,0x3f6dbec4,0xbf35bf35,0xbec43f6d
.long 0x80003f80,0x3f80a554,0xa50dbf80,0xbf80248d,0x80003f80,0x3f6d3ec4,0x3f35bf35,0xbec4bf6d
.long 0x80003f80,0x3f353f35,0x3f80a554,0x3f35bf35,0x80003f80,0x3ec43f6d,0x3f353f35,0x3f6d3ec4
.long 0x80003f80,0x80003f80,0x80003f80,0x80003f80,0xbf80248d,0xbf6dbec4,0xbf35bf35,0xbec4bf6d
.long 0xa50dbf80,0x3f35bf35,0x3f80a554,0x3f353f35,0x3f80a554,0x3ec43f6d,0xbf353f35,0xbf6dbec4
.long 0x80003f80,0xbf80248d,0xa50dbf80,0x3f80a554,0xbf80248d,0x3ec4bf6d,0x3f353f35,0xbf6d3ec4
.long 0xa50dbf80,0x3f353f35,0xbf80248d,0x3f35bf35,0x3f80a554,0xbf6d3ec4,0x3f35bf35,0xbec43f6d
.long 0x80003f80,0xa50dbf80,0x80003f80,0xa50dbf80,0xbf80248d,0x3f6d3ec4,0xbf35bf35,0x3ec43f6d
.long 0xa50dbf80,0xbf353f35,0x3f80a554,0xbf35bf35,0x3f80a554,0xbec4bf6d,0xbf353f35,0x3f6d3ec4
.long 0x80003f80,0x3f80a554,0xa50dbf80,0xbf80248d,0xbf80248d,0xbec43f6d,0x3f353f35,0x3f6dbec4
.long 0xa50dbf80,0xbf35bf35,0xbf80248d,0xbf353f35,0x3f80a554,0x3f6dbec4,0x3f35bf35,0x3ec4bf6d
.long 0x80003f80,0x80003f80,0x80003f80,0x80003f80,0xa50dbf80,0x3ec4bf6d,0x3f35bf35,0x3f6dbec4
.long 0x80003f80,0xbf353f35,0xbf80248d,0xbf35bf35,0xa50dbf80,0x3f6dbec4,0x3f353f35,0xbec43f6d
.long 0x80003f80,0xbf80248d,0xa50dbf80,0x3f80a554,0xa50dbf80,0x3f6d3ec4,0xbf353f35,0xbec4bf6d
.long 0x80003f80,0xbf35bf35,0x3f80a554,0xbf353f35,0xa50dbf80,0x3ec43f6d,0xbf35bf35,0x3f6d3ec4
.long 0x80003f80,0xa50dbf80,0x80003f80,0xa50dbf80,0xa50dbf80,0xbec43f6d,0x3f35bf35,0xbf6d3ec4
.long 0x80003f80,0x3f35bf35,0xbf80248d,0x3f353f35,0xa50dbf80,0xbf6d3ec4,0x3f353f35,0x3ec4bf6d
.long 0x80003f80,0x3f80a554,0xa50dbf80,0xbf80248d,0xa50dbf80,0xbf6dbec4,0xbf353f35,0x3ec43f6d
.long 0x80003f80,0x3f353f35,0x3f80a554,0x3f35bf35,0xa50dbf80,0xbec4bf6d,0xbf35bf35,0xbf6dbec4
.long 0x80003f80,0x80003f80,0x80003f80,0x80003f80,0x3f80a554,0x3f6d3ec4,0x3f353f35,0x3ec43f6d
.long 0xa50dbf80,0x3f35bf35,0x3f80a554,0x3f353f35,0xbf80248d,0xbec4bf6d,0x3f35bf35,0x3f6d3ec4
.long 0x80003f80,0xbf80248d,0xa50dbf80,0x3f80a554,0x3f80a554,0xbec43f6d,0xbf35bf35,0x3f6dbec4
.long 0xa50dbf80,0x3f353f35,0xbf80248d,0x3f35bf35,0xbf80248d,0x3f6dbec4,0xbf353f35,0x3ec4bf6d
.long 0x80003f80,0xa50dbf80,0x80003f80,0xa50dbf80,0x3f80a554,0xbf6dbec4,0x3f353f35,0xbec4bf6d
.long 0xa50dbf80,0xbf353f35,0x3f80a554,0xbf35bf35,0xbf80248d,0x3ec43f6d,0x3f35bf35,0xbf6dbec4
.long 0x80003f80,0x3f80a554,0xa50dbf80,0xbf80248d,0x3f80a554,0x3ec4bf6d,0xbf35bf35,0xbf6d3ec4
.long 0xa50dbf80,0xbf35bf35,0xbf80248d,0xbf353f35,0xbf80248d,0xbf6d3ec4,0xbf353f35,0xbec43f6d
.long 0x3f800000,0x3f800000,0x3f800000,0x3f800000,0x3f800000,0x3f6d3ec4,0x3f353f35,0x3ec43f6d
.long 0x3f800000,0x3f353f35,0x248d3f80,0xbf353f35,0x3f800000,0x3ec43f6d,0xbf353f35,0xbf6dbec4
.long 0x3f800000,0x248d3f80,0xbf80250d,0xa554bf80,0x3f800000,0xbec43f6d,0xbf35bf35,0x3f6dbec4
.long 0x3f800000,0xbf353f35,0xa554bf80,0x3f353f35,0x3f800000,0xbf6d3ec4,0x3f35bf35,0xbec43f6d
.long 0x3f800000,0xbf80250d,0x3f800000,0xbf80250d,0x3f800000,0xbf6dbec4,0x3f353f35,0xbec4bf6d
.long 0x3f800000,0xbf35bf35,0x248d3f80,0x3f35bf35,0x3f800000,0xbec4bf6d,0xbf353f35,0x3f6d3ec4
.long 0x3f800000,0xa554bf80,0xbf80250d,0x248d3f80,0x3f800000,0x3ec4bf6d,0xbf35bf35,0xbf6d3ec4
.long 0x3f800000,0x3f35bf35,0xa554bf80,0xbf35bf35,0x3f800000,0x3f6dbec4,0x3f35bf35,0x3ec4bf6d
.long 0x3f800000,0x3f800000,0x3f800000,0x3f800000,0x248d3f80,0xbec43f6d,0xbf353f35,0xbf6d3ec4
.long 0xbf80250d,0xbf35bf35,0xa554bf80,0x3f35bf35,0xa554bf80,0x3f6dbec4,0x3f353f35,0xbec43f6d
.long 0x3f800000,0x248d3f80,0xbf80250d,0xa554bf80,0x248d3f80,0xbf6dbec4,0x3f35bf35,0x3ec43f6d
.long 0xbf80250d,0x3f35bf35,0x248d3f80,0xbf35bf35,0xa554bf80,0x3ec43f6d,0xbf35bf35,0x3f6d3ec4
.long 0x3f800000,0xbf80250d,0x3f800000,0xbf80250d,0x248d3f80,0x3ec4bf6d,0xbf353f35,0x3f6dbec4
.long 0xbf80250d,0x3f353f35,0xa554bf80,0xbf353f35,0xa554bf80,0xbf6d3ec4,0x3f353f35,0x3ec4bf6d
.long 0x3f800000,0xa554bf80,0xbf80250d,0x248d3f80,0x248d3f80,0x3f6d3ec4,0x3f35bf35,0xbec4bf6d
.long 0xbf80250d,0xbf353f35,0x248d3f80,0x3f353f35,0xa554bf80,0xbec4bf6d,0xbf35bf35,0xbf6dbec4
.long 0x3f800000,0x3f800000,0x3f800000,0x3f800000,0xbf80250d,0xbf6dbec4,0xbf35bf35,0xbec4bf6d
.long 0x3f800000,0x3f353f35,0x248d3f80,0xbf353f35,0xbf80250d,0xbec4bf6d,0x3f35bf35,0x3f6d3ec4
.long 0x3f800000,0x248d3f80,0xbf80250d,0xa554bf80,0xbf80250d,0x3ec4bf6d,0x3f353f35,0xbf6d3ec4
.long 0x3f800000,0xbf353f35,0xa554bf80,0x3f353f35,0xbf80250d,0x3f6dbec4,0xbf353f35,0x3ec4bf6d
.long 0x3f800000,0xbf80250d,0x3f800000,0xbf80250d,0xbf80250d,0x3f6d3ec4,0xbf35bf35,0x3ec43f6d
.long 0x3f800000,0xbf35bf35,0x248d3f80,0x3f35bf35,0xbf80250d,0x3ec43f6d,0x3f35bf35,0xbf6dbec4
.long 0x3f800000,0xa554bf80,0xbf80250d,0x248d3f80,0xbf80250d,0xbec43f6d,0x3f353f35,0x3f6dbec4
.long 0x3f800000,0x3f35bf35,0xa554bf80,0xbf35bf35,0xbf80250d,0xbf6d3ec4,0xbf353f35,0xbec43f6d
.long 0x3f800000,0x3f800000,0x3f800000,0x3f800000,0xa554bf80,0x3ec4bf6d,0x3f35bf35,0x3f6dbec4
.long 0xbf80250d,0xbf35bf35,0xa554bf80,0x3f35bf35,0x248d3f80,0xbf6d3ec4,0xbf35bf35,0x3ec4bf6d
.long 0x3f800000,0x248d3f80,0xbf80250d,0xa554bf80,0xa554bf80,0x3f6d3ec4,0xbf353f35,0xbec4bf6d
.long 0xbf80250d,0x3f35bf35,0x248d3f80,0xbf35bf35,0x248d3f80,0xbec4bf6d,0x3f353f35,0xbf6dbec4
.long 0x3f800000,0xbf80250d,0x3f800000,0xbf80250d,0xa554bf80,0xbec43f6d,0x3f35bf35,0xbf6d3ec4
.long 0xbf80250d,0x3f353f35,0xa554bf80,0xbf353f35,0x248d3f80,0x3f6dbec4,0xbf35bf35,0xbec43f6d
.long 0x3f800000,0xa554bf80,0xbf80250d,0x248d3f80,0xa554bf80,0xbf6dbec4,0xbf353f35,0x3ec43f6d
.long 0xbf80250d,0xbf353f35,0x248d3f80,0x3f353f35,0x248d3f80,0x3ec43f6d,0x3f353f35,0x3f6d3ec4
.long 0x3f800000,0x3f800000,0x40000000,0x80000000,0x3f800000,0xbf800000,0x3fb504f3,0xbfb504f3
.long 0x3f800000,0x3f800000,0,0xc0000000,0x3f800000,0xbf800000,0xbfb504f3,0xbfb504f3
.long 0,0,0,0,0,0,0,0
.long 0,0,0,0,0,0,0,0
.long 0,0,0,0,0,0,0,0
.long 0,0,0,0,0,0,0,0
.long 0,0,0,0,0,0,0,0
.long 0,0,0,0,0,0,0,0
.long 0,0,0,0,0,0,0,0
.long 0,0,0,0,0,0,0,0
.long 0x3f800000,0x3f800000,0x40000000,0x80000000,0x3f800000,0xbf800000,0x3fb504f3,0xbfb504f3
.long 0x3f800000,0x3f800000,0,0xc0000000,0x3f800000,0xbf800000,0xbfb504f3,0xbfb504f3
.long 0,0,0,0,0,0,0,0
.long 0,0,0,0,0,0,0,0
.long 0,0,0,0,0,0,0,0
.long 0,0,0,0,0,0,0,0
.long 0,0,0,0,0,0,0,0
.long 0,0,0,0,0,0,0,0
.long 0,0,0,0,0,0,0,0
.long 0,0,0,0,0,0,0,0
.long 0x3f800000,0x3f800000,0x40000000,0x80000000,0x3f800000,0xbf800000,0x3fb504f3,0xbfb504f3
.long 0x3f800000,0x3f800000,0,0xc0000000,0x3f800000,0xbf800000,0xbfb504f3,0xbfb504f3
.long 0,0,0,0,0,0,0,0
.long 0,0,0,0,0,0,0,0
.long 0,0,0,0,0,0,0,0
.long 0,0,0,0,0,0,0,0
.long 0,0,0,0,0,0,0,0
.long 0,0,0,0,0,0,0,0
.long 0,0,0,0,0,0,0,0
.long 0,0,0,0,0,0,0,0
.long 0x3f800000,0x3f800000,0x40000000,0x80000000,0x3f800000,0xbf800000,0x3fb504f3,0xbfb504f3
.long 0x3f800000,0x3f800000,0,0xc0000000,0x3f800000,0xbf800000,0xbfb504f3,0xbfb504f3
.long 0x40000000,0x80000000,0x40000000,0x80000000,0,0xc0000000,0xbfb504f3,0xbfb504f3
.long 0xc0000000,0x80000000,0x80000000,0x40000000,0x80000000,0x40000000,0x3fb504f3,0xbfb504f3
.long 0,0,0,0,0,0,0,0
.long 0,0,0,0,0,0,0,0
.long 0,0,0,0,0,0,0,0
.long 0,0,0,0,0,0,0,0
.long 0,0,0,0,0,0,0,0
.long 0,0,0,0,0,0,0,0
.long 0,0,0,0,0,0,0,0
.long 0,0,0,0,0,0,0,0
.long 0x40000000,0x80000000,0x40000000,0x80000000,0,0xc0000000,0xbfb504f3,0xbfb504f3
.long 0xc0000000,0x80000000,0x80000000,0x40000000,0x80000000,0x40000000,0x3fb504f3,0xbfb504f3
.long 0,0,0,0,0,0,0,0
.long 0,0,0,0,0,0,0,0
.long 0,0,0,0,0,0,0,0
.long 0,0,0,0,0,0,0,0
.long 0,0,0,0,0,0,0,0
.long 0,0,0,0,0,0,0,0
.long 0,0,0,0,0,0,0,0
.long 0,0,0,0,0,0,0,0
.long 0x40000000,0x80000000,0x40000000,0x80000000,0,0xc0000000,0xbfb504f3,0xbfb504f3
.long 0xc0000000,0x80000000,0x80000000,0x40000000,0x80000000,0x40000000,0x3fb504f3,0xbfb504f3
.long 0,0,0,0,0,0,0,0
.long 0,0,0,0,0,0,0,0
.long 0,0,0,0,0,0,0,0
.long 0,0,0,0,0,0,0,0
.long 0,0,0,0,0,0,0,0
.long 0,0,0,0,0,0,0,0
.long 0,0,0,0,0,0,0,0
.long 0,0,0,0,0,0,0,0
.long 0x40000000,0x80000000,0x40000000,0x80000000,0,0xc0000000,0xbfb504f3,0xbfb504f3
.long 0xc0000000,0x80000000,0x80000000,0x40000000,0x80000000,0x40000000,0x3fb504f3,0xbfb504f3
.long 0x3f80,0x3e483f7b,0x3ec43f6d,0x3f0e3f55,0x3f80,0x3f0e3f55,0x3f6d3ec4,0x3f7bbe48
.long 0x3f80,0x3f553f0e,0x3f6dbec4,0x3e48bf7b,0x3f80,0x3f7b3e48,0x3ec4bf6d,0xbf55bf0e
.long 0x3f80,0x3f7bbe48,0xbec4bf6d,0xbf553f0e,0x3f80,0x3f55bf0e,0xbf6dbec4,0x3e483f7b
.long 0x3f80,0x3f0ebf55,0xbf6d3ec4,0x3f7b3e48,0x3f80,0x3e48bf7b,0xbec43f6d,0x3f0ebf55
.long 0x3f80,0xbe48bf7b,0x3ec43f6d,0xbf0ebf55,0x3f80,0xbf0ebf55,0x3f6d3ec4,0xbf7b3e48
.long 0x3f80,0xbf55bf0e,0x3f6dbec4,0xbe483f7b,0x3f80,0xbf7bbe48,0x3ec4bf6d,0x3f553f0e
.long 0x3f80,0xbf7b3e48,0xbec4bf6d,0x3f55bf0e,0x3f80,0xbf553f0e,0xbf6dbec4,0xbe48bf7b
.long 0x3f80,0xbf0e3f55,0xbf6d3ec4,0xbf7bbe48,0x3f80,0xbe483f7b,0xbec43f6d,0xbf0e3f55
.long 0x3f353f35,0x3f553f0e,0x3f6d3ec4,0x3f7b3e48,0x3f35bf35,0x3e48bf7b,0xbec4bf6d,0xbf55bf0e
.long 0xbf35bf35,0xbf7b3e48,0xbec43f6d,0x3f0e3f55,0xbf353f35,0x3f0e3f55,0x3f6dbec4,0xbe48bf7b
.long 0x3f353f35,0x3f0ebf55,0xbf6dbec4,0xbe483f7b,0x3f35bf35,0xbf7bbe48,0x3ec43f6d,0x3f0ebf55
.long 0xbf35bf35,0x3e483f7b,0x3ec4bf6d,0xbf553f0e,0xbf353f35,0x3f55bf0e,0xbf6d3ec4,0x3f7bbe48
.long 0x3f353f35,0xbf55bf0e,0x3f6d3ec4,0xbf7bbe48,0x3f35bf35,0xbe483f7b,0xbec4bf6d,0x3f553f0e
.long 0xbf35bf35,0x3f7bbe48,0xbec43f6d,0xbf0ebf55,0xbf353f35,0xbf0ebf55,0x3f6dbec4,0x3e483f7b
.long 0x3f353f35,0xbf0e3f55,0xbf6dbec4,0x3e48bf7b,0x3f35bf35,0x3f7b3e48,0x3ec43f6d,0xbf0e3f55
.long 0xbf35bf35,0xbe48bf7b,0x3ec4bf6d,0x3f55bf0e,0xbf353f35,0xbf553f0e,0xbf6d3ec4,0xbf7b3e48
.long 0x3f80248d,0x3f7bbe48,0x3f6dbec4,0x3f55bf0e,0xbf80a554,0xbf553f0e,0xbec43f6d,0x3e483f7b
.long 0x3f8025b0,0x3f0ebf55,0xbec4bf6d,0xbf7bbe48,0xbf80a5f7,0xbe483f7b,0x3f6d3ec4,0x3f0ebf55
.long 0x3f80261f,0xbe48bf7b,0xbf6d3ec4,0x3f0e3f55,0xbf80a731,0x3f0e3f55,0x3ec4bf6d,0xbf7b3e48
.long 0x3f80a68d,0xbf55bf0e,0x3ec43f6d,0x3e48bf7b,0xbf80a742,0x3f7b3e48,0xbf6dbec4,0x3f553f0e
.long 0x3f80a654,0xbf7b3e48,0x3f6dbec4,0xbf553f0e,0xbf80a754,0x3f55bf0e,0xbec43f6d,0xbe48bf7b
.long 0x3f80a60d,0xbf0e3f55,0xbec4bf6d,0x3f7b3e48,0xbf80a765,0x3e48bf7b,0x3f6d3ec4,0xbf0e3f55
.long 0x3f80a58e,0x3e483f7b,0xbf6d3ec4,0xbf0ebf55,0xbf80a777,0xbf0ebf55,0x3ec4bf6d,0x3f7bbe48
.long 0x3f80a137,0x3f553f0e,0x3ec43f6d,0xbe483f7b,0xbf80a784,0xbf7bbe48,0xbf6dbec4,0xbf55bf0e
.long 0x3f35bf35,0x3f0ebf55,0x3ec4bf6d,0x3e48bf7b,0x3f353f35,0x3f7b3e48,0x3f6dbec4,0x3f0ebf55
.long 0xbf353f35,0x3e483f7b,0x3f6d3ec4,0x3f55bf0e,0xbf35bf35,0xbf553f0e,0x3ec43f6d,0x3f7bbe48
.long 0x3f35bf35,0xbf55bf0e,0xbec43f6d,0x3f7b3e48,0x3f353f35,0x3e48bf7b,0xbf6d3ec4,0x3f553f0e
.long 0xbf353f35,0x3f7bbe48,0xbf6dbec4,0x3f0e3f55,0xbf35bf35,0x3f0e3f55,0xbec4bf6d,0x3e483f7b
.long 0x3f35bf35,0xbf0e3f55,0x3ec4bf6d,0xbe483f7b,0x3f353f35,0xbf7bbe48,0x3f6dbec4,0xbf0e3f55
.long 0xbf353f35,0xbe48bf7b,0x3f6d3ec4,0xbf553f0e,0xbf35bf35,0x3f55bf0e,0x3ec43f6d,0xbf7b3e48
.long 0x3f35bf35,0x3f553f0e,0xbec43f6d,0xbf7bbe48,0x3f353f35,0xbe483f7b,0xbf6d3ec4,0xbf55bf0e
.long 0xbf353f35,0xbf7b3e48,0xbf6dbec4,0xbf0ebf55,0xbf35bf35,0xbf0ebf55,0xbec4bf6d,0xbe48bf7b
.long 0x3f808000,0x3f7bbe48,0x3f6dbec4,0x3f55bf0e,0x3f808000,0x3f55bf0e,0x3ec4bf6d,0xbe48bf7b
.long 0x3f808000,0x3f0ebf55,0xbec4bf6d,0xbf7bbe48,0x3f808000,0x3e48bf7b,0xbf6dbec4,0xbf0e3f55
.long 0x3f808000,0xbe48bf7b,0xbf6d3ec4,0x3f0e3f55,0x3f808000,0xbf0ebf55,0xbec43f6d,0x3f7bbe48
.long 0x3f808000,0xbf55bf0e,0x3ec43f6d,0x3e48bf7b,0x3f808000,0xbf7bbe48,0x3f6d3ec4,0xbf55bf0e
.long 0x3f808000,0xbf7b3e48,0x3f6dbec4,0xbf553f0e,0x3f808000,0xbf553f0e,0x3ec4bf6d,0x3e483f7b
.long 0x3f808000,0xbf0e3f55,0xbec4bf6d,0x3f7b3e48,0x3f808000,0xbe483f7b,0xbf6dbec4,0x3f0ebf55
.long 0x3f808000,0x3e483f7b,0xbf6d3ec4,0xbf0ebf55,0x3f808000,0x3f0e3f55,0xbec43f6d,0xbf7b3e48
.long 0x3f808000,0x3f553f0e,0x3ec43f6d,0xbe483f7b,0x3f808000,0x3f7b3e48,0x3f6d3ec4,0x3f553f0e
.long 0x3f35bf35,0x3f0ebf55,0x3ec4bf6d,0x3e48bf7b,0xbf35bf35,0xbf7bbe48,0xbf6d3ec4,0xbf0e3f55
.long 0xbf353f35,0x3e483f7b,0x3f6d3ec4,0x3f55bf0e,0x3f353f35,0x3f55bf0e,0xbec4bf6d,0xbf7b3e48
.long 0x3f35bf35,0xbf55bf0e,0xbec43f6d,0x3f7b3e48,0xbf35bf35,0xbe483f7b,0x3f6dbec4,0xbf55bf0e
.long 0xbf353f35,0x3f7bbe48,0xbf6dbec4,0x3f0e3f55,0x3f353f35,0xbf0ebf55,0x3ec43f6d,0xbe48bf7b
.long 0x3f35bf35,0xbf0e3f55,0x3ec4bf6d,0xbe483f7b,0xbf35bf35,0x3f7b3e48,0xbf6d3ec4,0x3f0ebf55
.long 0xbf353f35,0xbe48bf7b,0x3f6d3ec4,0xbf553f0e,0x3f353f35,0xbf553f0e,0xbec4bf6d,0x3f7bbe48
.long 0x3f35bf35,0x3f553f0e,0xbec43f6d,0xbf7bbe48,0xbf35bf35,0x3e48bf7b,0x3f6dbec4,0x3f553f0e
.long 0xbf353f35,0xbf7b3e48,0xbf6dbec4,0xbf0ebf55,0x3f353f35,0x3f0e3f55,0x3ec43f6d,0x3e483f7b
.long 0x248dbf80,0xbe48bf7b,0xbec4bf6d,0xbf0ebf55,0xa5543f80,0x3f0e3f55,0x3f6d3ec4,0x3f7bbe48
.long 0x25b0bf80,0xbf55bf0e,0xbf6d3ec4,0xbe483f7b,0xa5f73f80,0x3f7b3e48,0x3ec4bf6d,0xbf55bf0e
.long 0x261fbf80,0xbf7b3e48,0x3ec43f6d,0x3f55bf0e,0xa7313f80,0x3f55bf0e,0xbf6dbec4,0x3e483f7b
.long 0xa68dbf80,0xbf0e3f55,0x3f6dbec4,0xbf7bbe48,0xa7423f80,0x3e48bf7b,0xbec43f6d,0x3f0ebf55
.long 0xa654bf80,0x3e483f7b,0xbec4bf6d,0x3f0e3f55,0xa7543f80,0xbf0ebf55,0x3f6d3ec4,0xbf7b3e48
.long 0xa60dbf80,0x3f553f0e,0xbf6d3ec4,0x3e48bf7b,0xa7653f80,0xbf7bbe48,0x3ec4bf6d,0x3f553f0e
.long 0xa58ebf80,0x3f7bbe48,0x3ec43f6d,0xbf553f0e,0xa7773f80,0xbf553f0e,0xbf6dbec4,0xbe48bf7b
.long 0xa137bf80,0x3f0ebf55,0x3f6dbec4,0x3f7b3e48,0xa7843f80,0xbe483f7b,0xbec43f6d,0xbf0e3f55
.long 0xbf35bf35,0xbf55bf0e,0xbf6dbec4,0xbf7bbe48,0x3f35bf35,0x3e48bf7b,0xbec4bf6d,0xbf55bf0e
.long 0x3f353f35,0x3f7bbe48,0x3ec4bf6d,0xbf0ebf55,0xbf353f35,0x3f0e3f55,0x3f6dbec4,0xbe48bf7b
.long 0xbf35bf35,0xbf0e3f55,0x3f6d3ec4,0x3e48bf7b,0x3f35bf35,0xbf7bbe48,0x3ec43f6d,0x3f0ebf55
.long 0x3f353f35,0xbe48bf7b,0xbec43f6d,0x3f55bf0e,0xbf353f35,0x3f55bf0e,0xbf6d3ec4,0x3f7bbe48
.long 0xbf35bf35,0x3f553f0e,0xbf6dbec4,0x3f7b3e48,0x3f35bf35,0xbe483f7b,0xbec4bf6d,0x3f553f0e
.long 0x3f353f35,0xbf7b3e48,0x3ec4bf6d,0x3f0e3f55,0xbf353f35,0xbf0ebf55,0x3f6dbec4,0x3e483f7b
.long 0xbf35bf35,0x3f0ebf55,0x3f6d3ec4,0xbe483f7b,0x3f35bf35,0x3f7b3e48,0x3ec43f6d,0xbf0e3f55
.long 0x3f353f35,0x3e483f7b,0xbec43f6d,0xbf553f0e,0xbf353f35,0xbf553f0e,0xbf6d3ec4,0xbf7b3e48
.long 0x80003f80,0x80003f80,0x80003f80,0x80003f80,0xbe483f7b,0xbf0e3f55,0xbf553f0e,0xbf7b3e48
.long 0xbec43f6d,0xbf6d3ec4,0xbf6dbec4,0xbec4bf6d,0xbf0e3f55,0xbf7bbe48,0xbe48bf7b,0x3f55bf0e
.long 0xbf353f35,0xbf35bf35,0x3f35bf35,0x3f353f35,0xbf553f0e,0xbe48bf7b,0x3f7b3e48,0xbf0e3f55
.long 0xbf6d3ec4,0x3ec4bf6d,0x3ec43f6d,0xbf6dbec4,0xbf7b3e48,0x3f55bf0e,0xbf0e3f55,0x3e48bf7b
.long 0xbf80248d,0x3f80a554,0xbf8025b0,0x3f80a5f7,0xbf7bbe48,0x3f553f0e,0xbf0ebf55,0x3e483f7b
.long 0xbf6dbec4,0x3ec43f6d,0x3ec4bf6d,0xbf6d3ec4,0xbf55bf0e,0xbe483f7b,0x3f7bbe48,0xbf0ebf55
.long 0xbf35bf35,0xbf353f35,0x3f353f35,0x3f35bf35,0xbf0ebf55,0xbf7b3e48,0xbe483f7b,0x3f553f0e
.long 0xbec4bf6d,0xbf6dbec4,0xbf6d3ec4,0xbec43f6d,0xbe48bf7b,0xbf0ebf55,0xbf55bf0e,0xbf7bbe48
.long 0x80003f80,0x80003f80,0x80003f80,0x80003f80,0xbf7bbe48,0xbf55bf0e,0xbf0ebf55,0xbe48bf7b
.long 0x3ec4bf6d,0x3f6dbec4,0x3f6d3ec4,0x3ec43f6d,0x3f553f0e,0xbe483f7b,0xbf7b3e48,0xbf0ebf55
.long 0xbf353f35,0xbf35bf35,0x3f35bf35,0x3f353f35,0xbf0ebf55,0x3f7bbe48,0xbe483f7b,0xbf55bf0e
.long 0x3f6dbec4,0xbec43f6d,0xbec4bf6d,0x3f6d3ec4,0x3e483f7b,0xbf0ebf55,0x3f553f0e,0xbf7bbe48
.long 0xbf80261f,0x3f80a731,0xbf80a68d,0x3f80a742,0x3e48bf7b,0xbf0e3f55,0x3f55bf0e,0xbf7b3e48
.long 0x3f6d3ec4,0xbec4bf6d,0xbec43f6d,0x3f6dbec4,0xbf0e3f55,0x3f7b3e48,0xbe48bf7b,0xbf553f0e
.long 0xbf35bf35,0xbf353f35,0x3f353f35,0x3f35bf35,0x3f55bf0e,0xbe48bf7b,0xbf7bbe48,0xbf0e3f55
.long 0x3ec43f6d,0x3f6d3ec4,0x3f6dbec4,0x3ec4bf6d,0xbf7b3e48,0xbf553f0e,0xbf0e3f55,0xbe483f7b
.long 0x80003f80,0x80003f80,0x80003f80,0x80003f80,0x3e48bf7b,0x3f0ebf55,0x3f55bf0e,0x3f7bbe48
.long 0xbec43f6d,0xbf6d3ec4,0xbf6dbec4,0xbec4bf6d,0x3f0ebf55,0x3f7b3e48,0x3e483f7b,0xbf553f0e
.long 0xbf353f35,0xbf35bf35,0x3f35bf35,0x3f353f35,0x3f55bf0e,0x3e483f7b,0xbf7bbe48,0x3f0ebf55
.long 0xbf6d3ec4,0x3ec4bf6d,0x3ec43f6d,0xbf6dbec4,0x3f7bbe48,0xbf553f0e,0x3f0ebf55,0xbe483f7b
.long 0xbf80a654,0x3f80a754,0xbf80a60d,0x3f80a765,0x3f7b3e48,0xbf55bf0e,0x3f0e3f55,0xbe48bf7b
.long 0xbf6dbec4,0x3ec43f6d,0x3ec4bf6d,0xbf6d3ec4,0x3f553f0e,0x3e48bf7b,0xbf7b3e48,0x3f0e3f55
.long 0xbf35bf35,0xbf353f35,0x3f353f35,0x3f35bf35,0x3f0e3f55,0x3f7bbe48,0x3e48bf7b,0xbf55bf0e
.long 0xbec4bf6d,0xbf6dbec4,0xbf6d3ec4,0xbec43f6d,0x3e483f7b,0x3f0e3f55,0x3f553f0e,0x3f7b3e48
.long 0x80003f80,0x80003f80,0x80003f80,0x80003f80,0x3f7b3e48,0x3f553f0e,0x3f0e3f55,0x3e483f7b
.long 0x3ec4bf6d,0x3f6dbec4,0x3f6d3ec4,0x3ec43f6d,0xbf55bf0e,0x3e48bf7b,0x3f7bbe48,0x3f0e3f55
.long 0xbf353f35,0xbf35bf35,0x3f35bf35,0x3f353f35,0x3f0e3f55,0xbf7b3e48,0x3e48bf7b,0x3f553f0e
.long 0x3f6dbec4,0xbec43f6d,0xbec4bf6d,0x3f6d3ec4,0xbe48bf7b,0x3f0e3f55,0xbf55bf0e,0x3f7b3e48
.long 0xbf80a58e,0x3f80a777,0xbf80a137,0x3f80a784,0xbe483f7b,0x3f0ebf55,0xbf553f0e,0x3f7bbe48
.long 0x3f6d3ec4,0xbec4bf6d,0xbec43f6d,0x3f6dbec4,0x3f0ebf55,0xbf7bbe48,0x3e483f7b,0x3f55bf0e
.long 0xbf35bf35,0xbf353f35,0x3f353f35,0x3f35bf35,0xbf553f0e,0x3e483f7b,0x3f7b3e48,0x3f0ebf55
.long 0x3ec43f6d,0x3f6d3ec4,0x3f6dbec4,0x3ec4bf6d,0x3f7bbe48,0x3f55bf0e,0x3f0ebf55,0x3e48bf7b
.long 0x3f800000,0x3f800000,0x3f800000,0x3f800000,0x3f7b3e48,0x3f553f0e,0x3f0e3f55,0x3e483f7b
.long 0x3f6d3ec4,0x3ec43f6d,0xbec43f6d,0xbf6d3ec4,0x3f553f0e,0xbe483f7b,0xbf7b3e48,0xbf0ebf55
.long 0x3f353f35,0xbf353f35,0xbf35bf35,0x3f35bf35,0x3f0e3f55,0xbf7b3e48,0x3e48bf7b,0x3f553f0e
.long 0x3ec43f6d,0xbf6dbec4,0x3f6dbec4,0xbec43f6d,0x3e483f7b,0xbf0ebf55,0x3f553f0e,0xbf7bbe48
.long 0x248d3f80,0xa554bf80,0x25b03f80,0xa5f7bf80,0xbe483f7b,0x3f0ebf55,0xbf553f0e,0x3f7bbe48
.long 0xbec43f6d,0x3f6dbec4,0xbf6dbec4,0x3ec43f6d,0xbf0e3f55,0x3f7b3e48,0xbe48bf7b,0xbf553f0e
.long 0xbf353f35,0x3f353f35,0x3f35bf35,0xbf35bf35,0xbf553f0e,0x3e483f7b,0x3f7b3e48,0x3f0ebf55
.long 0xbf6d3ec4,0xbec43f6d,0x3ec43f6d,0x3f6d3ec4,0xbf7b3e48,0xbf553f0e,0xbf0e3f55,0xbe483f7b
.long 0x3f800000,0x3f800000,0x3f800000,0x3f800000,0xbe483f7b,0xbf0e3f55,0xbf553f0e,0xbf7b3e48
.long 0xbf6dbec4,0xbec4bf6d,0x3ec4bf6d,0x3f6dbec4,0x3f0ebf55,0x3f7b3e48,0x3e483f7b,0xbf553f0e
.long 0x3f353f35,0xbf353f35,0xbf35bf35,0x3f35bf35,0xbf553f0e,0xbe48bf7b,0x3f7b3e48,0xbf0e3f55
.long 0xbec4bf6d,0x3f6d3ec4,0xbf6d3ec4,0x3ec4bf6d,0x3f7bbe48,0xbf553f0e,0x3f0ebf55,0xbe483f7b
.long 0x261f3f80,0xa731bf80,0xa68d3f80,0xa742bf80,0xbf7bbe48,0x3f553f0e,0xbf0ebf55,0x3e483f7b
.long 0x3ec4bf6d,0xbf6d3ec4,0x3f6d3ec4,0xbec4bf6d,0x3f553f0e,0x3e48bf7b,0xbf7b3e48,0x3f0e3f55
.long 0xbf353f35,0x3f353f35,0x3f35bf35,0xbf35bf35,0xbf0ebf55,0xbf7b3e48,0xbe483f7b,0x3f553f0e
.long 0x3f6dbec4,0x3ec4bf6d,0xbec4bf6d,0xbf6dbec4,0x3e483f7b,0x3f0e3f55,0x3f553f0e,0x3f7b3e48
.long 0x3f800000,0x3f800000,0x3f800000,0x3f800000,0xbf7bbe48,0xbf55bf0e,0xbf0ebf55,0xbe48bf7b
.long 0x3f6d3ec4,0x3ec43f6d,0xbec43f6d,0xbf6d3ec4,0xbf55bf0e,0x3e48bf7b,0x3f7bbe48,0x3f0e3f55
.long 0x3f353f35,0xbf353f35,0xbf35bf35,0x3f35bf35,0xbf0ebf55,0x3f7bbe48,0xbe483f7b,0xbf55bf0e
.long 0x3ec43f6d,0xbf6dbec4,0x3f6dbec4,0xbec43f6d,0xbe48bf7b,0x3f0e3f55,0xbf55bf0e,0x3f7b3e48
.long 0xa6543f80,0xa754bf80,0xa60d3f80,0xa765bf80,0x3e48bf7b,0xbf0e3f55,0x3f55bf0e,0xbf7b3e48
.long 0xbec43f6d,0x3f6dbec4,0xbf6dbec4,0x3ec43f6d,0x3f0ebf55,0xbf7bbe48,0x3e483f7b,0x3f55bf0e
.long 0xbf353f35,0x3f353f35,0x3f35bf35,0xbf35bf35,0x3f55bf0e,0xbe48bf7b,0xbf7bbe48,0xbf0e3f55
.long 0xbf6d3ec4,0xbec43f6d,0x3ec43f6d,0x3f6d3ec4,0x3f7bbe48,0x3f55bf0e,0x3f0ebf55,0x3e48bf7b
.long 0x3f800000,0x3f800000,0x3f800000,0x3f800000,0x3e48bf7b,0x3f0ebf55,0x3f55bf0e,0x3f7bbe48
.long 0xbf6dbec4,0xbec4bf6d,0x3ec4bf6d,0x3f6dbec4,0xbf0e3f55,0xbf7bbe48,0xbe48bf7b,0x3f55bf0e
.long 0x3f353f35,0xbf353f35,0xbf35bf35,0x3f35bf35,0x3f55bf0e,0x3e483f7b,0xbf7bbe48,0x3f0ebf55
.long 0xbec4bf6d,0x3f6d3ec4,0xbf6d3ec4,0x3ec4bf6d,0xbf7b3e48,0x3f55bf0e,0xbf0e3f55,0x3e48bf7b
.long 0xa58e3f80,0xa777bf80,0xa1373f80,0xa784bf80,0x3f7b3e48,0xbf55bf0e,0x3f0e3f55,0xbe48bf7b
.long 0x3ec4bf6d,0xbf6d3ec4,0x3f6d3ec4,0xbec4bf6d,0xbf55bf0e,0xbe483f7b,0x3f7bbe48,0xbf0ebf55
.long 0xbf353f35,0x3f353f35,0x3f35bf35,0xbf35bf35,0x3f0e3f55,0x3f7bbe48,0x3e48bf7b,0xbf55bf0e
.long 0x3f6dbec4,0x3ec4bf6d,0xbec4bf6d,0xbf6dbec4,0xbe48bf7b,0xbf0ebf55,0xbf55bf0e,0xbf7bbe48
.long 0x3f800000,0x3f7ffb11,0x3f7fec43,0x3f7fd397,0x3f800000,0x3f7fd397,0x3f7f4e6d,0x3f7e70b0
.long 0x3f800000,0x3f7f84ab,0x3f7e1324,0x3f7baccd,0x3f800000,0x3f7f0e58,0x3f7c3b28,0x3f778bc5
.long 0x3f800000,0x3f7e70b0,0x3f79c79d,0x3f721352,0x3f800000,0x3f7dabcc,0x3f76ba07,0x3f6b4b0c
.long 0x3f800000,0x3f7cbfc9,0x3f731447,0x3f633c5a,0x3f800000,0x3f7baccd,0x3f6ed89e,0x3f59f26a
.long 0x3f800000,0x3f7a7302,0x3f6a09a7,0x3f4f7a1f,0x3f800000,0x3f791298,0x3f64aa59,0x3f43e200
.long 0x3f800000,0x3f778bc5,0x3f5ebe05,0x3f373a23,0x3f800000,0x3f75dec6,0x3f584853,0x3f299415
.long 0x3f800000,0x3f740bdd,0x3f514d3d,0x3f1b02c6,0x3f800000,0x3f721352,0x3f49d112,0x3f0b9a6b
.long 0x3f800000,0x3f6ff573,0x3f41d870,0x3ef6e0cb,0x3f800000,0x3f6db293,0x3f396842,0x3ed53641
.long 0x3f7fb10f,0x3f7f84ab,0x3f7f4e6d,0x3f7f0e58,0x3f7d3aac,0x3f7baccd,0x3f79c79d,0x3f778bc5
.long 0x3f7853f8,0x3f740bdd,0x3f6ed89e,0x3f68bf3c,0x3f710908,0x3f68bf3c,0x3f5ebe05,0x3f531849
.long 0x3f676bd8,0x3f59f26a,0x3f49d112,0x3f373a23,0x3f5b941a,0x3f47de65,0x3f3085bb,0x3f15f6d9
.long 0x3f4d9f02,0x3f32c8c9,0x3f13682a,0x3ee0924f,0x3f3daef9,0x3f1b02c6,0x3ee63375,0x3e8e9a22
.long 0x3f2beb4a,0x3f00e7e4,0x3ea09ae5,0x3de1bc2e,0x3f187fc0,0x3ec9b953,0x3e2f10a2,0xbd7b2b74
.long 0x3f039c3d,0x3e8e9a22,0x3cc90ab0,0xbe6c9a7f,0x3edae880,0x3e22abb6,0xbdfab273,0xbec9b953
.long 0x3eac7cd4,0x3d16c32c,0xbe888e93,0xbf0b9a6b,0x3e78cfcc,0xbdafb680,0xbecf7bca,0xbf2e3bde
.long 0x3e164083,0xbe541501,0xbf08f59b,0xbf4bbbf8,0x3d48fb30,0xbea68f12,0xbf273656,0xbf633c5a
.long 0x3f7ec46d,0x3f7e70b0,0x3f7e1324,0x3f7dabcc,0x3f74fa0b,0x3f721352,0x3f6ed89e,0x3f6b4b0c
.long 0x3f61c598,0x3f59f26a,0x3f514d3d,0x3f47de65,0x3f45e403,0x3f373a23,0x3f273656,0x3f15f6d9
.long 0x3f226799,0x3f0b9a6b,0x3ee63375,0x3eb263ef,0x3ef15aea,0x3eb263ef,0x3e605c13,0x3dafb680
.long 0x3e94a031,0x3e09cf86,0xbcc90ab0,0xbe3b6ecf,0x3dc8bd36,0xbdafb680,0xbe888e93,0xbee0924f
.long 0xbdc8bd36,0xbe9aa086,0xbefc5d27,0xbf299415,0xbe94a031,0xbf00e7e4,0xbf3085bb,0xbf5695e5
.long 0xbef15aea,0xbf2e3bde,0xbf584853,0xbf740bdd,0xbf226799,0xbf531849,0xbf731447,0xbf7fd397
.long 0xbf45e403,0xbf6db293,0xbf7f4e6d,0xbf791298,0xbf61c598,0xbf7cbfc9,0xbf7c3b28,0xbf604621
.long 0xbf74fa0b,0xbf7f84ab,0xbf6a09a7,0xbf373a23,0xbf7ec46d,0xbf75dec6,0xbf49d112,0xbf00e7e4
.long 0x3f7d3aac,0x3f7cbfc9,0x3f7c3b28,0x3f7baccd,0x3f676bd8,0x3f633c5a,0x3f5ebe05,0x3f59f26a
.long 0x3f3daef9,0x3f32c8c9,0x3f273656,0x3f1b02c6,0x3f039c3d,0x3ee0924f,0x3eb8442a,0x3e8e9a22
.long 0x3e78cfcc,0x3e09cf86,0x3cc90ab0,0xbdafb680,0xbd48fb30,0xbe3b6ecf,0xbea09ae5,0xbee0924f
.long 0xbeac7cd4,0xbef6e0cb,0xbf1d7fd1,0xbf3b8f3b,0xbf187fc0,0xbf3b8f3b,0xbf584853,0xbf6db293
.long 0xbf4d9f02,0xbf68bf3c,0xbf79c79d,0xbf7ffb11,0xbf710908,0xbf7e70b0,0xbf7e1324,0xbf6ff573
.long 0xbf7fb10f,0xbf7a7302,0xbf64aa59,0xbf3fc767,0xbf7853f8,0xbf5d2d53,0xbf3085bb,0xbeebcbbb
.long 0xbf5b941a,0xbf299415,0xbecf7bca,0xbde1bc2e,0xbf2beb4a,0xbec9b953,0xbd96a905,0x3e827dc0
.long 0xbedae880,0xbdafb680,0x3e888e93,0x3f15f6d9,0xbe164083,0x3e6c9a7f,0x3f13682a,0x3f5695e5
.long 0,0x3c490e90,0x3cc90ab0,0x3d16c32c,0,0x3d16c32c,0x3d96a905,0x3de1bc2e
.long 0,0x3d7b2b74,0x3dfab273,0x3e3b6ecf,0,0x3dafb680,0x3e2f10a2,0x3e827dc0
.long 0,0x3de1bc2e,0x3e605c13,0x3ea68f12,0,0x3e09cf86,0x3e888e93,0x3ec9b953
.long 0,0x3e22abb6,0x3ea09ae5,0x3eebcbbb,0,0x3e3b6ecf,0x3eb8442a,0x3f064b82
.long 0,0x3e541501,0x3ecf7bca,0x3f15f6d9,0,0x3e6c9a7f,0x3ee63375,0x3f24d225
.long 0,0x3e827dc0,0x3efc5d27,0x3f32c8c9,0,0x3e8e9a22,0x3f08f59b,0x3f3fc767
.long 0,0x3e9aa086,0x3f13682a,0x3f4bbbf8,0,0x3ea68f12,0x3f1d7fd1,0x3f5695e5
.long 0,0x3eb263ef,0x3f273656,0x3f604621,0,0x3ebe1d4a,0x3f3085bb,0x3f68bf3c
.long 0x3d48fb30,0x3d7b2b74,0x3d96a905,0x3dafb680,0x3e164083,0x3e3b6ecf,0x3e605c13,0x3e827dc0
.long 0x3e78cfcc,0x3e9aa086,0x3eb8442a,0x3ed53641,0x3eac7cd4,0x3ed53641,0x3efc5d27,0x3f10d3cd
.long 0x3edae880,0x3f064b82,0x3f1d7fd1,0x3f32c8c9,0x3f039c3d,0x3f1ff6cb,0x3f396842,0x3f4f7a1f
.long 0x3f187fc0,0x3f373a23,0x3f514d3d,0x3f660f88,0x3f2beb4a,0x3f4bbbf8,0x3f64aa59,0x3f75dec6
.long 0x3f3daef9,0x3f5d2d53,0x3f731447,0x3f7e70b0,0x3f4d9f02,0x3f6b4b0c,0x3f7c3b28,0x3f7f84ab
.long 0x3f5b941a,0x3f75dec6,0x3f7fec43,0x3f791298,0x3f676bd8,0x3f7cbfc9,0x3f7e1324,0x3f6b4b0c
.long 0x3f710908,0x3f7fd397,0x3f76ba07,0x3f5695e5,0x3f7853f8,0x3f7f0e58,0x3f6a09a7,0x3f3b8f3b
.long 0x3f7d3aac,0x3f7a7302,0x3f584853,0x3f1b02c6,0x3f7fb10f,0x3f721352,0x3f41d870,0x3eebcbbb
.long 0x3dc8bd36,0x3de1bc2e,0x3dfab273,0x3e09cf86,0x3e94a031,0x3ea68f12,0x3eb8442a,0x3ec9b953
.long 0x3ef15aea,0x3f064b82,0x3f13682a,0x3f1ff6cb,0x3f226799,0x3f32c8c9,0x3f41d870,0x3f4f7a1f
.long 0x3f45e403,0x3f5695e5,0x3f64aa59,0x3f6ff573,0x3f61c598,0x3f6ff573,0x3f79c79d,0x3f7f0e58
.long 0x3f74fa0b,0x3f7dabcc,0x3f7fec43,0x3f7baccd,0x3f7ec46d,0x3f7f0e58,0x3f76ba07,0x3f660f88
.long 0x3f7ec46d,0x3f740bdd,0x3f5ebe05,0x3f3fc767,0x3f74fa0b,0x3f5d2d53,0x3f396842,0x3f0b9a6b
.long 0x3f61c598,0x3f3b8f3b,0x3f08f59b,0x3e9aa086,0x3f45e403,0x3f10d3cd,0x3ea09ae5,0x3d16c32c
.long 0x3f226799,0x3ebe1d4a,0x3d96a905,0xbe6c9a7f,0x3ef15aea,0x3e22abb6,0xbe2f10a2,0xbef6e0cb
.long 0x3e94a031,0xbd7b2b74,0xbecf7bca,0xbf32c8c9,0x3dc8bd36,0xbe8e9a22,0xbf1d7fd1,0xbf5d2d53
.long 0x3e164083,0x3e22abb6,0x3e2f10a2,0x3e3b6ecf,0x3edae880,0x3eebcbbb,0x3efc5d27,0x3f064b82
.long 0x3f2beb4a,0x3f373a23,0x3f41d870,0x3f4bbbf8,0x3f5b941a,0x3f660f88,0x3f6ed89e,0x3f75dec6
.long 0x3f7853f8,0x3f7dabcc,0x3f7fec43,0x3f7f0e58,0x3f7fb10f,0x3f7baccd,0x3f731447,0x3f660f88
.long 0x3f710908,0x3f604621,0x3f49d112,0x3f2e3bde,0x3f4d9f02,0x3f2e3bde,0x3f08f59b,0x3ebe1d4a
.long 0x3f187fc0,0x3ed53641,0x3e605c13,0x3c490e90,0x3eac7cd4,0x3de1bc2e,0xbdfab273,0xbeb263ef
.long 0x3d48fb30,0xbe541501,0xbee63375,0xbf299415,0xbe78cfcc,0xbf00e7e4,0xbf396842,0xbf633c5a
.long 0xbf039c3d,0xbf3fc767,0xbf6a09a7,0xbf7e70b0,0xbf3daef9,0xbf6b4b0c,0xbf7f4e6d,0xbf778bc5
.long 0xbf676bd8,0xbf7f0e58,0xbf76ba07,0xbf4f7a1f,0xbf7d3aac,0xbf791298,0xbf514d3d,0xbf0b9a6b
.long 0x3510d0c3,0x3510d0c3,0x3510d0c3,0x3510d0c3,0x3510cdf8,0x3510b7a4,0x35108afe,0x3510480f
.long 0x3510c598,0x35106c4f,0x350fb9f5,0x350eaef6,0x3510b7a4,0x350feee0,0x350e5e6f,0x350c087d
.long 0x3510a41b,0x350f3f81,0x350c79bc,0x350859a3,0x35108afe,0x350e5e6f,0x350a0db0,0x3503a95e
.long 0x35106c4f,0x350d4bf9,0x35071c9e,0x34fc010d,0x3510480f,0x350c087d,0x3503a95e,0x34eed39a
.long 0x35101e3f,0x350a946b,0x34ff6e83,0x34dfe343,0x350feee0,0x3508f046,0x34f6942c,0x34cf4c3c
.long 0x350fb9f5,0x35071c9e,0x34eccc40,0x34bd2dd7,0x350f7f7f,0x35051a16,0x34e2202b,0x34a9aa49
.long 0x350f3f81,0x3502e961,0x34d69a35,0x3494e66a,0x350ef9fd,0x35008b40,0x34ca4578,0x347e12dc
.long 0x350eaef6,0x34fc010d,0x34bd2dd7,0x34507936,0x350e5e6f,0x34f6942c,0x34af5fee,0x342155f9
.long 0x3510d0c3,0x3510d0c3,0x3510d0c3,0x3510d0c3,0x350feee0,0x350f7f7f,0x350ef9fd,0x350e5e6f
.long 0x350d4bf9,0x350b91d7,0x350981a1,0x35071c9e,0x3508f046,0x35051a16,0x35008b40,0x34f6942c
.long 0x3502e961,0x34f86cbc,0x34e8a23d,0x34d69a35,0x34f6942c,0x34e2202b,0x34ca4578,0x34af5fee
.long 0x34e4545b,0x34c7b658,0x34a6c599,0x348238aa,0x34cf4c3c,0x34a9aa49,0x347e12dc,0x342155f9
.long 0x34b7bd6c,0x348887f5,0x3428269e,0x33631c41,0x349df168,0x3449d35e,0x339bea3a,0xb346cbe4
.long 0x348238aa,0x33fdd580,0xb26373e9,0xb41a7f1d,0x3449d35e,0x3346cbe4,0xb3d40e5a,0xb47e12dc
.long 0x340cbfc9,0xb2e3625f,0xb44325bf,0xb4ac886f,0x339bea3a,0xb3d40e5a,0xb48ba7c4,0xb4d43308
.long 0x326373e9,0xb435b431,0xb4b230ab,0xb4f4b21b,0xb346cbe4,0xb47e12dc,0xb4d43308,0xb5067648
.long 0x3510d0c3,0x3510d0c3,0x3510d0c3,0x3510d0c3,0x350daced,0x350ce592,0x350c087d,0x350b15cf
.long 0x35046447,0x35015a4a,0x34fc010d,0x34f4b21b,0x34eabbc5,0x34dd9dba,0x34cf4c3c,0x34bfdb2a
.long 0x34c28117,0x34ac886f,0x3494e66a,0x3477aa97,0x3491d71e,0x3464397d,0x342155f9,0x33b80a7b
.long 0x3435b431,0x33c6103c,0x326373e9,0xb38dd0d0,0x337f63dd,0xb30e1543,0xb405d7d9,0xb464397d
.long 0xb3631c41,0xb428269e,0xb48887f5,0xb4b7bd6c,0xb42ef0c7,0xb491d71e,0xb4c51f84,0xb4eed39a
.long 0xb48ec231,0xb4c7b658,0xb4f4b21b,0xb50981a1,0xb4bfdb2a,0xb4f2c69b,0xb50a0db0,0xb510b7a4
.long 0xb4e8a23d,0xb50859a3,0xb510a41b,0xb50c79bc,0xb503a95e,0xb50feee0,0xb50daced,0xb4fa3bb7
.long 0xb50d4bf9,0xb50fb9f5,0xb5015a4a,0xb4c7b658,0xb510cdf8,0xb507bdbf,0xb4d8f91c,0xb48562e2
.long 0x3510d0c3,0x3510d0c3,0x3510d0c3,0x3510d0c3,0x350a0db0,0x3508f046,0x3507bdbf,0x35067648
.long 0x34eccc40,0x34e4545b,0x34db4fa5,0x34d1c3ad,0x34af5fee,0x349df168,0x348ba7c4,0x347138c6
.long 0x344325bf,0x340cbfc9,0x33a9fda1,0x32e3625f,0x32aa9173,0xb346cbe4,0xb3eff186,0xb43c709a
.long 0xb41a7f1d,0xb46abda8,0xb49af3ad,0xb4bd2dd7,0xb49df168,0xb4c51f84,0xb4e67fbe,0xb5008b40
.long 0xb4dfe343,0xb4ff6e83,0xb50a946b,0xb5101e3f,0xb5067648,0xb50ef9fd,0xb5108afe,0xb50b15cf
.long 0xb5106c4f,0xb50eaef6,0xb5046447,0xb4e4545b,0xb50ce592,0xb4fdbcac,0xb4cf4c3c,0xb491d71e
.long 0xb4f86cbc,0xb4c28117,0xb477aa97,0xb3a9fda1,0xb4bfdb2a,0xb464397d,0xb346cbe4,0x3405d7d9
.long 0xb46abda8,0xb32a73dd,0x341a7f1d,0x34a6c599,0xb37f63dd,0x3413a24b,0x34a9aa49,0x34f2c69b
.long 0,0,0,0,0x31e3784b,0x32aa9173,0x330e1543,0x3346cbe4
.long 0x326373e9,0x332a73dd,0x338dd0d0,0x33c6103c,0x32aa9173,0x337f63dd,0x33d40e5a,0x3413a24b
.long 0x32e3625f,0x33a9fda1,0x340cbfc9,0x344325bf,0x330e1543,0x33d40e5a,0x342ef0c7,0x347138c6
.long 0x332a73dd,0x33fdd580,0x34507936,0x348ec231,0x3346cbe4,0x3413a24b,0x347138c6,0x34a3da7b
.long 0x33631c41,0x3428269e,0x348887f5,0x34b7bd6c,0x337f63dd,0x343c709a,0x3497effa,0x34ca4578
.long 0x338dd0d0,0x34507936,0x34a6c599,0x34db4fa5,0x339bea3a,0x3464397d,0x34b4fa88,0x34eabbc5
.long 0x33a9fda1,0x3477aa97,0x34c28117,0x34f86cbc,0x33b80a7b,0x348562e2,0x34cf4c3c,0x35022458
.long 0x33c6103c,0x348ec231,0x34db4fa5,0x35071c9e,0x33d40e5a,0x3497effa,0x34e67fbe,0x350b15cf
.long 0,0,0,0,0x337f63dd,0x339bea3a,0x33b80a7b,0x33d40e5a
.long 0x33fdd580,0x341a7f1d,0x3435b431,0x34507936,0x343c709a,0x3464397d,0x348562e2,0x3497effa
.long 0x3477aa97,0x3494e66a,0x34ac886f,0x34c28117,0x3497effa,0x34b4fa88,0x34cf4c3c,0x34e67fbe
.long 0x34b230ab,0x34d1c3ad,0x34eccc40,0x35015a4a,0x34ca4578,0x34eabbc5,0x35022458,0x350b15cf
.long 0x34dfe343,0x34ff6e83,0x350a946b,0x35101e3f,0x34f2c69b,0x3507bdbf,0x350f7f7f,0x3510480f
.long 0x35015a4a,0x350d4bf9,0x3510c598,0x350b91d7,0x3507bdbf,0x3510480f,0x350e5e6f,0x35022458
.long 0x350c79bc,0x3510a41b,0x350859a3,0x34e8a23d,0x350f7f7f,0x350e5e6f,0x34fdbcac,0x34c51f84
.long 0x3510c598,0x350981a1,0x34e4545b,0x349af3ad,0x3510480f,0x35022458,0x34c51f84,0x34571703
.long 0,0,0,0,0x33eff186,0x3405d7d9,0x3413a24b,0x342155f9
.long 0x346abda8,0x348238aa,0x348ec231,0x349af3ad,0x34a9aa49,0x34ba7939,0x34ca4578,0x34d8f91c
.long 0x34d69a35,0x34e8a23d,0x34f86cbc,0x3502e961,0x34fa3bb7,0x35051a16,0x350b15cf,0x350ef9fd
.long 0x350981a1,0x350eaef6,0x3510c598,0x350fb9f5,0x350feee0,0x35108afe,0x350ce592,0x35051a16
.long 0x35101e3f,0x350a946b,0x34ff6e83,0x34dfe343,0x350a0db0,0x34fa3bb7,0x34d43308,0x34a3da7b
.long 0x34fc010d,0x34d1c3ad,0x349af3ad,0x3435b431,0x34d8f91c,0x349df168,0x342ef0c7,0x32aa9173
.long 0x34ac886f,0x344325bf,0x32e3625f,0xb40cbfc9,0x347138c6,0x337f63dd,0xb3eff186,0xb491d71e
.long 0x33fdd580,0xb38dd0d0,0xb48238aa,0xb4d1c3ad,0x31e3784b,0xb449d35e,0xb4bfdb2a,0xb5008b40
.long 0,0,0,0,0x342ef0c7,0x343c709a,0x3449d35e,0x34571703
.long 0x34a6c599,0x34b230ab,0x34bd2dd7,0x34c7b658,0x34e67fbe,0x34f2c69b,0x34fdbcac,0x3503a95e
.long 0x350859a3,0x350c79bc,0x350f3f81,0x3510a41b,0x3510b7a4,0x3510480f,0x350daced,0x3508f046
.long 0x350b91d7,0x35046447,0x34f4b21b,0x34db4fa5,0x34f2c69b,0x34d43308,0x34af5fee,0x348562e2
.long 0x34b7bd6c,0x348887f5,0x3428269e,0x33631c41,0x34571703,0x33b80a7b,0xb30e1543,0xb42155f9
.long 0x332a73dd,0xb3c6103c,0xb46abda8,0xb4b230ab,0xb405d7d9,0xb48ba7c4,0xb4ca4578,0xb4fa3bb7
.long 0xb494e66a,0xb4d69a35,0xb502e961,0xb50f3f81,0xb4d8f91c,0xb5051a16,0xb510480f,0xb50ce592
.long 0xb5046447,0xb5106c4f,0xb50b91d7,0xb4eccc40,0xb50feee0,0xb50c087d,0xb4eabbc5,0xb49df168
.long 0x3f80,0x3f80,0x3f80,0x3f80,0x3f80,0x3ec43f6d,0x3f353f35,0x3f6d3ec4
.long 0x3f80,0x3f353f35,0x3f80248d,0x3f35bf35,0x3f80,0x3f6d3ec4,0x3f35bf35,0xbec4bf6d
.long 0x3f80,0x3f80248d,0x250dbf80,0xbf80a554,0x3f80,0x3f6dbec4,0xbf35bf35,0xbec43f6d
.long 0x3f80,0x3f35bf35,0xbf80a554,0x3f353f35,0x3f80,0x3ec4bf6d,0xbf353f35,0x3f6dbec4
.long 0x3f80,0x250dbf80,0x3f80,0x250dbf80,0x3f80,0xbec4bf6d,0x3f353f35,0xbf6dbec4
.long 0x3f80,0xbf35bf35,0x3f80248d,0xbf353f35,0x3f80,0xbf6dbec4,0x3f35bf35,0x3ec43f6d
.long 0x3f80,0xbf80a554,0x250dbf80,0x3f80248d,0x3f80,0xbf6d3ec4,0xbf35bf35,0x3ec4bf6d
.long 0x3f80,0xbf353f35,0xbf80a554,0xbf35bf35,0x3f80,0xbec43f6d,0xbf353f35,0xbf6d3ec4
.long 0x3f80,0x3f80,0x3f80,0x3f80,0x3f80248d,0x3f6dbec4,0x3f35bf35,0x3ec4bf6d
.long 0x250dbf80,0xbf35bf35,0xbf80a554,0xbf353f35,0xbf80a554,0xbec43f6d,0x3f353f35,0x3f6dbec4
.long 0x3f80,0x3f80248d,0x250dbf80,0xbf80a554,0x3f80248d,0xbec4bf6d,0xbf353f35,0x3f6d3ec4
.long 0x250dbf80,0xbf353f35,0x3f80248d,0xbf35bf35,0xbf80a554,0x3f6d3ec4,0xbf35bf35,0x3ec43f6d
.long 0x3f80,0x250dbf80,0x3f80,0x250dbf80,0x3f80248d,0xbf6d3ec4,0x3f35bf35,0xbec43f6d
.long 0x250dbf80,0x3f353f35,0xbf80a554,0x3f35bf35,0xbf80a554,0x3ec4bf6d,0x3f353f35,0xbf6d3ec4
.long 0x3f80,0xbf80a554,0x250dbf80,0x3f80248d,0x3f80248d,0x3ec43f6d,0xbf353f35,0xbf6dbec4
.long 0x250dbf80,0x3f35bf35,0x3f80248d,0x3f353f35,0xbf80a554,0xbf6dbec4,0xbf35bf35,0xbec4bf6d
.long 0x3f80,0x3f80,0x3f80,0x3f80,0x250dbf80,0xbec4bf6d,0xbf35bf35,0xbf6dbec4
.long 0x3f80,0x3f353f35,0x3f80248d,0x3f35bf35,0x250dbf80,0xbf6dbec4,0xbf353f35,0x3ec43f6d
.long 0x3f80,0x3f80248d,0x250dbf80,0xbf80a554,0x250dbf80,0xbf6d3ec4,0x3f353f35,0x3ec4bf6d
.long 0x3f80,0x3f35bf35,0xbf80a554,0x3f353f35,0x250dbf80,0xbec43f6d,0x3f35bf35,0xbf6d3ec4
.long 0x3f80,0x250dbf80,0x3f80,0x250dbf80,0x250dbf80,0x3ec43f6d,0xbf35bf35,0x3f6d3ec4
.long 0x3f80,0xbf35bf35,0x3f80248d,0xbf353f35,0x250dbf80,0x3f6d3ec4,0xbf353f35,0xbec4bf6d
.long 0x3f80,0xbf80a554,0x250dbf80,0x3f80248d,0x250dbf80,0x3f6dbec4,0x3f353f35,0xbec43f6d
.long 0x3f80,0xbf353f35,0xbf80a554,0xbf35bf35,0x250dbf80,0x3ec4bf6d,0x3f35bf35,0x3f6dbec4
.long 0x3f80,0x3f80,0x3f80,0x3f80,0xbf80a554,0xbf6d3ec4,0xbf353f35,0xbec43f6d
.long 0x250dbf80,0xbf35bf35,0xbf80a554,0xbf353f35,0x3f80248d,0x3ec4bf6d,0xbf35bf35,0xbf6d3ec4
.long 0x3f80,0x3f80248d,0x250dbf80,0xbf80a554,0xbf80a554,0x3ec43f6d,0x3f35bf35,0xbf6dbec4
.long 0x250dbf80,0xbf353f35,0x3f80248d,0xbf35bf35,0x3f80248d,0xbf6dbec4,0x3f353f35,0xbec4bf6d
.long 0x3f80,0x250dbf80,0x3f80,0x250dbf80,0xbf80a554,0x3f6dbec4,0xbf353f35,0x3ec4bf6d
.long 0x250dbf80,0x3f353f35,0xbf80a554,0x3f35bf35,0x3f80248d,0xbec43f6d,0xbf35bf35,0x3f6dbec4
.long 0x3f80,0xbf80a554,0x250dbf80,0x3f80248d,0xbf80a554,0xbec4bf6d,0x3f35bf35,0x3f6d3ec4
.long 0x250dbf80,0x3f35bf35,0x3f80248d,0x3f353f35,0x3f80248d,0x3f6d3ec4,0x3f353f35,0x3ec43f6d
.long 0x3f808000,0x3f808000,0x3f808000,0x3f808000,0x3f808000,0x3f6dbec4,0x3f35bf35,0x3ec4bf6d
.long 0x3f808000,0x3f35bf35,0x248dbf80,0xbf35bf35,0x3f808000,0x3ec4bf6d,0xbf35bf35,0xbf6d3ec4
.long 0x3f808000,0x248dbf80,0xbf80a50d,0xa5543f80,0x3f808000,0xbec4bf6d,0xbf353f35,0x3f6d3ec4
.long 0x3f808000,0xbf35bf35,0xa5543f80,0x3f35bf35,0x3f808000,0xbf6dbec4,0x3f353f35,0xbec4bf6d
.long 0x3f808000,0xbf80a50d,0x3f808000,0xbf80a50d,0x3f808000,0xbf6d3ec4,0x3f35bf35,0xbec43f6d
.long 0x3f808000,0xbf353f35,0x248dbf80,0x3f353f35,0x3f808000,0xbec43f6d,0xbf35bf35,0x3f6dbec4
.long 0x3f808000,0xa5543f80,0xbf80a50d,0x248dbf80,0x3f808000,0x3ec43f6d,0xbf353f35,0xbf6dbec4
.long 0x3f808000,0x3f353f35,0xa5543f80,0xbf353f35,0x3f808000,0x3f6d3ec4,0x3f353f35,0x3ec43f6d
.long 0x3f808000,0x3f808000,0x3f808000,0x3f808000,0x248dbf80,0xbec4bf6d,0xbf35bf35,0xbf6dbec4
.long 0xbf80a50d,0xbf353f35,0xa5543f80,0x3f353f35,0xa5543f80,0x3f6d3ec4,0x3f35bf35,0xbec4bf6d
.long 0x3f808000,0x248dbf80,0xbf80a50d,0xa5543f80,0x248dbf80,0xbf6d3ec4,0x3f353f35,0x3ec4bf6d
.long 0xbf80a50d,0x3f353f35,0x248dbf80,0xbf353f35,0xa5543f80,0x3ec4bf6d,0xbf353f35,0x3f6dbec4
.long 0x3f808000,0xbf80a50d,0x3f808000,0xbf80a50d,0x248dbf80,0x3ec43f6d,0xbf35bf35,0x3f6d3ec4
.long 0xbf80a50d,0x3f35bf35,0xa5543f80,0xbf35bf35,0xa5543f80,0xbf6dbec4,0x3f35bf35,0x3ec43f6d
.long 0x3f808000,0xa5543f80,0xbf80a50d,0x248dbf80,0x248dbf80,0x3f6dbec4,0x3f353f35,0xbec43f6d
.long 0xbf80a50d,0xbf35bf35,0x248dbf80,0x3f35bf35,0xa5543f80,0xbec43f6d,0xbf353f35,0xbf6d3ec4
.long 0x3f808000,0x3f808000,0x3f808000,0x3f808000,0xbf80a50d,0xbf6d3ec4,0xbf353f35,0xbec43f6d
.long 0x3f808000,0x3f35bf35,0x248dbf80,0xbf35bf35,0xbf80a50d,0xbec43f6d,0x3f353f35,0x3f6dbec4
.long 0x3f808000,0x248dbf80,0xbf80a50d,0xa5543f80,0xbf80a50d,0x3ec43f6d,0x3f35bf35,0xbf6dbec4
.long 0x3f808000,0xbf35bf35,0xa5543f80,0x3f35bf35,0xbf80a50d,0x3f6d3ec4,0xbf35bf35,0x3ec43f6d
.long 0x3f808000,0xbf80a50d,0x3f808000,0xbf80a50d,0xbf80a50d,0x3f6dbec4,0xbf353f35,0x3ec4bf6d
.long 0x3f808000,0xbf353f35,0x248dbf80,0x3f353f35,0xbf80a50d,0x3ec4bf6d,0x3f353f35,0xbf6d3ec4
.long 0x3f808000,0xa5543f80,0xbf80a50d,0x248dbf80,0xbf80a50d,0xbec4bf6d,0x3f35bf35,0x3f6d3ec4
.long 0x3f808000,0x3f353f35,0xa5543f80,0xbf353f35,0xbf80a50d,0xbf6dbec4,0xbf35bf35,0xbec4bf6d
.long 0x3f808000,0x3f808000,0x3f808000,0x3f808000,0xa5543f80,0x3ec43f6d,0x3f353f35,0x3f6d3ec4
.long 0xbf80a50d,0xbf353f35,0xa5543f80,0x3f353f35,0x248dbf80,0xbf6dbec4,0xbf353f35,0x3ec43f6d
.long 0x3f808000,0x248dbf80,0xbf80a50d,0xa5543f80,0xa5543f80,0x3f6dbec4,0xbf35bf35,0xbec43f6d
.long 0xbf80a50d,0x3f353f35,0x248dbf80,0xbf353f35,0x248dbf80,0xbec43f6d,0x3f35bf35,0xbf6d3ec4
.long 0x3f808000,0xbf80a50d,0x3f808000,0xbf80a50d,0xa5543f80,0xbec4bf6d,0x3f353f35,0xbf6dbec4
.long 0xbf80a50d,0x3f35bf35,0xa5543f80,0xbf35bf35,0x248dbf80,0x3f6d3ec4,0xbf353f35,0xbec4bf6d
.long 0x3f808000,0xa5543f80,0xbf80a50d,0x248dbf80,0xa5543f80,0xbf6d3ec4,0xbf35bf35,0x3ec4bf6d
.long 0xbf80a50d,0xbf35bf35,0x248dbf80,0x3f35bf35,0x248dbf80,0x3ec4bf6d,0x3f35bf35,0x3f6dbec4
LtabEnd:
.section .rodata,"a"
.p2align 6
.amdhsa_kernel gated_mix__ssm_conv_s4d__spectral_gfnet__prompt_kernel
  .amdhsa_next_free_vgpr 256
  .amdhsa_next_free_sgpr 102
  .amdhsa_accum_offset 256
  .amdhsa_group_segment_fixed_size 0
  .amdhsa_kernarg_size 112
  .amdhsa_user_sgpr_count 2
  .amdhsa_user_sgpr_kernarg_segment_ptr 1
  .amdhsa_system_sgpr_workgroup_id_x 1
.end_amdhsa_kernel
```
